```python
import torch

def _softmax(x, axis=-1):
    return torch.softmax(x, dim=axis)
def _gelu(x):
    return torch.nn.functional.gelu(x, approximate="tanh")
def _silu(x):
    return torch.nn.functional.silu(x)
def _sigmoid(x):
    return torch.sigmoid(x)
def _layernorm(x, axis=-1, eps=1e-5):
    m = x.mean(dim=axis, keepdim=True)
    v = x.var(dim=axis, keepdim=True, unbiased=False)
    return (x - m) / torch.sqrt(v + eps)
def _scatter_add(tgt, idx, src, axis=0):
    return tgt.clone().index_add_(axis, idx, src)
def _segment_sum(src, seg, n):
    out = torch.zeros((n,) + src.shape[1:], dtype=src.dtype)
    return out.index_add_(0, seg, src)
def _pad(x, pw):
    flat = tuple(v for pair in reversed(pw) for v in pair)
    return torch.nn.functional.pad(x, flat)

kernel_name = 'sequential_preLN__ssm_conv_s4d__dense_activation_squared_relu__prompt'

def setup_inputs():

    _w = (lambda a: (lambda t: t.to(torch.bfloat16) if t.is_floating_point() else t)(torch.as_tensor(a)))
    def _A_setup():
        Bsz, L, D, N = 1, 2048, 640, 128
        return {
            "u": _w((lambda *s: torch.randn(*s, dtype=torch.bfloat16) * 0.05)(Bsz, L, D)),
            "log_A_real": _w((lambda *s: torch.randn(*s, dtype=torch.bfloat16) * 3.2)(D, N) * 0.5),
            "A_imag": _w((lambda *s: torch.randn(*s, dtype=torch.bfloat16) * 0.05)(D, N) * 3.14),
            "C_real": _w((lambda *s: torch.randn(*s, dtype=torch.bfloat16) * 0.2)(D, N) / N ** 0.5),
            "C_imag": _w((lambda *s: torch.randn(*s, dtype=torch.bfloat16) * 0.2)(D, N) / N ** 0.5),
            "log_dt": _w((lambda *s: torch.randn(*s, dtype=torch.bfloat16) * 0.05)(D) * 0.5 - 4.0),
            "D_skip": _w((lambda *s: torch.randn(*s, dtype=torch.bfloat16) * 0.05)(D)),
        }
    _A_in = _A_setup()

    def _B_setup():
        B, S, D, F = 1, 2048, 640, 1728
        return {
            "x": _w((lambda *s: torch.randn(*s, dtype=torch.bfloat16) * 0.05)(B, S, D)),
            "w1": _w((lambda *s: torch.randn(*s, dtype=torch.bfloat16) * 0.05)(D, F)),
            "b1": _w((lambda *s: torch.randn(*s, dtype=torch.bfloat16) * 0.4)(F)),
            "w2": _w((lambda *s: torch.randn(*s, dtype=torch.bfloat16) * 0.05)(F, D)),
            "b2": _w((lambda *s: torch.randn(*s, dtype=torch.bfloat16) * 1.6)(D)),
        }
    _B_in = _B_setup()

    return {
        "A_u": _A_in["u"],
        "A_log_A_real": _A_in["log_A_real"],
        "A_A_imag": _A_in["A_imag"],
        "A_C_real": _A_in["C_real"],
        "A_C_imag": _A_in["C_imag"],
        "A_log_dt": _A_in["log_dt"],
        "A_D_skip": _A_in["D_skip"],
        "B_x": _B_in["x"],
        "B_w1": _B_in["w1"],
        "B_b1": _B_in["b1"],
        "B_w2": _B_in["w2"],
        "B_b2": _B_in["b2"],
    }

def reference(A_u, A_log_A_real, A_A_imag, A_C_real, A_C_imag, A_log_dt, A_D_skip, B_x, B_w1, B_b1, B_w2, B_b2):
    def _A_ref(u, log_A_real, A_imag, C_real, C_imag, log_dt, D_skip):
        L = u.shape[1]
        dt = torch.exp(log_dt)
        A = -torch.exp(log_A_real) + 1j * A_imag
        C = (C_real + 1j * C_imag) * dt[:, None]
        pos = (lambda x, dt: x.to(dt))(torch.arange(L), log_dt.dtype)
        P = torch.exp((A * dt[:, None])[:, :, None] * pos[None, None, :])
        K = 2.0 * torch.einsum("dn,dnl->dl", C, P).real
        L2 = 2 * L
        u_t = (lambda x, *d: x.permute(*d))(u, 0, 2, 1)
        Kf = (lambda x, *a, **k: torch.fft.rfft(x.float(), *a, **k))(K, L2)
        Uf = (lambda x, *a, **k: torch.fft.rfft(x.float(), *a, **k))(u_t, L2)
        y = (lambda x, *a, **k: torch.fft.irfft(x, *a, **k).to(torch.bfloat16))(Uf * Kf[None, :, :], L2)[:, :, :L]
        y = (lambda x, *d: x.permute(*d))(y, 0, 2, 1)
        return y + u * D_skip[None, None, :]

    def _B_ref(x, w1, b1, w2, b2):
        h = torch.einsum("bsd,df->bsf", x, w1) + b1
        zero = torch.zeros_like(h)
        r = torch.where(h > zero, h, zero)
        h = r * r
        out = torch.einsum("bsf,fd->bsd", h, w2) + b2
        return out

    x = A_u
    h = x + _A_ref(_layernorm(x, axis=-1), A_log_A_real, A_A_imag, A_C_real, A_C_imag, A_log_dt, A_D_skip)
    h2 = h + _B_ref(_layernorm(h, axis=-1), B_w1, B_b1, B_w2, B_b2)
    return h2
```

```asm
; @launch grid=(256,1,1) block=(512,1,1) lds=163840
.amdgcn_target "amdgcn-amd-amdhsa--gfx950"
.text
.globl sequential_preLN__ssm_conv_s4d__dense_activation_squared_relu__prompt_kernel
.p2align 8
.type sequential_preLN__ssm_conv_s4d__dense_activation_squared_relu__prompt_kernel,@function
sequential_preLN__ssm_conv_s4d__dense_activation_squared_relu__prompt_kernel:
    s_cmp_ge_u32 s2, 256
    s_cbranch_scc1 L_END
    s_load_dwordx16 s[16:31], s[0:1], 0
    s_load_dwordx8 s[36:43], s[0:1], 64
    s_load_dwordx2 s[44:45], s[0:1], 96
    s_load_dwordx4 s[32:35], s[0:1], 104
    s_lshr_b32 s65, s2, 3
    s_sub_u32 s46, s65, 8
    s_cmp_ge_u32 s46, 2
    s_cbranch_scc1 L_NOPF
    s_getpc_b64 s[46:47]
L_PC:
    s_sub_u32 s46, s46, L_PC-sequential_preLN__ssm_conv_s4d__dense_activation_squared_relu__prompt_kernel
    s_subb_u32 s47, s47, 0
    v_lshlrev_b32 v4, 7, v0
    v_cmp_gt_u32 vcc, L_CODE_END-sequential_preLN__ssm_conv_s4d__dense_activation_squared_relu__prompt_kernel, v4
    s_and_saveexec_b64 s[68:69], vcc
    s_cbranch_execz L_NOPF2
    global_load_dword v253, v4, s[46:47]
L_NOPF2:
    s_mov_b64 exec, s[68:69]
L_NOPF:
    v_lshrrev_b32 v4, 6, v0
    v_and_b32 v1, 63, v0
    v_and_b32 v2, 15, v1
    v_readfirstlane_b32 s3, v4
    v_lshrrev_b32 v3, 4, v1
    v_mov_b32 v5, 0
    v_mov_b32 v6, 0
    v_mov_b32 v7, 0
    v_mov_b32 v240, 0
    v_mov_b32 v241, 0
    v_mov_b32 v242, 0
    v_mov_b32 v243, 0
    v_mov_b32 v244, 0
    v_mov_b32 v245, 0
    v_mov_b32 v246, 0
    s_and_b32 s64, s2, 7
    s_lshr_b32 s65, s2, 3
    s_lshr_b32 s66, s64, 1
    s_lshl_b32 s66, s66, 2
    s_lshr_b32 s46, s65, 3
    s_add_u32 s66, s66, s46
    s_and_b32 s67, s64, 1
    s_lshl_b32 s67, s67, 3
    s_and_b32 s46, s65, 7
    s_add_u32 s67, s67, s46
    s_and_b32 s46, s64, 1
    s_lshl_b32 s46, s46, 2
    s_and_b32 s47, s65, 3
    s_add_u32 s60, s46, s47
    s_mul_i32 s61, s60, 54
    s_and_b32 s46, s3, 3
    s_mul_i32 s46, s46, 7
    s_add_u32 s61, s61, s46
    s_lshr_b32 s46, s3, 2
    s_mul_i32 s46, s46, 27
    s_add_u32 s61, s61, s46
    s_mul_i32 s61, s61, 5120
    s_add_u32 s61, s61, 0x1000000
    s_cmp_lt_u32 s65, 8
    s_cbranch_scc1 L_STATS
    s_cmp_lt_u32 s65, 28
    s_cbranch_scc1 L_CONV
    s_branch L_COLSUM
L_STATS:
    s_lshl_b32 s46, s65, 3
    s_add_u32 s12, s46, s64
    s_lshl_b32 s13, s12, 5
    s_lshl_b32 s14, s3, 2
    s_add_u32 s13, s13, s14
    v_add_u32 v4, s13, v3
    v_mul_u32_u24 v5, 1280, v4
    v_lshl_add_u32 v5, v2, 4, v5
    s_waitcnt lgkmcnt(0)
    global_load_dwordx4 v[32:35], v5, s[16:17] offset:0
    global_load_dwordx4 v[36:39], v5, s[16:17] offset:256
    global_load_dwordx4 v[40:43], v5, s[16:17] offset:512
    global_load_dwordx4 v[44:47], v5, s[16:17] offset:768
    global_load_dwordx4 v[48:51], v5, s[16:17] offset:1024
    v_mov_b32 v250, v4
    s_mov_b32 s8, s34
    s_mov_b32 s9, s35
    s_mov_b32 s10, 0x10000000
    s_mov_b32 s11, 0x00020000
    s_mov_b32 s48, s36
    s_mov_b32 s49, s37
    s_mov_b32 s50, 0x21c000
    s_mov_b32 s51, 0x00020000
    s_mov_b32 s52, s40
    s_mov_b32 s53, s41
    s_mov_b32 s54, 0x21c000
    s_mov_b32 s55, 0x00020000
    s_mov_b32 s56, s32
    s_mov_b32 s57, s33
    s_mov_b32 s58, 0x100
    s_mov_b32 s59, 0x00020000
    s_cmp_lg_u32 s3, 7
    s_cbranch_scc1 NOST2_1
    s_mov_b64 s[68:69], exec
    s_mov_b64 exec, 0xf
    v_mov_b32 v4, -1
    v_mov_b32 v5, -1
    v_mov_b32 v6, -1
    v_mov_b32 v7, -1
    v_lshlrev_b32 v8, 4, v1
    s_lshl_b32 s13, s66, 10
    s_lshl_b32 s46, s67, 6
    s_add_u32 s13, s13, s46
    s_add_u32 s13, s13, 0x10000
    buffer_store_dwordx4 v[4:7], v8, s[8:11], s13 offen sc1
    s_mov_b64 exec, s[68:69]
    s_nop 1
NOST2_1:
    v_mov_b32 v4, v250
    s_cmp_lg_u32 s12, 0
    s_cbranch_scc1 L_NOZ
    s_cmp_lg_u32 s3, 7
    s_cbranch_scc1 L_NOZ
    v_mov_b32 v60, 0
    v_mov_b32 v61, 0
    v_mov_b32 v62, 0
    v_mov_b32 v63, 0
    v_lshlrev_b32 v6, 4, v1
    s_mov_b32 s14, 0x20000
    buffer_store_dwordx4 v[60:63], v6, s[8:11], s14 offen offset:0 sc1
    buffer_store_dwordx4 v[60:63], v6, s[8:11], s14 offen offset:1024 sc1
    buffer_store_dwordx4 v[60:63], v6, s[8:11], s14 offen offset:2048 sc1
L_NOZ:
    v_mov_b32 v7, 0x3f803f80
    v_mov_b32 v8, 0
    v_mov_b32 v9, 0
    v_mov_b32 v10, 0
    v_mov_b32 v11, 0
    v_mov_b32 v12, 0
    v_mov_b32 v13, 0
    v_mov_b32 v14, 0
    v_mov_b32 v15, 0
    s_waitcnt vmcnt(0)
    v_dot2_f32_bf16 v8, v32, v7, v8
    v_dot2_f32_bf16 v12, v32, v32, v12
    v_dot2_f32_bf16 v9, v33, v7, v9
    v_dot2_f32_bf16 v13, v33, v33, v13
    v_dot2_f32_bf16 v10, v34, v7, v10
    v_dot2_f32_bf16 v14, v34, v34, v14
    v_dot2_f32_bf16 v11, v35, v7, v11
    v_dot2_f32_bf16 v15, v35, v35, v15
    v_dot2_f32_bf16 v8, v36, v7, v8
    v_dot2_f32_bf16 v12, v36, v36, v12
    v_dot2_f32_bf16 v9, v37, v7, v9
    v_dot2_f32_bf16 v13, v37, v37, v13
    v_dot2_f32_bf16 v10, v38, v7, v10
    v_dot2_f32_bf16 v14, v38, v38, v14
    v_dot2_f32_bf16 v11, v39, v7, v11
    v_dot2_f32_bf16 v15, v39, v39, v15
    v_dot2_f32_bf16 v8, v40, v7, v8
    v_dot2_f32_bf16 v12, v40, v40, v12
    v_dot2_f32_bf16 v9, v41, v7, v9
    v_dot2_f32_bf16 v13, v41, v41, v13
    v_dot2_f32_bf16 v10, v42, v7, v10
    v_dot2_f32_bf16 v14, v42, v42, v14
    v_dot2_f32_bf16 v11, v43, v7, v11
    v_dot2_f32_bf16 v15, v43, v43, v15
    v_dot2_f32_bf16 v8, v44, v7, v8
    v_dot2_f32_bf16 v12, v44, v44, v12
    v_dot2_f32_bf16 v9, v45, v7, v9
    v_dot2_f32_bf16 v13, v45, v45, v13
    v_dot2_f32_bf16 v10, v46, v7, v10
    v_dot2_f32_bf16 v14, v46, v46, v14
    v_dot2_f32_bf16 v11, v47, v7, v11
    v_dot2_f32_bf16 v15, v47, v47, v15
    v_dot2_f32_bf16 v8, v48, v7, v8
    v_dot2_f32_bf16 v12, v48, v48, v12
    v_dot2_f32_bf16 v9, v49, v7, v9
    v_dot2_f32_bf16 v13, v49, v49, v13
    v_dot2_f32_bf16 v10, v50, v7, v10
    v_dot2_f32_bf16 v14, v50, v50, v14
    v_dot2_f32_bf16 v11, v51, v7, v11
    v_dot2_f32_bf16 v15, v51, v51, v15
    s_nop 2
    v_add_f32 v8, v8, v9
    v_add_f32 v10, v10, v11
    v_add_f32 v12, v12, v13
    v_add_f32 v14, v14, v15
    v_add_f32 v8, v8, v10
    v_add_f32 v9, v12, v14
    s_nop 1
    v_add_f32_dpp v8, v8, v8 row_ror:8 row_mask:0xf bank_mask:0xf
    v_add_f32_dpp v9, v9, v9 row_ror:8 row_mask:0xf bank_mask:0xf
    s_nop 1
    v_add_f32_dpp v8, v8, v8 row_ror:4 row_mask:0xf bank_mask:0xf
    v_add_f32_dpp v9, v9, v9 row_ror:4 row_mask:0xf bank_mask:0xf
    s_nop 1
    v_add_f32_dpp v8, v8, v8 row_ror:2 row_mask:0xf bank_mask:0xf
    v_add_f32_dpp v9, v9, v9 row_ror:2 row_mask:0xf bank_mask:0xf
    s_nop 1
    v_add_f32_dpp v8, v8, v8 row_ror:1 row_mask:0xf bank_mask:0xf
    v_add_f32_dpp v9, v9, v9 row_ror:1 row_mask:0xf bank_mask:0xf
    v_mul_f32 v8, 0x3acccccd, v8
    v_mul_f32 v9, 0x3acccccd, v9
    v_fma_f32 v9, -v8, v8, v9
    v_max_f32 v9, 0, v9
    v_cvt_pk_bf16_f32 v8, v8, v8
    v_lshlrev_b32 v8, 16, v8
    v_cvt_pk_bf16_f32 v9, v9, v9
    v_lshlrev_b32 v9, 16, v9
    v_add_f32 v9, 0x3727c5ac, v9
    v_cvt_pk_bf16_f32 v9, v9, v9
    v_lshlrev_b32 v9, 16, v9
    v_sqrt_f32 v9, v9
    s_nop 0
    v_cvt_pk_bf16_f32 v9, v9, v9
    v_lshlrev_b32 v9, 16, v9
    v_rcp_f32 v9, v9
    s_nop 0
    v_lshlrev_b32 v4, 3, v4
    v_cmp_eq_u32 vcc, 0, v2
    s_and_saveexec_b64 s[68:69], vcc
    s_mov_b32 s14, 0x0
    buffer_store_dwordx2 v[8:9], v4, s[8:11], s14 offen sc1
    s_mov_b64 exec, s[68:69]
    s_waitcnt vmcnt(0)
    s_barrier
    s_cmp_lg_u32 s3, 0
    s_cbranch_scc1 L_NC1
    s_mov_b64 s[68:69], exec
    s_mov_b64 exec, 1
    v_mov_b32 v4, 0
    v_mov_b32 v5, 1
    buffer_atomic_add v5, v4, s[56:59], 0 offen sc0 sc1
    s_waitcnt vmcnt(0)
    v_readfirstlane_b32 s13, v5
    s_mov_b64 exec, s[68:69]
    s_cmp_lg_u32 s13, 63
    s_cbranch_scc1 ARR_2
    s_mov_b32 s13, 128
    s_mov_b64 s[68:69], exec
    s_mov_b64 exec, 1
    v_mov_b32 v4, 0
    v_mov_b32 v5, 1
    buffer_store_dword v5, v4, s[56:59], s13 offen sc1
    s_mov_b64 exec, s[68:69]
ARR_2:
    s_branch L_NC1
L_COLSUM:
    s_waitcnt lgkmcnt(0)
    s_mov_b32 s8, s34
    s_mov_b32 s9, s35
    s_mov_b32 s10, 0x10000000
    s_mov_b32 s11, 0x00020000
    s_mov_b32 s48, s36
    s_mov_b32 s49, s37
    s_mov_b32 s50, 0x21c000
    s_mov_b32 s51, 0x00020000
    s_mov_b32 s52, s40
    s_mov_b32 s53, s41
    s_mov_b32 s54, 0x21c000
    s_mov_b32 s55, 0x00020000
    s_mov_b32 s56, s32
    s_mov_b32 s57, s33
    s_mov_b32 s58, 0x100
    s_mov_b32 s59, 0x00020000
    s_cmp_lg_u32 s3, 7
    s_cbranch_scc1 NOST2_3
    s_mov_b64 s[68:69], exec
    s_mov_b64 exec, 0xf
    v_mov_b32 v4, -1
    v_mov_b32 v5, -1
    v_mov_b32 v6, -1
    v_mov_b32 v7, -1
    v_lshlrev_b32 v8, 4, v1
    s_lshl_b32 s13, s66, 10
    s_lshl_b32 s46, s67, 6
    s_add_u32 s13, s13, s46
    s_add_u32 s13, s13, 0x10000
    buffer_store_dwordx4 v[4:7], v8, s[8:11], s13 offen sc1
    s_mov_b64 exec, s[68:69]
    s_nop 1
NOST2_3:
L_NC1:
    s_sub_u32 s46, s65, 20
    s_cmp_lt_u32 s65, 8
    s_cselect_b32 s46, s65, s46
    s_lshl_b32 s46, s46, 3
    s_add_u32 s46, s46, s64
    s_mov_b32 s62, s46
    s_mul_i32 s63, s3, 96
    s_add_u32 s63, s63, s46
    s_cmp_lg_u32 s3, 7
    s_cbranch_scc1 L_NC1A
    v_lshlrev_b32 v8, 2, v1
    v_add_u32 v8, 158720, v8
    v_mov_b32 v9, 0
    ds_write_b32 v8, v9
    s_waitcnt lgkmcnt(0)
L_NC1A:
    s_barrier
    s_cmp_ge_u32 s3, 4
    s_cbranch_scc1 L_NC_LD
    s_cmp_ge_u32 s63, 432
    s_cbranch_scc1 RPD_4
    s_mul_i32 s14, s3, 5120
    s_add_u32 s14, s14, 114688
    s_mul_i32 s13, s63, 19419
    s_lshr_b32 s13, s13, 20
    s_mul_i32 s15, s13, 54
    s_sub_u32 s15, s63, s15
    s_mul_i32 s4, s15, 40960
    s_mul_i32 s5, s13, 160
    s_add_u32 s4, s4, s5
    s_mov_b32 s47, 104858
    v_add_u32 v8, 0, v1
    v_mul_lo_u32 v9, v8, s47
    v_lshrrev_b32 v9, 20, v9
    v_mul_u32_u24 v10, 10, v9
    v_sub_u32 v10, v8, v10
    v_mul_u32_u24 v9, 1280, v9
    v_lshl_add_u32 v9, v10, 4, v9
    s_add_u32 m0, s14, 0
    s_nop 0
    buffer_load_dwordx4 v9, s[52:55], s4 offen lds
    v_add_u32 v8, 64, v1
    v_mul_lo_u32 v9, v8, s47
    v_lshrrev_b32 v9, 20, v9
    v_mul_u32_u24 v10, 10, v9
    v_sub_u32 v10, v8, v10
    v_mul_u32_u24 v9, 1280, v9
    v_lshl_add_u32 v9, v10, 4, v9
    s_add_u32 m0, s14, 1024
    s_nop 0
    buffer_load_dwordx4 v9, s[52:55], s4 offen lds
    v_add_u32 v8, 128, v1
    v_mul_lo_u32 v9, v8, s47
    v_lshrrev_b32 v9, 20, v9
    v_mul_u32_u24 v10, 10, v9
    v_sub_u32 v10, v8, v10
    v_mul_u32_u24 v9, 1280, v9
    v_lshl_add_u32 v9, v10, 4, v9
    s_add_u32 m0, s14, 2048
    s_nop 0
    buffer_load_dwordx4 v9, s[52:55], s4 offen lds
    v_add_u32 v8, 192, v1
    v_mul_lo_u32 v9, v8, s47
    v_lshrrev_b32 v9, 20, v9
    v_mul_u32_u24 v10, 10, v9
    v_sub_u32 v10, v8, v10
    v_mul_u32_u24 v9, 1280, v9
    v_lshl_add_u32 v9, v10, 4, v9
    s_add_u32 m0, s14, 3072
    s_nop 0
    buffer_load_dwordx4 v9, s[52:55], s4 offen lds
    v_add_u32 v8, 256, v1
    v_mul_lo_u32 v9, v8, s47
    v_lshrrev_b32 v9, 20, v9
    v_mul_u32_u24 v10, 10, v9
    v_sub_u32 v10, v8, v10
    v_mul_u32_u24 v9, 1280, v9
    v_lshl_add_u32 v9, v10, 4, v9
    s_add_u32 m0, s14, 4096
    s_nop 0
    buffer_load_dwordx4 v9, s[52:55], s4 offen lds
    v_lshrrev_b32 v5, 2, v2
    v_lshl_add_u32 v5, v3, 2, v5
    v_and_b32 v6, 3, v2
    v_lshlrev_b32 v6, 3, v6
    v_mul_u32_u24 v5, 160, v5
    v_add3_u32 v5, v5, v6, s14
    v_lshlrev_b32 v7, 4, v1
    s_mul_i32 s4, s63, 5120
    s_add_u32 s4, s4, 0x1000000
    s_waitcnt vmcnt(0)
    ds_read_b64_tr_b16 v[64:65], v5 offset:0
    ds_read_b64_tr_b16 v[66:67], v5 offset:2560
    ds_read_b64_tr_b16 v[68:69], v5 offset:32
    ds_read_b64_tr_b16 v[70:71], v5 offset:2592
    ds_read_b64_tr_b16 v[72:73], v5 offset:64
    ds_read_b64_tr_b16 v[74:75], v5 offset:2624
    ds_read_b64_tr_b16 v[76:77], v5 offset:96
    ds_read_b64_tr_b16 v[78:79], v5 offset:2656
    ds_read_b64_tr_b16 v[80:81], v5 offset:128
    ds_read_b64_tr_b16 v[82:83], v5 offset:2688
    s_waitcnt lgkmcnt(8)
    buffer_store_dwordx4 v[64:67], v7, s[8:11], s4 offen offset:0 sc1
    s_waitcnt lgkmcnt(6)
    buffer_store_dwordx4 v[68:71], v7, s[8:11], s4 offen offset:1024 sc1
    s_waitcnt lgkmcnt(4)
    buffer_store_dwordx4 v[72:75], v7, s[8:11], s4 offen offset:2048 sc1
    s_waitcnt lgkmcnt(2)
    buffer_store_dwordx4 v[76:79], v7, s[8:11], s4 offen offset:3072 sc1
    s_waitcnt lgkmcnt(0)
    s_add_u32 s4, s4, 4096
    buffer_store_dwordx4 v[80:83], v7, s[8:11], s4 offen offset:0 sc1
RPD_4:
    s_cmp_ge_u32 s62, 12
    s_cbranch_scc1 L_NC2
    s_lshl_b32 s63, s62, 2
    s_add_u32 s63, s63, s3
    s_add_u32 s63, s63, 384
    s_waitcnt lgkmcnt(0)
    s_cmp_ge_u32 s63, 432
    s_cbranch_scc1 RPD_5
    s_mul_i32 s14, s3, 5120
    s_add_u32 s14, s14, 114688
    s_mul_i32 s13, s63, 19419
    s_lshr_b32 s13, s13, 20
    s_mul_i32 s15, s13, 54
    s_sub_u32 s15, s63, s15
    s_mul_i32 s4, s15, 40960
    s_mul_i32 s5, s13, 160
    s_add_u32 s4, s4, s5
    s_mov_b32 s47, 104858
    v_add_u32 v8, 0, v1
    v_mul_lo_u32 v9, v8, s47
    v_lshrrev_b32 v9, 20, v9
    v_mul_u32_u24 v10, 10, v9
    v_sub_u32 v10, v8, v10
    v_mul_u32_u24 v9, 1280, v9
    v_lshl_add_u32 v9, v10, 4, v9
    s_add_u32 m0, s14, 0
    s_nop 0
    buffer_load_dwordx4 v9, s[52:55], s4 offen lds
    v_add_u32 v8, 64, v1
    v_mul_lo_u32 v9, v8, s47
    v_lshrrev_b32 v9, 20, v9
    v_mul_u32_u24 v10, 10, v9
    v_sub_u32 v10, v8, v10
    v_mul_u32_u24 v9, 1280, v9
    v_lshl_add_u32 v9, v10, 4, v9
    s_add_u32 m0, s14, 1024
    s_nop 0
    buffer_load_dwordx4 v9, s[52:55], s4 offen lds
    v_add_u32 v8, 128, v1
    v_mul_lo_u32 v9, v8, s47
    v_lshrrev_b32 v9, 20, v9
    v_mul_u32_u24 v10, 10, v9
    v_sub_u32 v10, v8, v10
    v_mul_u32_u24 v9, 1280, v9
    v_lshl_add_u32 v9, v10, 4, v9
    s_add_u32 m0, s14, 2048
    s_nop 0
    buffer_load_dwordx4 v9, s[52:55], s4 offen lds
    v_add_u32 v8, 192, v1
    v_mul_lo_u32 v9, v8, s47
    v_lshrrev_b32 v9, 20, v9
    v_mul_u32_u24 v10, 10, v9
    v_sub_u32 v10, v8, v10
    v_mul_u32_u24 v9, 1280, v9
    v_lshl_add_u32 v9, v10, 4, v9
    s_add_u32 m0, s14, 3072
    s_nop 0
    buffer_load_dwordx4 v9, s[52:55], s4 offen lds
    v_add_u32 v8, 256, v1
    v_mul_lo_u32 v9, v8, s47
    v_lshrrev_b32 v9, 20, v9
    v_mul_u32_u24 v10, 10, v9
    v_sub_u32 v10, v8, v10
    v_mul_u32_u24 v9, 1280, v9
    v_lshl_add_u32 v9, v10, 4, v9
    s_add_u32 m0, s14, 4096
    s_nop 0
    buffer_load_dwordx4 v9, s[52:55], s4 offen lds
    v_lshrrev_b32 v5, 2, v2
    v_lshl_add_u32 v5, v3, 2, v5
    v_and_b32 v6, 3, v2
    v_lshlrev_b32 v6, 3, v6
    v_mul_u32_u24 v5, 160, v5
    v_add3_u32 v5, v5, v6, s14
    v_lshlrev_b32 v7, 4, v1
    s_mul_i32 s4, s63, 5120
    s_add_u32 s4, s4, 0x1000000
    s_waitcnt vmcnt(0)
    ds_read_b64_tr_b16 v[64:65], v5 offset:0
    ds_read_b64_tr_b16 v[66:67], v5 offset:2560
    ds_read_b64_tr_b16 v[68:69], v5 offset:32
    ds_read_b64_tr_b16 v[70:71], v5 offset:2592
    ds_read_b64_tr_b16 v[72:73], v5 offset:64
    ds_read_b64_tr_b16 v[74:75], v5 offset:2624
    ds_read_b64_tr_b16 v[76:77], v5 offset:96
    ds_read_b64_tr_b16 v[78:79], v5 offset:2656
    ds_read_b64_tr_b16 v[80:81], v5 offset:128
    ds_read_b64_tr_b16 v[82:83], v5 offset:2688
    s_waitcnt lgkmcnt(8)
    buffer_store_dwordx4 v[64:67], v7, s[8:11], s4 offen offset:0 sc1
    s_waitcnt lgkmcnt(6)
    buffer_store_dwordx4 v[68:71], v7, s[8:11], s4 offen offset:1024 sc1
    s_waitcnt lgkmcnt(4)
    buffer_store_dwordx4 v[72:75], v7, s[8:11], s4 offen offset:2048 sc1
    s_waitcnt lgkmcnt(2)
    buffer_store_dwordx4 v[76:79], v7, s[8:11], s4 offen offset:3072 sc1
    s_waitcnt lgkmcnt(0)
    s_add_u32 s4, s4, 4096
    buffer_store_dwordx4 v[80:83], v7, s[8:11], s4 offen offset:0 sc1
RPD_5:
L_NC2:
    s_waitcnt vmcnt(0)
    s_mov_b64 exec, 1
    v_mov_b32 v4, 158728
    v_mov_b32 v5, 1
    ds_add_rtn_u32 v5, v4, v5
    s_waitcnt lgkmcnt(0)
    v_readfirstlane_b32 s13, v5
    s_mov_b64 exec, -1
    s_cmp_lg_u32 s13, 3
    s_cbranch_scc1 L_NC3
    s_mov_b64 s[68:69], exec
    s_mov_b64 exec, 1
    v_mov_b32 v4, 4
    v_mov_b32 v5, 1
    buffer_atomic_add v5, v4, s[56:59], 0 offen sc0 sc1
    s_waitcnt vmcnt(0)
    v_readfirstlane_b32 s13, v5
    s_mov_b64 exec, s[68:69]
    s_cmp_lg_u32 s13, 95
    s_cbranch_scc1 ARR_6
    s_mov_b32 s13, 132
    s_mov_b64 s[68:69], exec
    s_mov_b64 exec, 1
    v_mov_b32 v4, 0
    v_mov_b32 v5, 1
    buffer_store_dword v5, v4, s[56:59], s13 offen sc1
    s_mov_b64 exec, s[68:69]
ARR_6:
L_NC3:
    s_cmp_lt_u32 s65, 28
    s_cbranch_scc1 L_NC5
    s_sub_u32 s46, s65, 28
    s_lshl_b32 s46, s46, 3
    s_add_u32 s12, s46, s64
    s_cmp_ge_u32 s12, 27
    s_cbranch_scc1 L_NC5
    v_lshrrev_b32 v4, 3, v1
    s_lshl_b32 s13, s3, 3
    v_add_u32 v4, s13, v4
    v_mul_u32_u24 v4, 3456, v4
    v_and_b32 v5, 7, v1
    v_lshl_add_u32 v4, v5, 4, v4
    s_lshl_b32 s13, s12, 7
    buffer_load_dwordx4 v[64:67], v4, s[48:51], s13 offen
    s_add_u32 s13, s13, 110592
    buffer_load_dwordx4 v[68:71], v4, s[48:51], s13 offen
    s_add_u32 s13, s13, 110592
    buffer_load_dwordx4 v[72:75], v4, s[48:51], s13 offen
    s_add_u32 s13, s13, 110592
    buffer_load_dwordx4 v[76:79], v4, s[48:51], s13 offen
    s_add_u32 s13, s13, 110592
    buffer_load_dwordx4 v[80:83], v4, s[48:51], s13 offen
    s_add_u32 s13, s13, 110592
    buffer_load_dwordx4 v[84:87], v4, s[48:51], s13 offen
    s_add_u32 s13, s13, 110592
    buffer_load_dwordx4 v[88:91], v4, s[48:51], s13 offen
    s_add_u32 s13, s13, 110592
    buffer_load_dwordx4 v[92:95], v4, s[48:51], s13 offen
    s_add_u32 s13, s13, 110592
    buffer_load_dwordx4 v[96:99], v4, s[48:51], s13 offen
    s_add_u32 s13, s13, 110592
    buffer_load_dwordx4 v[100:103], v4, s[48:51], s13 offen
    s_add_u32 s13, s13, 110592
    buffer_load_dwordx4 v[104:107], v4, s[48:51], s13 offen
    s_add_u32 s13, s13, 110592
    buffer_load_dwordx4 v[108:111], v4, s[48:51], s13 offen
    s_add_u32 s13, s13, 110592
    buffer_load_dwordx4 v[112:115], v4, s[48:51], s13 offen
    s_add_u32 s13, s13, 110592
    buffer_load_dwordx4 v[116:119], v4, s[48:51], s13 offen
    s_add_u32 s13, s13, 110592
    buffer_load_dwordx4 v[120:123], v4, s[48:51], s13 offen
    s_add_u32 s13, s13, 110592
    buffer_load_dwordx4 v[124:127], v4, s[48:51], s13 offen
    s_add_u32 s13, s13, 110592
    buffer_load_dwordx4 v[128:131], v4, s[48:51], s13 offen
    s_add_u32 s13, s13, 110592
    buffer_load_dwordx4 v[132:135], v4, s[48:51], s13 offen
    s_add_u32 s13, s13, 110592
    buffer_load_dwordx4 v[136:139], v4, s[48:51], s13 offen
    s_add_u32 s13, s13, 110592
    buffer_load_dwordx4 v[140:143], v4, s[48:51], s13 offen
    s_add_u32 s13, s13, 110592
    v_mov_b32 v8, 0
    v_mov_b32 v9, 0
    v_mov_b32 v10, 0
    v_mov_b32 v11, 0
    v_mov_b32 v12, 0
    v_mov_b32 v13, 0
    v_mov_b32 v14, 0
    v_mov_b32 v15, 0
    s_waitcnt vmcnt(19)
    v_lshlrev_b32 v16, 16, v64
    v_and_b32 v17, 0xffff0000, v64
    v_pk_add_f32 v[8:9], v[8:9], v[16:17]
    v_lshlrev_b32 v16, 16, v65
    v_and_b32 v17, 0xffff0000, v65
    v_pk_add_f32 v[10:11], v[10:11], v[16:17]
    v_lshlrev_b32 v16, 16, v66
    v_and_b32 v17, 0xffff0000, v66
    v_pk_add_f32 v[12:13], v[12:13], v[16:17]
    v_lshlrev_b32 v16, 16, v67
    v_and_b32 v17, 0xffff0000, v67
    v_pk_add_f32 v[14:15], v[14:15], v[16:17]
    s_waitcnt vmcnt(18)
    v_lshlrev_b32 v16, 16, v68
    v_and_b32 v17, 0xffff0000, v68
    v_pk_add_f32 v[8:9], v[8:9], v[16:17]
    v_lshlrev_b32 v16, 16, v69
    v_and_b32 v17, 0xffff0000, v69
    v_pk_add_f32 v[10:11], v[10:11], v[16:17]
    v_lshlrev_b32 v16, 16, v70
    v_and_b32 v17, 0xffff0000, v70
    v_pk_add_f32 v[12:13], v[12:13], v[16:17]
    v_lshlrev_b32 v16, 16, v71
    v_and_b32 v17, 0xffff0000, v71
    v_pk_add_f32 v[14:15], v[14:15], v[16:17]
    s_waitcnt vmcnt(17)
    v_lshlrev_b32 v16, 16, v72
    v_and_b32 v17, 0xffff0000, v72
    v_pk_add_f32 v[8:9], v[8:9], v[16:17]
    v_lshlrev_b32 v16, 16, v73
    v_and_b32 v17, 0xffff0000, v73
    v_pk_add_f32 v[10:11], v[10:11], v[16:17]
    v_lshlrev_b32 v16, 16, v74
    v_and_b32 v17, 0xffff0000, v74
    v_pk_add_f32 v[12:13], v[12:13], v[16:17]
    v_lshlrev_b32 v16, 16, v75
    v_and_b32 v17, 0xffff0000, v75
    v_pk_add_f32 v[14:15], v[14:15], v[16:17]
    s_waitcnt vmcnt(16)
    v_lshlrev_b32 v16, 16, v76
    v_and_b32 v17, 0xffff0000, v76
    v_pk_add_f32 v[8:9], v[8:9], v[16:17]
    v_lshlrev_b32 v16, 16, v77
    v_and_b32 v17, 0xffff0000, v77
    v_pk_add_f32 v[10:11], v[10:11], v[16:17]
    v_lshlrev_b32 v16, 16, v78
    v_and_b32 v17, 0xffff0000, v78
    v_pk_add_f32 v[12:13], v[12:13], v[16:17]
    v_lshlrev_b32 v16, 16, v79
    v_and_b32 v17, 0xffff0000, v79
    v_pk_add_f32 v[14:15], v[14:15], v[16:17]
    s_waitcnt vmcnt(15)
    v_lshlrev_b32 v16, 16, v80
    v_and_b32 v17, 0xffff0000, v80
    v_pk_add_f32 v[8:9], v[8:9], v[16:17]
    v_lshlrev_b32 v16, 16, v81
    v_and_b32 v17, 0xffff0000, v81
    v_pk_add_f32 v[10:11], v[10:11], v[16:17]
    v_lshlrev_b32 v16, 16, v82
    v_and_b32 v17, 0xffff0000, v82
    v_pk_add_f32 v[12:13], v[12:13], v[16:17]
    v_lshlrev_b32 v16, 16, v83
    v_and_b32 v17, 0xffff0000, v83
    v_pk_add_f32 v[14:15], v[14:15], v[16:17]
    s_waitcnt vmcnt(14)
    v_lshlrev_b32 v16, 16, v84
    v_and_b32 v17, 0xffff0000, v84
    v_pk_add_f32 v[8:9], v[8:9], v[16:17]
    v_lshlrev_b32 v16, 16, v85
    v_and_b32 v17, 0xffff0000, v85
    v_pk_add_f32 v[10:11], v[10:11], v[16:17]
    v_lshlrev_b32 v16, 16, v86
    v_and_b32 v17, 0xffff0000, v86
    v_pk_add_f32 v[12:13], v[12:13], v[16:17]
    v_lshlrev_b32 v16, 16, v87
    v_and_b32 v17, 0xffff0000, v87
    v_pk_add_f32 v[14:15], v[14:15], v[16:17]
    s_waitcnt vmcnt(13)
    v_lshlrev_b32 v16, 16, v88
    v_and_b32 v17, 0xffff0000, v88
    v_pk_add_f32 v[8:9], v[8:9], v[16:17]
    v_lshlrev_b32 v16, 16, v89
    v_and_b32 v17, 0xffff0000, v89
    v_pk_add_f32 v[10:11], v[10:11], v[16:17]
    v_lshlrev_b32 v16, 16, v90
    v_and_b32 v17, 0xffff0000, v90
    v_pk_add_f32 v[12:13], v[12:13], v[16:17]
    v_lshlrev_b32 v16, 16, v91
    v_and_b32 v17, 0xffff0000, v91
    v_pk_add_f32 v[14:15], v[14:15], v[16:17]
    s_waitcnt vmcnt(12)
    v_lshlrev_b32 v16, 16, v92
    v_and_b32 v17, 0xffff0000, v92
    v_pk_add_f32 v[8:9], v[8:9], v[16:17]
    v_lshlrev_b32 v16, 16, v93
    v_and_b32 v17, 0xffff0000, v93
    v_pk_add_f32 v[10:11], v[10:11], v[16:17]
    v_lshlrev_b32 v16, 16, v94
    v_and_b32 v17, 0xffff0000, v94
    v_pk_add_f32 v[12:13], v[12:13], v[16:17]
    v_lshlrev_b32 v16, 16, v95
    v_and_b32 v17, 0xffff0000, v95
    v_pk_add_f32 v[14:15], v[14:15], v[16:17]
    s_waitcnt vmcnt(11)
    v_lshlrev_b32 v16, 16, v96
    v_and_b32 v17, 0xffff0000, v96
    v_pk_add_f32 v[8:9], v[8:9], v[16:17]
    v_lshlrev_b32 v16, 16, v97
    v_and_b32 v17, 0xffff0000, v97
    v_pk_add_f32 v[10:11], v[10:11], v[16:17]
    v_lshlrev_b32 v16, 16, v98
    v_and_b32 v17, 0xffff0000, v98
    v_pk_add_f32 v[12:13], v[12:13], v[16:17]
    v_lshlrev_b32 v16, 16, v99
    v_and_b32 v17, 0xffff0000, v99
    v_pk_add_f32 v[14:15], v[14:15], v[16:17]
    s_waitcnt vmcnt(10)
    v_lshlrev_b32 v16, 16, v100
    v_and_b32 v17, 0xffff0000, v100
    v_pk_add_f32 v[8:9], v[8:9], v[16:17]
    v_lshlrev_b32 v16, 16, v101
    v_and_b32 v17, 0xffff0000, v101
    v_pk_add_f32 v[10:11], v[10:11], v[16:17]
    v_lshlrev_b32 v16, 16, v102
    v_and_b32 v17, 0xffff0000, v102
    v_pk_add_f32 v[12:13], v[12:13], v[16:17]
    v_lshlrev_b32 v16, 16, v103
    v_and_b32 v17, 0xffff0000, v103
    v_pk_add_f32 v[14:15], v[14:15], v[16:17]
    s_waitcnt vmcnt(9)
    v_lshlrev_b32 v16, 16, v104
    v_and_b32 v17, 0xffff0000, v104
    v_pk_add_f32 v[8:9], v[8:9], v[16:17]
    v_lshlrev_b32 v16, 16, v105
    v_and_b32 v17, 0xffff0000, v105
    v_pk_add_f32 v[10:11], v[10:11], v[16:17]
    v_lshlrev_b32 v16, 16, v106
    v_and_b32 v17, 0xffff0000, v106
    v_pk_add_f32 v[12:13], v[12:13], v[16:17]
    v_lshlrev_b32 v16, 16, v107
    v_and_b32 v17, 0xffff0000, v107
    v_pk_add_f32 v[14:15], v[14:15], v[16:17]
    s_waitcnt vmcnt(8)
    v_lshlrev_b32 v16, 16, v108
    v_and_b32 v17, 0xffff0000, v108
    v_pk_add_f32 v[8:9], v[8:9], v[16:17]
    v_lshlrev_b32 v16, 16, v109
    v_and_b32 v17, 0xffff0000, v109
    v_pk_add_f32 v[10:11], v[10:11], v[16:17]
    v_lshlrev_b32 v16, 16, v110
    v_and_b32 v17, 0xffff0000, v110
    v_pk_add_f32 v[12:13], v[12:13], v[16:17]
    v_lshlrev_b32 v16, 16, v111
    v_and_b32 v17, 0xffff0000, v111
    v_pk_add_f32 v[14:15], v[14:15], v[16:17]
    s_waitcnt vmcnt(7)
    v_lshlrev_b32 v16, 16, v112
    v_and_b32 v17, 0xffff0000, v112
    v_pk_add_f32 v[8:9], v[8:9], v[16:17]
    v_lshlrev_b32 v16, 16, v113
    v_and_b32 v17, 0xffff0000, v113
    v_pk_add_f32 v[10:11], v[10:11], v[16:17]
    v_lshlrev_b32 v16, 16, v114
    v_and_b32 v17, 0xffff0000, v114
    v_pk_add_f32 v[12:13], v[12:13], v[16:17]
    v_lshlrev_b32 v16, 16, v115
    v_and_b32 v17, 0xffff0000, v115
    v_pk_add_f32 v[14:15], v[14:15], v[16:17]
    s_waitcnt vmcnt(6)
    v_lshlrev_b32 v16, 16, v116
    v_and_b32 v17, 0xffff0000, v116
    v_pk_add_f32 v[8:9], v[8:9], v[16:17]
    v_lshlrev_b32 v16, 16, v117
    v_and_b32 v17, 0xffff0000, v117
    v_pk_add_f32 v[10:11], v[10:11], v[16:17]
    v_lshlrev_b32 v16, 16, v118
    v_and_b32 v17, 0xffff0000, v118
    v_pk_add_f32 v[12:13], v[12:13], v[16:17]
    v_lshlrev_b32 v16, 16, v119
    v_and_b32 v17, 0xffff0000, v119
    v_pk_add_f32 v[14:15], v[14:15], v[16:17]
    s_waitcnt vmcnt(5)
    v_lshlrev_b32 v16, 16, v120
    v_and_b32 v17, 0xffff0000, v120
    v_pk_add_f32 v[8:9], v[8:9], v[16:17]
    v_lshlrev_b32 v16, 16, v121
    v_and_b32 v17, 0xffff0000, v121
    v_pk_add_f32 v[10:11], v[10:11], v[16:17]
    v_lshlrev_b32 v16, 16, v122
    v_and_b32 v17, 0xffff0000, v122
    v_pk_add_f32 v[12:13], v[12:13], v[16:17]
    v_lshlrev_b32 v16, 16, v123
    v_and_b32 v17, 0xffff0000, v123
    v_pk_add_f32 v[14:15], v[14:15], v[16:17]
    s_waitcnt vmcnt(4)
    v_lshlrev_b32 v16, 16, v124
    v_and_b32 v17, 0xffff0000, v124
    v_pk_add_f32 v[8:9], v[8:9], v[16:17]
    v_lshlrev_b32 v16, 16, v125
    v_and_b32 v17, 0xffff0000, v125
    v_pk_add_f32 v[10:11], v[10:11], v[16:17]
    v_lshlrev_b32 v16, 16, v126
    v_and_b32 v17, 0xffff0000, v126
    v_pk_add_f32 v[12:13], v[12:13], v[16:17]
    v_lshlrev_b32 v16, 16, v127
    v_and_b32 v17, 0xffff0000, v127
    v_pk_add_f32 v[14:15], v[14:15], v[16:17]
    s_waitcnt vmcnt(3)
    v_lshlrev_b32 v16, 16, v128
    v_and_b32 v17, 0xffff0000, v128
    v_pk_add_f32 v[8:9], v[8:9], v[16:17]
    v_lshlrev_b32 v16, 16, v129
    v_and_b32 v17, 0xffff0000, v129
    v_pk_add_f32 v[10:11], v[10:11], v[16:17]
    v_lshlrev_b32 v16, 16, v130
    v_and_b32 v17, 0xffff0000, v130
    v_pk_add_f32 v[12:13], v[12:13], v[16:17]
    v_lshlrev_b32 v16, 16, v131
    v_and_b32 v17, 0xffff0000, v131
    v_pk_add_f32 v[14:15], v[14:15], v[16:17]
    s_waitcnt vmcnt(2)
    v_lshlrev_b32 v16, 16, v132
    v_and_b32 v17, 0xffff0000, v132
    v_pk_add_f32 v[8:9], v[8:9], v[16:17]
    v_lshlrev_b32 v16, 16, v133
    v_and_b32 v17, 0xffff0000, v133
    v_pk_add_f32 v[10:11], v[10:11], v[16:17]
    v_lshlrev_b32 v16, 16, v134
    v_and_b32 v17, 0xffff0000, v134
    v_pk_add_f32 v[12:13], v[12:13], v[16:17]
    v_lshlrev_b32 v16, 16, v135
    v_and_b32 v17, 0xffff0000, v135
    v_pk_add_f32 v[14:15], v[14:15], v[16:17]
    s_waitcnt vmcnt(1)
    v_lshlrev_b32 v16, 16, v136
    v_and_b32 v17, 0xffff0000, v136
    v_pk_add_f32 v[8:9], v[8:9], v[16:17]
    v_lshlrev_b32 v16, 16, v137
    v_and_b32 v17, 0xffff0000, v137
    v_pk_add_f32 v[10:11], v[10:11], v[16:17]
    v_lshlrev_b32 v16, 16, v138
    v_and_b32 v17, 0xffff0000, v138
    v_pk_add_f32 v[12:13], v[12:13], v[16:17]
    v_lshlrev_b32 v16, 16, v139
    v_and_b32 v17, 0xffff0000, v139
    v_pk_add_f32 v[14:15], v[14:15], v[16:17]
    s_waitcnt vmcnt(0)
    v_lshlrev_b32 v16, 16, v140
    v_and_b32 v17, 0xffff0000, v140
    v_pk_add_f32 v[8:9], v[8:9], v[16:17]
    v_lshlrev_b32 v16, 16, v141
    v_and_b32 v17, 0xffff0000, v141
    v_pk_add_f32 v[10:11], v[10:11], v[16:17]
    v_lshlrev_b32 v16, 16, v142
    v_and_b32 v17, 0xffff0000, v142
    v_pk_add_f32 v[12:13], v[12:13], v[16:17]
    v_lshlrev_b32 v16, 16, v143
    v_and_b32 v17, 0xffff0000, v143
    v_pk_add_f32 v[14:15], v[14:15], v[16:17]
    s_nop 0
    v_add_f32_dpp v8, v8, v8 row_ror:8 row_mask:0xf bank_mask:0xf
    v_add_f32_dpp v9, v9, v9 row_ror:8 row_mask:0xf bank_mask:0xf
    v_add_f32_dpp v10, v10, v10 row_ror:8 row_mask:0xf bank_mask:0xf
    v_add_f32_dpp v11, v11, v11 row_ror:8 row_mask:0xf bank_mask:0xf
    v_add_f32_dpp v12, v12, v12 row_ror:8 row_mask:0xf bank_mask:0xf
    v_add_f32_dpp v13, v13, v13 row_ror:8 row_mask:0xf bank_mask:0xf
    v_add_f32_dpp v14, v14, v14 row_ror:8 row_mask:0xf bank_mask:0xf
    v_add_f32_dpp v15, v15, v15 row_ror:8 row_mask:0xf bank_mask:0xf
    v_mov_b32 v16, v8
    v_mov_b32 v17, v9
    v_mov_b32 v18, v10
    v_mov_b32 v19, v11
    v_mov_b32 v20, v12
    v_mov_b32 v21, v13
    v_mov_b32 v22, v14
    v_mov_b32 v23, v15
    s_nop 0
    v_permlane16_swap_b32 v16, v8
    v_permlane16_swap_b32 v17, v9
    v_permlane16_swap_b32 v18, v10
    v_permlane16_swap_b32 v19, v11
    v_permlane16_swap_b32 v20, v12
    v_permlane16_swap_b32 v21, v13
    v_permlane16_swap_b32 v22, v14
    v_permlane16_swap_b32 v23, v15
    s_nop 0
    v_add_f32 v8, v8, v16
    v_add_f32 v9, v9, v17
    v_add_f32 v10, v10, v18
    v_add_f32 v11, v11, v19
    v_add_f32 v12, v12, v20
    v_add_f32 v13, v13, v21
    v_add_f32 v14, v14, v22
    v_add_f32 v15, v15, v23
    v_mov_b32 v16, v8
    v_mov_b32 v17, v9
    v_mov_b32 v18, v10
    v_mov_b32 v19, v11
    v_mov_b32 v20, v12
    v_mov_b32 v21, v13
    v_mov_b32 v22, v14
    v_mov_b32 v23, v15
    s_nop 0
    v_permlane32_swap_b32 v16, v8
    v_permlane32_swap_b32 v17, v9
    v_permlane32_swap_b32 v18, v10
    v_permlane32_swap_b32 v19, v11
    v_permlane32_swap_b32 v20, v12
    v_permlane32_swap_b32 v21, v13
    v_permlane32_swap_b32 v22, v14
    v_permlane32_swap_b32 v23, v15
    s_nop 0
    v_add_f32 v8, v8, v16
    v_add_f32 v9, v9, v17
    v_add_f32 v10, v10, v18
    v_add_f32 v11, v11, v19
    v_add_f32 v12, v12, v20
    v_add_f32 v13, v13, v21
    v_add_f32 v14, v14, v22
    v_add_f32 v15, v15, v23
    v_lshlrev_b32 v4, 5, v1
    s_lshl_b32 s13, s3, 8
    s_add_u32 s13, s13, 161792
    v_add_u32 v4, s13, v4
    s_mov_b64 exec, 0xff
    ds_write_b128 v4, v[8:11]
    ds_write_b128 v4, v[12:15] offset:16
    s_mov_b64 exec, -1
    s_waitcnt lgkmcnt(0)
    s_mov_b64 exec, 1
    v_mov_b32 v4, 158740
    v_mov_b32 v5, 1
    ds_add_rtn_u32 v5, v4, v5
    s_waitcnt lgkmcnt(0)
    v_readfirstlane_b32 s13, v5
    s_mov_b64 exec, -1
    s_cmp_lg_u32 s13, 3
    s_cbranch_scc1 L_NC5
    v_lshlrev_b32 v4, 2, v1
    v_add_u32 v5, 161792, v4
    ds_read_b32 v8, v5 offset:0
    ds_read_b32 v9, v5 offset:256
    ds_read_b32 v10, v5 offset:512
    ds_read_b32 v11, v5 offset:768
    s_waitcnt lgkmcnt(0)
    v_add_f32 v8, v8, v9
    v_add_f32 v8, v8, v10
    v_add_f32 v8, v8, v11
    s_lshl_b32 s13, s12, 8
    s_add_u32 s13, s13, 0x8000
    buffer_store_dword v8, v4, s[8:11], s13 offen sc1
    s_waitcnt vmcnt(0)
    s_mov_b64 exec, 1
    v_mov_b32 v4, 158744
    v_mov_b32 v5, 1
    ds_add_u32 v4, v5
    s_mov_b64 exec, -1
L_NC5:
    s_branch L_PHASE_B
L_NC_LD:
    s_cmp_lg_u32 s3, 7
    s_cbranch_scc1 L_NC_L3
    s_mov_b32 s46, 128
    s_mov_b64 s[68:69], exec
    s_mov_b32 exec_lo, 0x1
    s_mov_b32 exec_hi, 0x0
    v_lshlrev_b32 v12, 2, v1
    s_mov_b32 s47, 0
POLL_7:
    buffer_load_dword v8, v12, s[56:59], s46 offen sc1
    s_waitcnt vmcnt(0)
    v_cmp_ne_u32 vcc, 0, v8
    s_cmp_eq_u64 vcc, exec
    s_cbranch_scc1 POLLD_8
    s_sleep 2
    s_add_u32 s47, s47, 1
    s_cmp_lt_u32 s47, 262144
    s_cbranch_scc1 POLL_7
POLLD_8:
    s_mov_b64 exec, s[68:69]
    s_mov_b64 exec, 1
    v_mov_b32 v8, 158784
    v_mov_b32 v9, 1
    ds_add_u32 v8, v9
    s_mov_b64 exec, -1
    s_mov_b64 s[68:69], exec
    s_mov_b64 exec, 1
    s_lshl_b32 s13, s64, 7
    s_add_u32 s13, s13, 0x20000
    v_mov_b32 v4, 0
    v_mov_b32 v5, 1
    buffer_atomic_add v5, v4, s[8:11], s13 offen sc1
    s_mov_b64 exec, s[68:69]
L_NC_L3:
    s_mul_i32 s46, s67, 224
    s_mov_b32 s47, 74899
    v_add_u32 v4, 0, v1
    v_mul_lo_u32 v5, v4, s47
    v_lshrrev_b32 v5, 20, v5
    v_mul_u32_u24 v6, 14, v5
    v_sub_u32 v6, v4, v6
    v_mul_u32_u24 v5, 3456, v5
    v_lshl_add_u32 v5, v6, 4, v5
    v_add_u32 v240, s46, v5
    v_add_u32 v4, 64, v1
    v_mul_lo_u32 v5, v4, s47
    v_lshrrev_b32 v5, 20, v5
    v_mul_u32_u24 v6, 14, v5
    v_sub_u32 v6, v4, v6
    v_mul_u32_u24 v5, 3456, v5
    v_lshl_add_u32 v5, v6, 4, v5
    v_add_u32 v241, s46, v5
    v_add_u32 v4, 128, v1
    v_mul_lo_u32 v5, v4, s47
    v_lshrrev_b32 v5, 20, v5
    v_mul_u32_u24 v6, 14, v5
    v_sub_u32 v6, v4, v6
    v_mul_u32_u24 v5, 3456, v5
    v_lshl_add_u32 v5, v6, 4, v5
    v_add_u32 v242, s46, v5
    v_add_u32 v4, 192, v1
    v_mul_lo_u32 v5, v4, s47
    v_lshrrev_b32 v5, 20, v5
    v_mul_u32_u24 v6, 14, v5
    v_sub_u32 v6, v4, v6
    v_mul_u32_u24 v5, 3456, v5
    v_lshl_add_u32 v5, v6, 4, v5
    v_add_u32 v243, s46, v5
    v_add_u32 v4, 256, v1
    v_mul_lo_u32 v5, v4, s47
    v_lshrrev_b32 v5, 20, v5
    v_mul_u32_u24 v6, 14, v5
    v_sub_u32 v6, v4, v6
    v_mul_u32_u24 v5, 3456, v5
    v_lshl_add_u32 v5, v6, 4, v5
    v_add_u32 v244, s46, v5
    v_add_u32 v4, 320, v1
    v_mul_lo_u32 v5, v4, s47
    v_lshrrev_b32 v5, 20, v5
    v_mul_u32_u24 v6, 14, v5
    v_sub_u32 v6, v4, v6
    v_mul_u32_u24 v5, 3456, v5
    v_lshl_add_u32 v5, v6, 4, v5
    v_add_u32 v245, s46, v5
    v_add_u32 v4, 384, v1
    v_mul_lo_u32 v5, v4, s47
    v_lshrrev_b32 v5, 20, v5
    v_mul_u32_u24 v6, 14, v5
    v_sub_u32 v6, v4, v6
    v_mul_u32_u24 v5, 3456, v5
    v_lshl_add_u32 v5, v6, 4, v5
    v_add_u32 v246, s46, v5
    s_and_b32 s46, s3, 3
    s_add_u32 s46, s46, 0
    s_mul_i32 s47, s46, 110592
    s_mul_i32 s46, s46, 7168
    s_add_u32 m0, s46, 0
    s_nop 0
    buffer_load_dwordx4 v240, s[48:51], s47 offen lds
    s_add_u32 m0, s46, 1024
    s_nop 0
    buffer_load_dwordx4 v241, s[48:51], s47 offen lds
    s_add_u32 m0, s46, 2048
    s_nop 0
    buffer_load_dwordx4 v242, s[48:51], s47 offen lds
    s_add_u32 m0, s46, 3072
    s_nop 0
    buffer_load_dwordx4 v243, s[48:51], s47 offen lds
    s_add_u32 m0, s46, 4096
    s_nop 0
    buffer_load_dwordx4 v244, s[48:51], s47 offen lds
    s_add_u32 m0, s46, 5120
    s_nop 0
    buffer_load_dwordx4 v245, s[48:51], s47 offen lds
    s_add_u32 m0, s46, 6144
    s_nop 0
    buffer_load_dwordx4 v246, s[48:51], s47 offen lds
    s_and_b32 s46, s3, 3
    s_add_u32 s46, s46, 4
    s_mul_i32 s47, s46, 110592
    s_mul_i32 s46, s46, 7168
    s_add_u32 m0, s46, 0
    s_nop 0
    buffer_load_dwordx4 v240, s[48:51], s47 offen lds
    s_add_u32 m0, s46, 1024
    s_nop 0
    buffer_load_dwordx4 v241, s[48:51], s47 offen lds
    s_add_u32 m0, s46, 2048
    s_nop 0
    buffer_load_dwordx4 v242, s[48:51], s47 offen lds
    s_add_u32 m0, s46, 3072
    s_nop 0
    buffer_load_dwordx4 v243, s[48:51], s47 offen lds
    s_add_u32 m0, s46, 4096
    s_nop 0
    buffer_load_dwordx4 v244, s[48:51], s47 offen lds
    s_add_u32 m0, s46, 5120
    s_nop 0
    buffer_load_dwordx4 v245, s[48:51], s47 offen lds
    s_add_u32 m0, s46, 6144
    s_nop 0
    buffer_load_dwordx4 v246, s[48:51], s47 offen lds
    s_and_b32 s46, s3, 3
    s_add_u32 s46, s46, 8
    s_mul_i32 s47, s46, 110592
    s_mul_i32 s46, s46, 7168
    s_add_u32 m0, s46, 0
    s_nop 0
    buffer_load_dwordx4 v240, s[48:51], s47 offen lds
    s_add_u32 m0, s46, 1024
    s_nop 0
    buffer_load_dwordx4 v241, s[48:51], s47 offen lds
    s_add_u32 m0, s46, 2048
    s_nop 0
    buffer_load_dwordx4 v242, s[48:51], s47 offen lds
    s_add_u32 m0, s46, 3072
    s_nop 0
    buffer_load_dwordx4 v243, s[48:51], s47 offen lds
    s_add_u32 m0, s46, 4096
    s_nop 0
    buffer_load_dwordx4 v244, s[48:51], s47 offen lds
    s_add_u32 m0, s46, 5120
    s_nop 0
    buffer_load_dwordx4 v245, s[48:51], s47 offen lds
    s_add_u32 m0, s46, 6144
    s_nop 0
    buffer_load_dwordx4 v246, s[48:51], s47 offen lds
    s_and_b32 s46, s3, 3
    s_add_u32 s46, s46, 12
    s_mul_i32 s47, s46, 110592
    s_mul_i32 s46, s46, 7168
    s_add_u32 m0, s46, 0
    s_nop 0
    buffer_load_dwordx4 v240, s[48:51], s47 offen lds
    s_add_u32 m0, s46, 1024
    s_nop 0
    buffer_load_dwordx4 v241, s[48:51], s47 offen lds
    s_add_u32 m0, s46, 2048
    s_nop 0
    buffer_load_dwordx4 v242, s[48:51], s47 offen lds
    s_add_u32 m0, s46, 3072
    s_nop 0
    buffer_load_dwordx4 v243, s[48:51], s47 offen lds
    s_add_u32 m0, s46, 4096
    s_nop 0
    buffer_load_dwordx4 v244, s[48:51], s47 offen lds
    s_add_u32 m0, s46, 5120
    s_nop 0
    buffer_load_dwordx4 v245, s[48:51], s47 offen lds
    s_add_u32 m0, s46, 6144
    s_nop 0
    buffer_load_dwordx4 v246, s[48:51], s47 offen lds
    v_mov_b32 v4, 158728
LW_9:
    ds_read_b32 v5, v4
    s_waitcnt lgkmcnt(0)
    v_readfirstlane_b32 s13, v5
    s_cmp_ge_u32 s13, 4
    s_cbranch_scc1 LWD_10
    s_sleep 4
    s_branch LW_9
LWD_10:
    s_and_b32 s46, s3, 3
    s_add_u32 s46, s46, 16
    s_mul_i32 s47, s46, 110592
    s_mul_i32 s46, s46, 7168
    s_add_u32 m0, s46, 0
    s_nop 0
    buffer_load_dwordx4 v240, s[48:51], s47 offen lds
    s_add_u32 m0, s46, 1024
    s_nop 0
    buffer_load_dwordx4 v241, s[48:51], s47 offen lds
    s_add_u32 m0, s46, 2048
    s_nop 0
    buffer_load_dwordx4 v242, s[48:51], s47 offen lds
    s_add_u32 m0, s46, 3072
    s_nop 0
    buffer_load_dwordx4 v243, s[48:51], s47 offen lds
    s_add_u32 m0, s46, 4096
    s_nop 0
    buffer_load_dwordx4 v244, s[48:51], s47 offen lds
    s_add_u32 m0, s46, 5120
    s_nop 0
    buffer_load_dwordx4 v245, s[48:51], s47 offen lds
    s_add_u32 m0, s46, 6144
    s_nop 0
    buffer_load_dwordx4 v246, s[48:51], s47 offen lds
    v_lshlrev_b32 v252, 4, v1
    v_mov_b32 v248, -1
    v_mov_b32 v249, -1
    v_mov_b32 v250, -1
    v_mov_b32 v251, -1
    s_lshl_b32 s27, s66, 3
    s_and_b32 s28, s3, 3
    s_lshl_b32 s28, s28, 1
    s_add_u32 s27, s27, s28
    s_lshl_b32 s27, s27, 10
    s_add_u32 s27, s27, 0x400000
    s_mul_i32 s28, s67, 7
    s_lshr_b32 s28, s28, 1
    s_lshl_b32 s28, s28, 17
    s_add_u32 s29, s27, s28
    s_bitcmp1_b32 s67, 0
    s_cbranch_scc1 HPS_11
    buffer_store_dwordx4 v[248:251], v252, s[8:11], s29 offen offset:0 sc1
    buffer_store_dwordx4 v[248:251], v252, s[8:11], s29 offen offset:1024 sc1
HPS_11:
    s_add_u32 s29, s29, 131072
    buffer_store_dwordx4 v[248:251], v252, s[8:11], s29 offen offset:0 sc1
    buffer_store_dwordx4 v[248:251], v252, s[8:11], s29 offen offset:1024 sc1
    s_add_u32 s29, s29, 131072
    buffer_store_dwordx4 v[248:251], v252, s[8:11], s29 offen offset:0 sc1
    buffer_store_dwordx4 v[248:251], v252, s[8:11], s29 offen offset:1024 sc1
    s_add_u32 s29, s29, 131072
    buffer_store_dwordx4 v[248:251], v252, s[8:11], s29 offen offset:0 sc1
    buffer_store_dwordx4 v[248:251], v252, s[8:11], s29 offen offset:1024 sc1
    s_waitcnt vmcnt(0)
    v_mov_b32 v4, 158784
LW_12:
    ds_read_b32 v5, v4
    s_waitcnt lgkmcnt(0)
    v_readfirstlane_b32 s13, v5
    s_cmp_ge_u32 s13, 1
    s_cbranch_scc1 LWD_13
    s_sleep 4
    s_branch LW_12
LWD_13:
    s_cmp_lt_u32 s65, 28
    s_cbranch_scc1 L_NC_L4
    s_sub_u32 s46, s65, 28
    s_lshl_b32 s46, s46, 3
    s_add_u32 s46, s46, s64
    s_cmp_ge_u32 s46, 27
    s_cbranch_scc1 L_NC_L4
    v_mov_b32 v4, 158744
LW_14:
    ds_read_b32 v5, v4
    s_waitcnt lgkmcnt(0)
    v_readfirstlane_b32 s13, v5
    s_cmp_ge_u32 s13, 1
    s_cbranch_scc1 LWD_15
    s_sleep 4
    s_branch LW_14
LWD_15:
L_NC_L4:
    s_mov_b64 exec, 1
    v_mov_b32 v248, 158732
    v_mov_b32 v249, 1
    ds_add_rtn_u32 v249, v248, v249
    s_waitcnt lgkmcnt(0)
    v_readfirstlane_b32 s13, v249
    s_mov_b64 exec, -1
    s_cmp_lg_u32 s13, 3
    s_cbranch_scc1 L_PHASE_B
    s_mov_b64 s[68:69], exec
    s_mov_b64 exec, 1
    s_lshl_b32 s13, s64, 7
    s_add_u32 s13, s13, 0x20400
    v_mov_b32 v248, 0
    v_mov_b32 v249, 1
    buffer_atomic_add v249, v248, s[8:11], s13 offen sc1
    s_mov_b64 exec, s[68:69]
    s_branch L_PHASE_B
L_CONV:
    s_mul_i32 s12, s64, 20
    s_add_u32 s12, s12, s65
    s_sub_u32 s12, s12, 8
    s_lshl_b32 s13, s12, 2
    s_and_b32 s14, s3, 3
    s_add_u32 s15, s13, s14
    s_lshr_b32 s6, s3, 2
    s_lshl_b32 s46, s6, 6
    v_add_u32 v4, s46, v1
    s_lshl_b32 s47, s15, 8
    v_lshl_add_u32 v5, v4, 1, s47
    s_lshr_b32 s46, s15, 1
    s_lshl_b32 s46, s46, 2
    s_waitcnt lgkmcnt(0)
    global_load_ushort v10, v5, s[18:19]
    global_load_ushort v11, v5, s[20:21]
    global_load_ushort v12, v5, s[22:23]
    global_load_ushort v13, v5, s[24:25]
    s_load_dword s4, s[26:27], s46
    s_load_dword s5, s[28:29], s46
    v_mov_b32 v250, v4
    s_mov_b32 s8, s34
    s_mov_b32 s9, s35
    s_mov_b32 s10, 0x10000000
    s_mov_b32 s11, 0x00020000
    s_mov_b32 s48, s36
    s_mov_b32 s49, s37
    s_mov_b32 s50, 0x21c000
    s_mov_b32 s51, 0x00020000
    s_mov_b32 s52, s40
    s_mov_b32 s53, s41
    s_mov_b32 s54, 0x21c000
    s_mov_b32 s55, 0x00020000
    s_mov_b32 s56, s32
    s_mov_b32 s57, s33
    s_mov_b32 s58, 0x100
    s_mov_b32 s59, 0x00020000
    s_cmp_lg_u32 s3, 7
    s_cbranch_scc1 NOST2_16
    s_mov_b64 s[68:69], exec
    s_mov_b64 exec, 0xf
    v_mov_b32 v4, -1
    v_mov_b32 v5, -1
    v_mov_b32 v6, -1
    v_mov_b32 v7, -1
    v_lshlrev_b32 v8, 4, v1
    s_lshl_b32 s13, s66, 10
    s_lshl_b32 s46, s67, 6
    s_add_u32 s13, s13, s46
    s_add_u32 s13, s13, 0x10000
    buffer_store_dwordx4 v[4:7], v8, s[8:11], s13 offen sc1
    s_mov_b64 exec, s[68:69]
    s_nop 1
NOST2_16:
    v_mov_b32 v4, v250
    s_lshl_b32 s13, s12, 2
    s_cmp_lt_u32 s3, 4
    s_cbranch_scc1 L_CV_PH
    v_subrev_u32 v6, 256, v0
    v_mul_u32_u24 v6, 10240, v6
    s_lshl_b32 s46, s13, 1
    v_add_u32 v6, s46, v6
    v_add_u32 v7, 5120, v6
    global_load_dwordx2 v[100:101], v6, s[16:17] offset:0
    global_load_dwordx2 v[102:103], v6, s[16:17] offset:1280
    global_load_dwordx2 v[104:105], v6, s[16:17] offset:2560
    global_load_dwordx2 v[106:107], v6, s[16:17] offset:3840
    s_branch L_CV_NOX
L_CV_PH:
    v_mov_b32 v60, -1
    v_mov_b32 v61, -1
    v_mov_b32 v62, -1
    v_mov_b32 v63, -1
    v_lshlrev_b32 v6, 4, v0
    s_lshl_b32 s46, s12, 14
    s_add_u32 s46, s46, 0x100000
    buffer_store_dwordx4 v[60:63], v6, s[8:11], s46 offen sc1
    s_add_u32 s46, s46, 4096
    buffer_store_dwordx4 v[60:63], v6, s[8:11], s46 offen sc1
    s_add_u32 s46, s46, 4096
    buffer_store_dwordx4 v[60:63], v6, s[8:11], s46 offen sc1
    s_add_u32 s46, s46, 4096
    buffer_store_dwordx4 v[60:63], v6, s[8:11], s46 offen sc1
L_CV_NOX:
    s_mul_i32 s46, s14, 34272
    v_lshl_add_u32 v5, v4, 2, s46
    s_waitcnt lgkmcnt(0)
    s_and_b32 s46, s15, 1
    s_lshl_b32 s46, s46, 4
    s_lshr_b32 s4, s4, s46
    s_lshl_b32 s4, s4, 16
    s_lshr_b32 s5, s5, s46
    s_lshl_b32 s5, s5, 16
    v_mov_b32 v14, s4
    v_mul_f32 v14, 0x3fb8aa3b, v14
    v_exp_f32 v14, v14
    s_nop 0
    v_cvt_pk_bf16_f32 v14, v14, v14
    v_lshlrev_b32 v14, 16, v14
    s_cmp_lt_u32 s3, 4
    s_cbranch_scc1 L_CV_W0
    s_waitcnt vmcnt(4)
    s_branch L_CV_W1
L_CV_W0:
    s_waitcnt vmcnt(4)
L_CV_W1:
    v_lshlrev_b32 v10, 16, v10
    v_lshlrev_b32 v11, 16, v11
    v_lshlrev_b32 v12, 16, v12
    v_lshlrev_b32 v13, 16, v13
    v_mul_f32 v10, 0x3fb8aa3b, v10
    v_exp_f32 v10, v10
    s_nop 0
    v_cvt_pk_bf16_f32 v10, v10, v10
    v_lshlrev_b32 v10, 16, v10
    v_mul_f32 v10, v10, v14
    v_mul_f32 v10, 0xbfb8aa3b, v10
    v_mul_f32 v11, v11, v14
    v_mul_f32 v11, 0.15915494, v11
    v_mul_f32 v12, v12, v14
    v_mul_f32 v13, v13, v14
    v_add_f32 v32, v12, v12
    v_add_f32 v33, v13, v13
    v_mul_f32 v20, 0x3f800000, v10
    v_mul_f32 v21, 0x3f800000, v11
    v_mul_f32 v22, 0x41800000, v10
    v_mul_f32 v23, 0x41800000, v11
    v_mul_f32 v24, 0x43800000, v10
    v_mul_f32 v25, 0x43800000, v11
    v_mul_f32 v26, 0x40000000, v10
    v_mul_f32 v27, 0x40000000, v11
    v_mul_f32 v28, 0x40800000, v10
    v_mul_f32 v29, 0x40800000, v11
    v_mul_f32 v30, 0x41000000, v10
    v_mul_f32 v31, 0x41000000, v11
    v_exp_f32 v20, v20
    v_fract_f32 v21, v21
    v_exp_f32 v22, v22
    v_fract_f32 v23, v23
    v_exp_f32 v24, v24
    v_fract_f32 v25, v25
    v_exp_f32 v26, v26
    v_fract_f32 v27, v27
    v_exp_f32 v28, v28
    v_fract_f32 v29, v29
    v_exp_f32 v30, v30
    v_fract_f32 v31, v31
    v_cos_f32 v52, v21
    v_sin_f32 v21, v21
    v_cos_f32 v53, v23
    v_sin_f32 v23, v23
    v_cos_f32 v54, v25
    v_sin_f32 v25, v25
    v_cos_f32 v55, v27
    v_sin_f32 v27, v27
    v_cos_f32 v56, v29
    v_sin_f32 v29, v29
    v_cos_f32 v57, v31
    v_sin_f32 v31, v31
    s_nop 0
    v_mul_f32 v21, v20, v21
    v_mul_f32 v20, v20, v52
    v_mul_f32 v23, v22, v23
    v_mul_f32 v22, v22, v53
    v_mul_f32 v25, v24, v25
    v_mul_f32 v24, v24, v54
    v_mul_f32 v27, v26, v27
    v_mul_f32 v26, v26, v55
    v_mul_f32 v29, v28, v29
    v_mul_f32 v28, v28, v56
    v_mul_f32 v31, v30, v31
    v_mul_f32 v30, v30, v57
    v_mov_b32 v34, 1.0
    v_mov_b32 v35, 0
    v_mov_b32 v36, v32
    v_mov_b32 v37, v33
    v_cvt_pk_bf16_f32 v72, v32, -v33
    v_cvt_pk_bf16_f32 v73, v34, v35
    v_pk_mul_f32 v[52:53], v[36:37], v[24:25] op_sel:[0,0] op_sel_hi:[1,0]
    v_pk_mul_f32 v[54:55], v[32:33], v[20:21] op_sel:[0,0] op_sel_hi:[1,0]
    v_pk_mul_f32 v[56:57], v[34:35], v[22:23] op_sel:[0,0] op_sel_hi:[1,0]
    ds_write_b32 v5, v72 offset:0
    ds_write_b32 v5, v73 offset:25568
    v_pk_fma_f32 v[38:39], v[36:37], v[24:25], v[52:53] op_sel:[1,1,0] op_sel_hi:[0,1,1] neg_lo:[0,1,0]
    v_pk_fma_f32 v[32:33], v[32:33], v[20:21], v[54:55] op_sel:[1,1,0] op_sel_hi:[0,1,1] neg_lo:[0,1,0]
    v_pk_fma_f32 v[34:35], v[34:35], v[22:23], v[56:57] op_sel:[1,1,0] op_sel_hi:[0,1,1] neg_lo:[0,1,0]
    s_cmp_lt_u32 s3, 4
    s_cbranch_scc1 XG_17
    global_load_dwordx2 v[108:109], v7, s[16:17] offset:0
XG_17:
    v_cvt_pk_bf16_f32 v74, v32, -v33
    v_cvt_pk_bf16_f32 v75, v34, v35
    v_cvt_pk_bf16_f32 v76, v38, -v39
    v_pk_mul_f32 v[52:53], v[38:39], v[24:25] op_sel:[0,0] op_sel_hi:[1,0]
    v_pk_mul_f32 v[54:55], v[32:33], v[20:21] op_sel:[0,0] op_sel_hi:[1,0]
    v_pk_mul_f32 v[56:57], v[34:35], v[22:23] op_sel:[0,0] op_sel_hi:[1,0]
    v_pk_mul_f32 v[58:59], v[38:39], v[26:27] op_sel:[0,0] op_sel_hi:[1,0]
    ds_write_b32 v5, v74 offset:544
    ds_write_b32 v5, v75 offset:26112
    ds_write_b32 v5, v76 offset:8704
    v_pk_fma_f32 v[40:41], v[38:39], v[24:25], v[52:53] op_sel:[1,1,0] op_sel_hi:[0,1,1] neg_lo:[0,1,0]
    v_pk_fma_f32 v[32:33], v[32:33], v[20:21], v[54:55] op_sel:[1,1,0] op_sel_hi:[0,1,1] neg_lo:[0,1,0]
    v_pk_fma_f32 v[34:35], v[34:35], v[22:23], v[56:57] op_sel:[1,1,0] op_sel_hi:[0,1,1] neg_lo:[0,1,0]
    v_pk_fma_f32 v[38:39], v[38:39], v[26:27], v[58:59] op_sel:[1,1,0] op_sel_hi:[0,1,1] neg_lo:[0,1,0]
    v_cvt_pk_bf16_f32 v77, v32, -v33
    v_cvt_pk_bf16_f32 v78, v34, v35
    v_cvt_pk_bf16_f32 v79, v38, -v39
    v_cvt_pk_bf16_f32 v80, v40, -v41
    v_pk_mul_f32 v[52:53], v[40:41], v[24:25] op_sel:[0,0] op_sel_hi:[1,0]
    v_pk_mul_f32 v[54:55], v[32:33], v[20:21] op_sel:[0,0] op_sel_hi:[1,0]
    v_pk_mul_f32 v[56:57], v[34:35], v[22:23] op_sel:[0,0] op_sel_hi:[1,0]
    v_pk_mul_f32 v[58:59], v[38:39], v[26:27] op_sel:[0,0] op_sel_hi:[1,0]
    v_pk_mul_f32 v[60:61], v[40:41], v[28:29] op_sel:[0,0] op_sel_hi:[1,0]
    ds_write_b32 v5, v77 offset:1088
    ds_write_b32 v5, v78 offset:26656
    ds_write_b32 v5, v79 offset:9248
    ds_write_b32 v5, v80 offset:13600
    v_pk_fma_f32 v[42:43], v[40:41], v[24:25], v[52:53] op_sel:[1,1,0] op_sel_hi:[0,1,1] neg_lo:[0,1,0]
    v_pk_fma_f32 v[32:33], v[32:33], v[20:21], v[54:55] op_sel:[1,1,0] op_sel_hi:[0,1,1] neg_lo:[0,1,0]
    v_pk_fma_f32 v[34:35], v[34:35], v[22:23], v[56:57] op_sel:[1,1,0] op_sel_hi:[0,1,1] neg_lo:[0,1,0]
    v_pk_fma_f32 v[38:39], v[38:39], v[26:27], v[58:59] op_sel:[1,1,0] op_sel_hi:[0,1,1] neg_lo:[0,1,0]
    v_pk_fma_f32 v[40:41], v[40:41], v[28:29], v[60:61] op_sel:[1,1,0] op_sel_hi:[0,1,1] neg_lo:[0,1,0]
    v_cvt_pk_bf16_f32 v81, v32, -v33
    v_cvt_pk_bf16_f32 v82, v34, v35
    v_cvt_pk_bf16_f32 v83, v38, -v39
    v_cvt_pk_bf16_f32 v84, v40, -v41
    v_cvt_pk_bf16_f32 v85, v42, -v43
    v_pk_mul_f32 v[52:53], v[42:43], v[24:25] op_sel:[0,0] op_sel_hi:[1,0]
    v_pk_mul_f32 v[54:55], v[32:33], v[20:21] op_sel:[0,0] op_sel_hi:[1,0]
    v_pk_mul_f32 v[56:57], v[34:35], v[22:23] op_sel:[0,0] op_sel_hi:[1,0]
    v_pk_mul_f32 v[58:59], v[38:39], v[26:27] op_sel:[0,0] op_sel_hi:[1,0]
    v_pk_mul_f32 v[60:61], v[40:41], v[28:29] op_sel:[0,0] op_sel_hi:[1,0]
    v_pk_mul_f32 v[62:63], v[42:43], v[28:29] op_sel:[0,0] op_sel_hi:[1,0]
    ds_write_b32 v5, v81 offset:1632
    ds_write_b32 v5, v82 offset:27200
    ds_write_b32 v5, v83 offset:9792
    ds_write_b32 v5, v84 offset:14144
    ds_write_b32 v5, v85 offset:16320
    v_pk_fma_f32 v[44:45], v[42:43], v[24:25], v[52:53] op_sel:[1,1,0] op_sel_hi:[0,1,1] neg_lo:[0,1,0]
    v_pk_fma_f32 v[32:33], v[32:33], v[20:21], v[54:55] op_sel:[1,1,0] op_sel_hi:[0,1,1] neg_lo:[0,1,0]
    v_pk_fma_f32 v[34:35], v[34:35], v[22:23], v[56:57] op_sel:[1,1,0] op_sel_hi:[0,1,1] neg_lo:[0,1,0]
    v_pk_fma_f32 v[38:39], v[38:39], v[26:27], v[58:59] op_sel:[1,1,0] op_sel_hi:[0,1,1] neg_lo:[0,1,0]
    v_pk_fma_f32 v[40:41], v[40:41], v[28:29], v[60:61] op_sel:[1,1,0] op_sel_hi:[0,1,1] neg_lo:[0,1,0]
    v_pk_fma_f32 v[42:43], v[42:43], v[28:29], v[62:63] op_sel:[1,1,0] op_sel_hi:[0,1,1] neg_lo:[0,1,0]
    s_cmp_lt_u32 s3, 4
    s_cbranch_scc1 XG_18
    global_load_dwordx2 v[110:111], v7, s[16:17] offset:1280
XG_18:
    v_cvt_pk_bf16_f32 v86, v32, -v33
    v_cvt_pk_bf16_f32 v87, v34, v35
    v_cvt_pk_bf16_f32 v72, v38, -v39
    v_cvt_pk_bf16_f32 v73, v40, -v41
    v_cvt_pk_bf16_f32 v74, v42, -v43
    v_cvt_pk_bf16_f32 v75, v44, -v45
    v_pk_mul_f32 v[52:53], v[44:45], v[24:25] op_sel:[0,0] op_sel_hi:[1,0]
    v_pk_mul_f32 v[54:55], v[32:33], v[20:21] op_sel:[0,0] op_sel_hi:[1,0]
    v_pk_mul_f32 v[56:57], v[34:35], v[22:23] op_sel:[0,0] op_sel_hi:[1,0]
    v_pk_mul_f32 v[58:59], v[38:39], v[26:27] op_sel:[0,0] op_sel_hi:[1,0]
    v_pk_mul_f32 v[60:61], v[40:41], v[28:29] op_sel:[0,0] op_sel_hi:[1,0]
    v_pk_mul_f32 v[62:63], v[42:43], v[28:29] op_sel:[0,0] op_sel_hi:[1,0]
    v_pk_mul_f32 v[64:65], v[44:45], v[30:31] op_sel:[0,0] op_sel_hi:[1,0]
    ds_write_b32 v5, v86 offset:2176
    ds_write_b32 v5, v87 offset:27744
    ds_write_b32 v5, v72 offset:10336
    ds_write_b32 v5, v73 offset:14688
    ds_write_b32 v5, v74 offset:16864
    ds_write_b32 v5, v75 offset:19040
    v_pk_fma_f32 v[46:47], v[44:45], v[24:25], v[52:53] op_sel:[1,1,0] op_sel_hi:[0,1,1] neg_lo:[0,1,0]
    v_pk_fma_f32 v[32:33], v[32:33], v[20:21], v[54:55] op_sel:[1,1,0] op_sel_hi:[0,1,1] neg_lo:[0,1,0]
    v_pk_fma_f32 v[34:35], v[34:35], v[22:23], v[56:57] op_sel:[1,1,0] op_sel_hi:[0,1,1] neg_lo:[0,1,0]
    v_pk_fma_f32 v[38:39], v[38:39], v[26:27], v[58:59] op_sel:[1,1,0] op_sel_hi:[0,1,1] neg_lo:[0,1,0]
    v_pk_fma_f32 v[40:41], v[40:41], v[28:29], v[60:61] op_sel:[1,1,0] op_sel_hi:[0,1,1] neg_lo:[0,1,0]
    v_pk_fma_f32 v[42:43], v[42:43], v[28:29], v[62:63] op_sel:[1,1,0] op_sel_hi:[0,1,1] neg_lo:[0,1,0]
    v_pk_fma_f32 v[44:45], v[44:45], v[30:31], v[64:65] op_sel:[1,1,0] op_sel_hi:[0,1,1] neg_lo:[0,1,0]
    v_cvt_pk_bf16_f32 v76, v32, -v33
    v_cvt_pk_bf16_f32 v77, v34, v35
    v_cvt_pk_bf16_f32 v78, v38, -v39
    v_cvt_pk_bf16_f32 v79, v40, -v41
    v_cvt_pk_bf16_f32 v80, v42, -v43
    v_cvt_pk_bf16_f32 v81, v44, -v45
    v_cvt_pk_bf16_f32 v82, v46, -v47
    v_pk_mul_f32 v[52:53], v[46:47], v[24:25] op_sel:[0,0] op_sel_hi:[1,0]
    v_pk_mul_f32 v[54:55], v[32:33], v[20:21] op_sel:[0,0] op_sel_hi:[1,0]
    v_pk_mul_f32 v[56:57], v[34:35], v[22:23] op_sel:[0,0] op_sel_hi:[1,0]
    v_pk_mul_f32 v[58:59], v[38:39], v[26:27] op_sel:[0,0] op_sel_hi:[1,0]
    v_pk_mul_f32 v[60:61], v[40:41], v[28:29] op_sel:[0,0] op_sel_hi:[1,0]
    v_pk_mul_f32 v[62:63], v[42:43], v[28:29] op_sel:[0,0] op_sel_hi:[1,0]
    v_pk_mul_f32 v[64:65], v[44:45], v[30:31] op_sel:[0,0] op_sel_hi:[1,0]
    v_pk_mul_f32 v[66:67], v[46:47], v[30:31] op_sel:[0,0] op_sel_hi:[1,0]
    ds_write_b32 v5, v76 offset:2720
    ds_write_b32 v5, v77 offset:28288
    ds_write_b32 v5, v78 offset:10880
    ds_write_b32 v5, v79 offset:15232
    ds_write_b32 v5, v80 offset:17408
    ds_write_b32 v5, v81 offset:19584
    ds_write_b32 v5, v82 offset:20672
    v_pk_fma_f32 v[48:49], v[46:47], v[24:25], v[52:53] op_sel:[1,1,0] op_sel_hi:[0,1,1] neg_lo:[0,1,0]
    v_pk_fma_f32 v[32:33], v[32:33], v[20:21], v[54:55] op_sel:[1,1,0] op_sel_hi:[0,1,1] neg_lo:[0,1,0]
    v_pk_fma_f32 v[34:35], v[34:35], v[22:23], v[56:57] op_sel:[1,1,0] op_sel_hi:[0,1,1] neg_lo:[0,1,0]
    v_pk_fma_f32 v[38:39], v[38:39], v[26:27], v[58:59] op_sel:[1,1,0] op_sel_hi:[0,1,1] neg_lo:[0,1,0]
    v_pk_fma_f32 v[40:41], v[40:41], v[28:29], v[60:61] op_sel:[1,1,0] op_sel_hi:[0,1,1] neg_lo:[0,1,0]
    v_pk_fma_f32 v[42:43], v[42:43], v[28:29], v[62:63] op_sel:[1,1,0] op_sel_hi:[0,1,1] neg_lo:[0,1,0]
    v_pk_fma_f32 v[44:45], v[44:45], v[30:31], v[64:65] op_sel:[1,1,0] op_sel_hi:[0,1,1] neg_lo:[0,1,0]
    v_pk_fma_f32 v[46:47], v[46:47], v[30:31], v[66:67] op_sel:[1,1,0] op_sel_hi:[0,1,1] neg_lo:[0,1,0]
    v_cvt_pk_bf16_f32 v83, v32, -v33
    v_cvt_pk_bf16_f32 v84, v34, v35
    v_cvt_pk_bf16_f32 v85, v38, -v39
    v_cvt_pk_bf16_f32 v86, v40, -v41
    v_cvt_pk_bf16_f32 v87, v42, -v43
    v_cvt_pk_bf16_f32 v72, v44, -v45
    v_cvt_pk_bf16_f32 v73, v46, -v47
    v_cvt_pk_bf16_f32 v74, v48, -v49
    v_pk_mul_f32 v[52:53], v[48:49], v[24:25] op_sel:[0,0] op_sel_hi:[1,0]
    v_pk_mul_f32 v[54:55], v[32:33], v[20:21] op_sel:[0,0] op_sel_hi:[1,0]
    v_pk_mul_f32 v[56:57], v[34:35], v[22:23] op_sel:[0,0] op_sel_hi:[1,0]
    v_pk_mul_f32 v[58:59], v[38:39], v[26:27] op_sel:[0,0] op_sel_hi:[1,0]
    v_pk_mul_f32 v[60:61], v[42:43], v[28:29] op_sel:[0,0] op_sel_hi:[1,0]
    v_pk_mul_f32 v[62:63], v[46:47], v[30:31] op_sel:[0,0] op_sel_hi:[1,0]
    v_pk_mul_f32 v[64:65], v[48:49], v[30:31] op_sel:[0,0] op_sel_hi:[1,0]
    ds_write_b32 v5, v83 offset:3264
    ds_write_b32 v5, v84 offset:28832
    ds_write_b32 v5, v85 offset:11424
    ds_write_b32 v5, v86 offset:15776
    ds_write_b32 v5, v87 offset:17952
    ds_write_b32 v5, v72 offset:20128
    ds_write_b32 v5, v73 offset:21216
    ds_write_b32 v5, v74 offset:22304
    v_pk_fma_f32 v[50:51], v[48:49], v[24:25], v[52:53] op_sel:[1,1,0] op_sel_hi:[0,1,1] neg_lo:[0,1,0]
    v_pk_fma_f32 v[32:33], v[32:33], v[20:21], v[54:55] op_sel:[1,1,0] op_sel_hi:[0,1,1] neg_lo:[0,1,0]
    v_pk_fma_f32 v[34:35], v[34:35], v[22:23], v[56:57] op_sel:[1,1,0] op_sel_hi:[0,1,1] neg_lo:[0,1,0]
    v_pk_fma_f32 v[38:39], v[38:39], v[26:27], v[58:59] op_sel:[1,1,0] op_sel_hi:[0,1,1] neg_lo:[0,1,0]
    v_pk_fma_f32 v[42:43], v[42:43], v[28:29], v[60:61] op_sel:[1,1,0] op_sel_hi:[0,1,1] neg_lo:[0,1,0]
    v_pk_fma_f32 v[46:47], v[46:47], v[30:31], v[62:63] op_sel:[1,1,0] op_sel_hi:[0,1,1] neg_lo:[0,1,0]
    v_pk_fma_f32 v[48:49], v[48:49], v[30:31], v[64:65] op_sel:[1,1,0] op_sel_hi:[0,1,1] neg_lo:[0,1,0]
    s_cmp_lt_u32 s3, 4
    s_cbranch_scc1 XG_19
    global_load_dwordx2 v[112:113], v7, s[16:17] offset:2560
XG_19:
    v_cvt_pk_bf16_f32 v75, v32, -v33
    v_cvt_pk_bf16_f32 v76, v34, v35
    v_cvt_pk_bf16_f32 v77, v38, -v39
    v_cvt_pk_bf16_f32 v78, v42, -v43
    v_cvt_pk_bf16_f32 v79, v46, -v47
    v_cvt_pk_bf16_f32 v80, v48, -v49
    v_cvt_pk_bf16_f32 v81, v50, -v51
    v_pk_mul_f32 v[52:53], v[32:33], v[20:21] op_sel:[0,0] op_sel_hi:[1,0]
    v_pk_mul_f32 v[54:55], v[34:35], v[22:23] op_sel:[0,0] op_sel_hi:[1,0]
    v_pk_mul_f32 v[56:57], v[38:39], v[26:27] op_sel:[0,0] op_sel_hi:[1,0]
    v_pk_mul_f32 v[58:59], v[48:49], v[30:31] op_sel:[0,0] op_sel_hi:[1,0]
    v_pk_mul_f32 v[60:61], v[50:51], v[30:31] op_sel:[0,0] op_sel_hi:[1,0]
    ds_write_b32 v5, v75 offset:3808
    ds_write_b32 v5, v76 offset:29376
    ds_write_b32 v5, v77 offset:11968
    ds_write_b32 v5, v78 offset:18496
    ds_write_b32 v5, v79 offset:21760
    ds_write_b32 v5, v80 offset:22848
    ds_write_b32 v5, v81 offset:23936
    v_pk_fma_f32 v[32:33], v[32:33], v[20:21], v[52:53] op_sel:[1,1,0] op_sel_hi:[0,1,1] neg_lo:[0,1,0]
    v_pk_fma_f32 v[34:35], v[34:35], v[22:23], v[54:55] op_sel:[1,1,0] op_sel_hi:[0,1,1] neg_lo:[0,1,0]
    v_pk_fma_f32 v[38:39], v[38:39], v[26:27], v[56:57] op_sel:[1,1,0] op_sel_hi:[0,1,1] neg_lo:[0,1,0]
    v_pk_fma_f32 v[48:49], v[48:49], v[30:31], v[58:59] op_sel:[1,1,0] op_sel_hi:[0,1,1] neg_lo:[0,1,0]
    v_pk_fma_f32 v[50:51], v[50:51], v[30:31], v[60:61] op_sel:[1,1,0] op_sel_hi:[0,1,1] neg_lo:[0,1,0]
    v_cvt_pk_bf16_f32 v82, v32, -v33
    v_cvt_pk_bf16_f32 v83, v34, v35
    v_cvt_pk_bf16_f32 v84, v38, -v39
    v_cvt_pk_bf16_f32 v85, v48, -v49
    v_cvt_pk_bf16_f32 v86, v50, -v51
    v_pk_mul_f32 v[52:53], v[32:33], v[20:21] op_sel:[0,0] op_sel_hi:[1,0]
    v_pk_mul_f32 v[54:55], v[34:35], v[22:23] op_sel:[0,0] op_sel_hi:[1,0]
    v_pk_mul_f32 v[56:57], v[38:39], v[26:27] op_sel:[0,0] op_sel_hi:[1,0]
    v_pk_mul_f32 v[58:59], v[50:51], v[30:31] op_sel:[0,0] op_sel_hi:[1,0]
    ds_write_b32 v5, v82 offset:4352
    ds_write_b32 v5, v83 offset:29920
    ds_write_b32 v5, v84 offset:12512
    ds_write_b32 v5, v85 offset:23392
    ds_write_b32 v5, v86 offset:24480
    v_pk_fma_f32 v[32:33], v[32:33], v[20:21], v[52:53] op_sel:[1,1,0] op_sel_hi:[0,1,1] neg_lo:[0,1,0]
    v_pk_fma_f32 v[34:35], v[34:35], v[22:23], v[54:55] op_sel:[1,1,0] op_sel_hi:[0,1,1] neg_lo:[0,1,0]
    v_pk_fma_f32 v[38:39], v[38:39], v[26:27], v[56:57] op_sel:[1,1,0] op_sel_hi:[0,1,1] neg_lo:[0,1,0]
    v_pk_fma_f32 v[50:51], v[50:51], v[30:31], v[58:59] op_sel:[1,1,0] op_sel_hi:[0,1,1] neg_lo:[0,1,0]
    v_cvt_pk_bf16_f32 v87, v32, -v33
    v_cvt_pk_bf16_f32 v72, v34, v35
    v_cvt_pk_bf16_f32 v73, v38, -v39
    v_cvt_pk_bf16_f32 v74, v50, -v51
    v_pk_mul_f32 v[52:53], v[32:33], v[20:21] op_sel:[0,0] op_sel_hi:[1,0]
    v_pk_mul_f32 v[54:55], v[34:35], v[22:23] op_sel:[0,0] op_sel_hi:[1,0]
    ds_write_b32 v5, v87 offset:4896
    ds_write_b32 v5, v72 offset:30464
    ds_write_b32 v5, v73 offset:13056
    ds_write_b32 v5, v74 offset:25024
    v_pk_fma_f32 v[32:33], v[32:33], v[20:21], v[52:53] op_sel:[1,1,0] op_sel_hi:[0,1,1] neg_lo:[0,1,0]
    v_pk_fma_f32 v[34:35], v[34:35], v[22:23], v[54:55] op_sel:[1,1,0] op_sel_hi:[0,1,1] neg_lo:[0,1,0]
    s_cmp_lt_u32 s3, 4
    s_cbranch_scc1 XG_20
    global_load_dwordx2 v[114:115], v7, s[16:17] offset:3840
XG_20:
    v_cvt_pk_bf16_f32 v75, v32, -v33
    v_cvt_pk_bf16_f32 v76, v34, v35
    v_pk_mul_f32 v[52:53], v[32:33], v[20:21] op_sel:[0,0] op_sel_hi:[1,0]
    v_pk_mul_f32 v[54:55], v[34:35], v[22:23] op_sel:[0,0] op_sel_hi:[1,0]
    ds_write_b32 v5, v75 offset:5440
    ds_write_b32 v5, v76 offset:31008
    v_pk_fma_f32 v[32:33], v[32:33], v[20:21], v[52:53] op_sel:[1,1,0] op_sel_hi:[0,1,1] neg_lo:[0,1,0]
    v_pk_fma_f32 v[34:35], v[34:35], v[22:23], v[54:55] op_sel:[1,1,0] op_sel_hi:[0,1,1] neg_lo:[0,1,0]
    v_cvt_pk_bf16_f32 v77, v32, -v33
    v_cvt_pk_bf16_f32 v78, v34, v35
    v_pk_mul_f32 v[52:53], v[32:33], v[20:21] op_sel:[0,0] op_sel_hi:[1,0]
    v_pk_mul_f32 v[54:55], v[34:35], v[22:23] op_sel:[0,0] op_sel_hi:[1,0]
    ds_write_b32 v5, v77 offset:5984
    ds_write_b32 v5, v78 offset:31552
    v_pk_fma_f32 v[32:33], v[32:33], v[20:21], v[52:53] op_sel:[1,1,0] op_sel_hi:[0,1,1] neg_lo:[0,1,0]
    v_pk_fma_f32 v[34:35], v[34:35], v[22:23], v[54:55] op_sel:[1,1,0] op_sel_hi:[0,1,1] neg_lo:[0,1,0]
    v_cvt_pk_bf16_f32 v79, v32, -v33
    v_cvt_pk_bf16_f32 v80, v34, v35
    v_pk_mul_f32 v[52:53], v[32:33], v[20:21] op_sel:[0,0] op_sel_hi:[1,0]
    v_pk_mul_f32 v[54:55], v[34:35], v[22:23] op_sel:[0,0] op_sel_hi:[1,0]
    ds_write_b32 v5, v79 offset:6528
    ds_write_b32 v5, v80 offset:32096
    v_pk_fma_f32 v[32:33], v[32:33], v[20:21], v[52:53] op_sel:[1,1,0] op_sel_hi:[0,1,1] neg_lo:[0,1,0]
    v_pk_fma_f32 v[34:35], v[34:35], v[22:23], v[54:55] op_sel:[1,1,0] op_sel_hi:[0,1,1] neg_lo:[0,1,0]
    v_cvt_pk_bf16_f32 v81, v32, -v33
    v_cvt_pk_bf16_f32 v82, v34, v35
    v_pk_mul_f32 v[52:53], v[32:33], v[20:21] op_sel:[0,0] op_sel_hi:[1,0]
    v_pk_mul_f32 v[54:55], v[34:35], v[22:23] op_sel:[0,0] op_sel_hi:[1,0]
    ds_write_b32 v5, v81 offset:7072
    ds_write_b32 v5, v82 offset:32640
    v_pk_fma_f32 v[32:33], v[32:33], v[20:21], v[52:53] op_sel:[1,1,0] op_sel_hi:[0,1,1] neg_lo:[0,1,0]
    v_pk_fma_f32 v[34:35], v[34:35], v[22:23], v[54:55] op_sel:[1,1,0] op_sel_hi:[0,1,1] neg_lo:[0,1,0]
    v_cvt_pk_bf16_f32 v83, v32, -v33
    v_cvt_pk_bf16_f32 v84, v34, v35
    v_pk_mul_f32 v[52:53], v[32:33], v[20:21] op_sel:[0,0] op_sel_hi:[1,0]
    v_pk_mul_f32 v[54:55], v[34:35], v[22:23] op_sel:[0,0] op_sel_hi:[1,0]
    ds_write_b32 v5, v83 offset:7616
    ds_write_b32 v5, v84 offset:33184
    v_pk_fma_f32 v[32:33], v[32:33], v[20:21], v[52:53] op_sel:[1,1,0] op_sel_hi:[0,1,1] neg_lo:[0,1,0]
    v_pk_fma_f32 v[34:35], v[34:35], v[22:23], v[54:55] op_sel:[1,1,0] op_sel_hi:[0,1,1] neg_lo:[0,1,0]
    v_cvt_pk_bf16_f32 v85, v32, -v33
    v_cvt_pk_bf16_f32 v86, v34, v35
    ds_write_b32 v5, v85 offset:8160
    ds_write_b32 v5, v86 offset:33728
    s_cmp_lg_u32 s3, 4
    s_cbranch_scc1 L_CV_B1
    v_lshlrev_b32 v8, 2, v1
    v_add_u32 v8, 158720, v8
    v_mov_b32 v9, 0
    ds_write_b32 v8, v9
L_CV_B1:
    s_waitcnt lgkmcnt(0)
    s_barrier
    s_cmp_ge_u32 s3, 4
    s_cbranch_scc1 L_CV_NORM
    s_mul_i32 s46, s3, 34272
    v_lshrrev_b32 v8, 3, v2
    v_bfe_u32 v9, v2, 2, 1
    v_and_b32 v10, 3, v2
    v_mul_u32_u24 v11, 8, v8
    v_mul_u32_u24 v12, 4, v9
    v_add3_u32 v11, v11, v12, v10
    v_add_u32 v11, 0, v11
    v_mul_u32_u24 v11, 544, v11
    v_lshl_add_u32 v11, v3, 4, v11
    v_add_u32 v16, s46, v11
    v_mul_u32_u24 v11, 4, v8
    v_mul_u32_u24 v12, 2, v9
    v_add3_u32 v11, v11, v12, v10
    v_add_u32 v11, 16, v11
    v_mul_u32_u24 v11, 544, v11
    v_lshl_add_u32 v11, v3, 4, v11
    v_add_u32 v17, s46, v11
    v_mul_u32_u24 v11, 5, v8
    v_mul_u32_u24 v12, 2, v9
    v_add3_u32 v11, v11, v12, v10
    v_add_u32 v11, 25, v11
    v_mul_u32_u24 v11, 544, v11
    v_lshl_add_u32 v11, v3, 4, v11
    v_add_u32 v18, s46, v11
    v_mul_u32_u24 v11, 6, v8
    v_mul_u32_u24 v12, 3, v9
    v_add3_u32 v11, v11, v12, v10
    v_add_u32 v11, 35, v11
    v_mul_u32_u24 v11, 544, v11
    v_lshl_add_u32 v11, v3, 4, v11
    v_add_u32 v19, s46, v11
    v_add_u32 v11, 47, v2
    v_mul_u32_u24 v11, 544, v11
    v_lshl_add_u32 v11, v3, 4, v11
    v_add_u32 v15, s46, v11
    ds_read_b128 v[32:35], v15 offset:0
    ds_read_b128 v[64:67], v16 offset:0
    ds_read_b128 v[36:39], v15 offset:64
    ds_read_b128 v[68:71], v16 offset:64
    ds_read_b128 v[40:43], v15 offset:128
    ds_read_b128 v[72:75], v16 offset:128
    ds_read_b128 v[44:47], v15 offset:192
    ds_read_b128 v[76:79], v16 offset:192
    ds_read_b128 v[48:51], v15 offset:256
    ds_read_b128 v[80:83], v16 offset:256
    ds_read_b128 v[52:55], v15 offset:320
    ds_read_b128 v[84:87], v16 offset:320
    ds_read_b128 v[56:59], v15 offset:384
    ds_read_b128 v[88:91], v16 offset:384
    ds_read_b128 v[60:63], v15 offset:448
    ds_read_b128 v[92:95], v16 offset:448
    ds_read_b128 v[96:99], v17 offset:0
    ds_read_b128 v[100:103], v17 offset:64
    ds_read_b128 v[104:107], v17 offset:128
    ds_read_b128 v[108:111], v17 offset:192
    ds_read_b128 v[112:115], v17 offset:256
    ds_read_b128 v[116:119], v17 offset:320
    ds_read_b128 v[120:123], v17 offset:384
    ds_read_b128 v[124:127], v17 offset:448
    s_waitcnt lgkmcnt(15)
    v_mfma_f32_16x16x32_bf16 v[20:23], v[64:67], v[32:35], 0
    s_waitcnt lgkmcnt(15)
    v_mfma_f32_16x16x32_bf16 v[20:23], v[68:71], v[36:39], v[20:23]
    s_waitcnt lgkmcnt(15)
    v_mfma_f32_16x16x32_bf16 v[20:23], v[72:75], v[40:43], v[20:23]
    s_waitcnt lgkmcnt(15)
    v_mfma_f32_16x16x32_bf16 v[20:23], v[76:79], v[44:47], v[20:23]
    s_waitcnt lgkmcnt(14)
    v_mfma_f32_16x16x32_bf16 v[20:23], v[80:83], v[48:51], v[20:23]
    s_waitcnt lgkmcnt(12)
    v_mfma_f32_16x16x32_bf16 v[20:23], v[84:87], v[52:55], v[20:23]
    s_waitcnt lgkmcnt(10)
    v_mfma_f32_16x16x32_bf16 v[20:23], v[88:91], v[56:59], v[20:23]
    s_waitcnt lgkmcnt(8)
    v_mfma_f32_16x16x32_bf16 v[20:23], v[92:95], v[60:63], v[20:23]
    ds_read_b128 v[128:131], v18 offset:0
    ds_read_b128 v[132:135], v18 offset:64
    ds_read_b128 v[136:139], v18 offset:128
    ds_read_b128 v[140:143], v18 offset:192
    ds_read_b128 v[144:147], v18 offset:256
    ds_read_b128 v[148:151], v18 offset:320
    ds_read_b128 v[152:155], v18 offset:384
    ds_read_b128 v[156:159], v18 offset:448
    s_waitcnt lgkmcnt(15)
    v_mfma_f32_16x16x32_bf16 v[24:27], v[96:99], v[32:35], 0
    s_waitcnt lgkmcnt(14)
    v_mfma_f32_16x16x32_bf16 v[24:27], v[100:103], v[36:39], v[24:27]
    s_waitcnt lgkmcnt(13)
    v_mfma_f32_16x16x32_bf16 v[24:27], v[104:107], v[40:43], v[24:27]
    s_waitcnt lgkmcnt(12)
    v_mfma_f32_16x16x32_bf16 v[24:27], v[108:111], v[44:47], v[24:27]
    s_waitcnt lgkmcnt(11)
    v_mfma_f32_16x16x32_bf16 v[24:27], v[112:115], v[48:51], v[24:27]
    s_waitcnt lgkmcnt(10)
    v_mfma_f32_16x16x32_bf16 v[24:27], v[116:119], v[52:55], v[24:27]
    s_waitcnt lgkmcnt(9)
    v_mfma_f32_16x16x32_bf16 v[24:27], v[120:123], v[56:59], v[24:27]
    s_waitcnt lgkmcnt(8)
    v_mfma_f32_16x16x32_bf16 v[24:27], v[124:127], v[60:63], v[24:27]
    ds_read_b128 v[160:163], v19 offset:0
    ds_read_b128 v[164:167], v19 offset:64
    ds_read_b128 v[168:171], v19 offset:128
    ds_read_b128 v[172:175], v19 offset:192
    ds_read_b128 v[176:179], v19 offset:256
    ds_read_b128 v[180:183], v19 offset:320
    ds_read_b128 v[184:187], v19 offset:384
    ds_read_b128 v[188:191], v19 offset:448
    s_waitcnt lgkmcnt(15)
    v_mfma_f32_16x16x32_bf16 v[28:31], v[128:131], v[32:35], 0
    s_waitcnt lgkmcnt(14)
    v_mfma_f32_16x16x32_bf16 v[28:31], v[132:135], v[36:39], v[28:31]
    s_waitcnt lgkmcnt(13)
    v_mfma_f32_16x16x32_bf16 v[28:31], v[136:139], v[40:43], v[28:31]
    s_waitcnt lgkmcnt(12)
    v_mfma_f32_16x16x32_bf16 v[28:31], v[140:143], v[44:47], v[28:31]
    s_waitcnt lgkmcnt(11)
    v_mfma_f32_16x16x32_bf16 v[28:31], v[144:147], v[48:51], v[28:31]
    s_waitcnt lgkmcnt(10)
    v_mfma_f32_16x16x32_bf16 v[28:31], v[148:151], v[52:55], v[28:31]
    s_waitcnt lgkmcnt(9)
    v_mfma_f32_16x16x32_bf16 v[28:31], v[152:155], v[56:59], v[28:31]
    s_waitcnt lgkmcnt(8)
    v_mfma_f32_16x16x32_bf16 v[28:31], v[156:159], v[60:63], v[28:31]
    s_waitcnt lgkmcnt(7)
    v_mfma_f32_16x16x32_bf16 v[192:195], v[160:163], v[32:35], 0
    s_waitcnt lgkmcnt(6)
    v_mfma_f32_16x16x32_bf16 v[192:195], v[164:167], v[36:39], v[192:195]
    s_waitcnt lgkmcnt(5)
    v_mfma_f32_16x16x32_bf16 v[192:195], v[168:171], v[40:43], v[192:195]
    s_waitcnt lgkmcnt(4)
    v_mfma_f32_16x16x32_bf16 v[192:195], v[172:175], v[44:47], v[192:195]
    s_waitcnt lgkmcnt(3)
    v_mfma_f32_16x16x32_bf16 v[192:195], v[176:179], v[48:51], v[192:195]
    s_waitcnt lgkmcnt(2)
    v_mfma_f32_16x16x32_bf16 v[192:195], v[180:183], v[52:55], v[192:195]
    s_waitcnt lgkmcnt(1)
    v_mfma_f32_16x16x32_bf16 v[192:195], v[184:187], v[56:59], v[192:195]
    s_waitcnt lgkmcnt(0)
    v_mfma_f32_16x16x32_bf16 v[192:195], v[188:191], v[60:63], v[192:195]
    s_mul_i32 s46, s3, 34272
    v_lshlrev_b32 v10, 5, v2
    v_cmp_eq_u32 vcc, 0, v1
    v_mov_b32 v11, s5
    v_lshl_add_u32 v12, v3, 3, v10
    v_cndmask_b32 v11, 0, v11, vcc
    s_nop 3
    v_add_f32 v20, v20, v11
    v_cvt_pk_bf16_f32 v64, v23, v22
    v_cvt_pk_bf16_f32 v65, v21, v20
    v_sub_u32 v13, 4088, v12
    v_add_u32 v13, s46, v13
    ds_write_b64 v13, v[64:65]
    v_cvt_pk_bf16_f32 v66, v26, v25
    v_cvt_pk_bf16_f32 v67, v24, v24
    v_sub_u32 v13, 3576, v12
    v_add_u32 v13, s46, v13
    ds_write_b64 v13, v[66:67]
    v_cvt_pk_bf16_f32 v68, v30, v30
    v_cvt_pk_bf16_f32 v69, v29, v29
    v_cvt_pk_bf16_f32 v70, v29, v28
    v_cvt_pk_bf16_f32 v71, v28, v28
    v_lshrrev_b32 v11, 1, v3
    v_lshl_add_u32 v12, v11, 9, v10
    v_and_b32 v11, 1, v3
    v_lshl_add_u32 v12, v11, 4, v12
    v_sub_u32 v13, 3056, v12
    v_add_u32 v13, s46, v13
    ds_write_b128 v13, v[68:71]
    v_cvt_pk_bf16_f32 v72, v194, v194
    v_mov_b32 v73, v72
    v_cvt_pk_bf16_f32 v74, v193, v193
    v_mov_b32 v75, v74
    v_mov_b32 v76, v74
    v_cvt_pk_bf16_f32 v77, v193, v192
    v_cvt_pk_bf16_f32 v78, v192, v192
    v_mov_b32 v79, v78
    v_lshl_add_u32 v12, v3, 9, v10
    v_sub_u32 v13, 2016, v12
    v_add_u32 v13, s46, v13
    ds_write_b128 v13, v[72:75]
    ds_write_b128 v13, v[76:79] offset:16
    v_mov_b32 v32, 0
    v_mov_b32 v33, 0
    v_mov_b32 v34, 0
    v_mov_b32 v35, 0
    v_bfe_u32 v8, v1, 2, 2
    v_mul_u32_u24 v8, 4160, v8
    v_and_b32 v9, 3, v1
    v_lshl_add_u32 v8, v9, 4, v8
    v_add_u32 v8, s46, v8
    ds_write_b128 v8, v[32:35] offset:4096
    v_lshl_add_u32 v8, v1, 3, s46
    v_add_u32 v9, 4160, v8
    v_add_u32 v10, 8320, v8
    v_add_u32 v11, 12480, v8
    s_waitcnt lgkmcnt(0)
    ds_read_b64 v[32:33], v8 offset:0
    ds_read_b64 v[34:35], v8 offset:8
    ds_read_b64 v[36:37], v8 offset:512
    ds_read_b64 v[38:39], v8 offset:520
    ds_read_b64 v[40:41], v8 offset:1024
    ds_read_b64 v[42:43], v8 offset:1032
    ds_read_b64 v[44:45], v8 offset:1536
    ds_read_b64 v[46:47], v8 offset:1544
    ds_read_b64 v[48:49], v8 offset:2048
    ds_read_b64 v[50:51], v8 offset:2056
    ds_read_b64 v[52:53], v8 offset:2560
    ds_read_b64 v[54:55], v8 offset:2568
    ds_read_b64 v[56:57], v8 offset:3072
    ds_read_b64 v[58:59], v8 offset:3080
    ds_read_b64 v[60:61], v8 offset:3584
    ds_read_b64 v[62:63], v8 offset:3592
    s_waitcnt lgkmcnt(14)
    v_alignbit_b32 v64, v33, v32, 16
    v_alignbit_b32 v65, v34, v33, 16
    v_alignbit_b32 v66, v35, v34, 16
    ds_write2_b32 v9, v64, v65 offset0:0 offset1:1
    ds_write2_b32 v10, v33, v34 offset0:0 offset1:1
    ds_write2_b32 v11, v65, v66 offset0:0 offset1:1
    s_waitcnt lgkmcnt(15)
    v_alignbit_b32 v68, v37, v36, 16
    v_alignbit_b32 v69, v38, v37, 16
    v_alignbit_b32 v70, v39, v38, 16
    v_add_u32 v9, 512, v9
    v_add_u32 v10, 512, v10
    v_add_u32 v11, 512, v11
    ds_write2_b32 v9, v68, v69 offset0:0 offset1:1
    ds_write2_b32 v10, v37, v38 offset0:0 offset1:1
    ds_write2_b32 v11, v69, v70 offset0:0 offset1:1
    s_waitcnt lgkmcnt(15)
    v_alignbit_b32 v72, v41, v40, 16
    v_alignbit_b32 v73, v42, v41, 16
    v_alignbit_b32 v74, v43, v42, 16
    v_add_u32 v9, 512, v9
    v_add_u32 v10, 512, v10
    v_add_u32 v11, 512, v11
    ds_write2_b32 v9, v72, v73 offset0:0 offset1:1
    ds_write2_b32 v10, v41, v42 offset0:0 offset1:1
    ds_write2_b32 v11, v73, v74 offset0:0 offset1:1
    s_waitcnt lgkmcnt(15)
    v_alignbit_b32 v76, v45, v44, 16
    v_alignbit_b32 v77, v46, v45, 16
    v_alignbit_b32 v78, v47, v46, 16
    v_add_u32 v9, 512, v9
    v_add_u32 v10, 512, v10
    v_add_u32 v11, 512, v11
    ds_write2_b32 v9, v76, v77 offset0:0 offset1:1
    ds_write2_b32 v10, v45, v46 offset0:0 offset1:1
    ds_write2_b32 v11, v77, v78 offset0:0 offset1:1
    s_waitcnt lgkmcnt(15)
    v_alignbit_b32 v80, v49, v48, 16
    v_alignbit_b32 v81, v50, v49, 16
    v_alignbit_b32 v82, v51, v50, 16
    v_add_u32 v9, 512, v9
    v_add_u32 v10, 512, v10
    v_add_u32 v11, 512, v11
    ds_write2_b32 v9, v80, v81 offset0:0 offset1:1
    ds_write2_b32 v10, v49, v50 offset0:0 offset1:1
    ds_write2_b32 v11, v81, v82 offset0:0 offset1:1
    s_waitcnt lgkmcnt(15)
    v_alignbit_b32 v84, v53, v52, 16
    v_alignbit_b32 v85, v54, v53, 16
    v_alignbit_b32 v86, v55, v54, 16
    v_add_u32 v9, 512, v9
    v_add_u32 v10, 512, v10
    v_add_u32 v11, 512, v11
    ds_write2_b32 v9, v84, v85 offset0:0 offset1:1
    ds_write2_b32 v10, v53, v54 offset0:0 offset1:1
    ds_write2_b32 v11, v85, v86 offset0:0 offset1:1
    s_waitcnt lgkmcnt(15)
    v_alignbit_b32 v88, v57, v56, 16
    v_alignbit_b32 v89, v58, v57, 16
    v_alignbit_b32 v90, v59, v58, 16
    v_add_u32 v9, 512, v9
    v_add_u32 v10, 512, v10
    v_add_u32 v11, 512, v11
    ds_write2_b32 v9, v88, v89 offset0:0 offset1:1
    ds_write2_b32 v10, v57, v58 offset0:0 offset1:1
    ds_write2_b32 v11, v89, v90 offset0:0 offset1:1
    s_waitcnt lgkmcnt(15)
    v_alignbit_b32 v92, v61, v60, 16
    v_alignbit_b32 v93, v62, v61, 16
    v_alignbit_b32 v94, v63, v62, 16
    v_add_u32 v9, 512, v9
    v_add_u32 v10, 512, v10
    v_add_u32 v11, 512, v11
    ds_write2_b32 v9, v92, v93 offset0:0 offset1:1
    ds_write2_b32 v10, v61, v62 offset0:0 offset1:1
    ds_write2_b32 v11, v93, v94 offset0:0 offset1:1
    s_waitcnt vmcnt(0)
    s_branch L_CV_B2
L_CV_NORM:
    s_mul_i32 s46, s67, 224
    s_mov_b32 s47, 74899
    v_add_u32 v4, 0, v1
    v_mul_lo_u32 v5, v4, s47
    v_lshrrev_b32 v5, 20, v5
    v_mul_u32_u24 v6, 14, v5
    v_sub_u32 v6, v4, v6
    v_mul_u32_u24 v5, 3456, v5
    v_lshl_add_u32 v5, v6, 4, v5
    v_add_u32 v240, s46, v5
    v_add_u32 v4, 64, v1
    v_mul_lo_u32 v5, v4, s47
    v_lshrrev_b32 v5, 20, v5
    v_mul_u32_u24 v6, 14, v5
    v_sub_u32 v6, v4, v6
    v_mul_u32_u24 v5, 3456, v5
    v_lshl_add_u32 v5, v6, 4, v5
    v_add_u32 v241, s46, v5
    v_add_u32 v4, 128, v1
    v_mul_lo_u32 v5, v4, s47
    v_lshrrev_b32 v5, 20, v5
    v_mul_u32_u24 v6, 14, v5
    v_sub_u32 v6, v4, v6
    v_mul_u32_u24 v5, 3456, v5
    v_lshl_add_u32 v5, v6, 4, v5
    v_add_u32 v242, s46, v5
    v_add_u32 v4, 192, v1
    v_mul_lo_u32 v5, v4, s47
    v_lshrrev_b32 v5, 20, v5
    v_mul_u32_u24 v6, 14, v5
    v_sub_u32 v6, v4, v6
    v_mul_u32_u24 v5, 3456, v5
    v_lshl_add_u32 v5, v6, 4, v5
    v_add_u32 v243, s46, v5
    v_add_u32 v4, 256, v1
    v_mul_lo_u32 v5, v4, s47
    v_lshrrev_b32 v5, 20, v5
    v_mul_u32_u24 v6, 14, v5
    v_sub_u32 v6, v4, v6
    v_mul_u32_u24 v5, 3456, v5
    v_lshl_add_u32 v5, v6, 4, v5
    v_add_u32 v244, s46, v5
    v_add_u32 v4, 320, v1
    v_mul_lo_u32 v5, v4, s47
    v_lshrrev_b32 v5, 20, v5
    v_mul_u32_u24 v6, 14, v5
    v_sub_u32 v6, v4, v6
    v_mul_u32_u24 v5, 3456, v5
    v_lshl_add_u32 v5, v6, 4, v5
    v_add_u32 v245, s46, v5
    v_add_u32 v4, 384, v1
    v_mul_lo_u32 v5, v4, s47
    v_lshrrev_b32 v5, 20, v5
    v_mul_u32_u24 v6, 14, v5
    v_sub_u32 v6, v4, v6
    v_mul_u32_u24 v5, 3456, v5
    v_lshl_add_u32 v5, v6, 4, v5
    v_add_u32 v246, s46, v5
    s_cmp_lg_u32 s3, 4
    s_cbranch_scc1 L_CV_NW
    s_mov_b32 s46, 128
    s_mov_b64 s[68:69], exec
    s_mov_b32 exec_lo, 0x1
    s_mov_b32 exec_hi, 0x0
    v_lshlrev_b32 v12, 2, v1
    s_mov_b32 s47, 0
POLL_21:
    buffer_load_dword v8, v12, s[56:59], s46 offen sc1
    s_waitcnt vmcnt(0)
    v_cmp_ne_u32 vcc, 0, v8
    s_cmp_eq_u64 vcc, exec
    s_cbranch_scc1 POLLD_22
    s_sleep 1
    s_add_u32 s47, s47, 1
    s_cmp_lt_u32 s47, 262144
    s_cbranch_scc1 POLL_21
POLLD_22:
    s_mov_b64 exec, s[68:69]
    s_mov_b64 exec, 1
    v_mov_b32 v8, 158784
    v_mov_b32 v9, 1
    ds_add_u32 v8, v9
    s_mov_b64 exec, -1
    s_branch L_CV_NG
L_CV_NW:
    v_mov_b32 v4, 158784
LW_23:
    ds_read_b32 v5, v4
    s_waitcnt lgkmcnt(0)
    v_readfirstlane_b32 s13, v5
    s_cmp_ge_u32 s13, 1
    s_cbranch_scc1 LWD_24
    s_sleep 1
    s_branch LW_23
LWD_24:
L_CV_NG:
    v_subrev_u32 v6, 256, v0
    v_lshlrev_b32 v6, 6, v6
    s_mov_b32 s46, 0x0
    buffer_load_dwordx4 v[120:123], v6, s[8:11], s46 offen offset:0 sc1
    buffer_load_dwordx4 v[124:127], v6, s[8:11], s46 offen offset:16 sc1
    buffer_load_dwordx4 v[128:131], v6, s[8:11], s46 offen offset:32 sc1
    buffer_load_dwordx4 v[132:135], v6, s[8:11], s46 offen offset:48 sc1
    s_mov_b32 s46, 0x5040100
    s_mov_b32 s47, 0x7060302
    s_waitcnt vmcnt(4)
    v_perm_b32 v136, v102, v100, s46
    v_perm_b32 v137, v106, v104, s46
    v_perm_b32 v138, v110, v108, s46
    v_perm_b32 v139, v114, v112, s46
    v_perm_b32 v140, v102, v100, s47
    v_perm_b32 v141, v106, v104, s47
    v_perm_b32 v142, v110, v108, s47
    v_perm_b32 v143, v114, v112, s47
    v_perm_b32 v144, v103, v101, s46
    v_perm_b32 v145, v107, v105, s46
    v_perm_b32 v146, v111, v109, s46
    v_perm_b32 v147, v115, v113, s46
    v_perm_b32 v148, v103, v101, s47
    v_perm_b32 v149, v107, v105, s47
    v_perm_b32 v150, v111, v109, s47
    v_perm_b32 v151, v115, v113, s47
    v_lshlrev_b32 v168, 16, v100
    v_and_b32 v169, 0xffff0000, v100
    v_lshlrev_b32 v170, 16, v101
    v_and_b32 v171, 0xffff0000, v101
    v_lshlrev_b32 v172, 16, v102
    v_and_b32 v173, 0xffff0000, v102
    v_lshlrev_b32 v174, 16, v103
    v_and_b32 v175, 0xffff0000, v103
    v_lshlrev_b32 v176, 16, v104
    v_and_b32 v177, 0xffff0000, v104
    v_lshlrev_b32 v178, 16, v105
    v_and_b32 v179, 0xffff0000, v105
    v_lshlrev_b32 v180, 16, v106
    v_and_b32 v181, 0xffff0000, v106
    v_lshlrev_b32 v182, 16, v107
    v_and_b32 v183, 0xffff0000, v107
    v_lshlrev_b32 v184, 16, v108
    v_and_b32 v185, 0xffff0000, v108
    v_lshlrev_b32 v186, 16, v109
    v_and_b32 v187, 0xffff0000, v109
    v_lshlrev_b32 v188, 16, v110
    v_and_b32 v189, 0xffff0000, v110
    v_lshlrev_b32 v190, 16, v111
    v_and_b32 v191, 0xffff0000, v111
    v_lshlrev_b32 v192, 16, v112
    v_and_b32 v193, 0xffff0000, v112
    v_lshlrev_b32 v194, 16, v113
    v_and_b32 v195, 0xffff0000, v113
    v_lshlrev_b32 v196, 16, v114
    v_and_b32 v197, 0xffff0000, v114
    v_lshlrev_b32 v198, 16, v115
    v_and_b32 v199, 0xffff0000, v115
    s_waitcnt vmcnt(0)
    v_sub_f32 v168, v168, v120
    v_sub_f32 v169, v169, v120
    v_cvt_pk_bf16_f32 v8, v168, v169
    v_sub_f32 v170, v170, v120
    v_sub_f32 v171, v171, v120
    v_cvt_pk_bf16_f32 v9, v170, v171
    v_lshlrev_b32 v168, 16, v8
    v_and_b32 v169, 0xffff0000, v8
    v_mul_f32 v168, v168, v121
    v_mul_f32 v169, v169, v121
    v_lshlrev_b32 v170, 16, v9
    v_and_b32 v171, 0xffff0000, v9
    v_mul_f32 v170, v170, v121
    v_mul_f32 v171, v171, v121
    v_sub_f32 v172, v172, v122
    v_sub_f32 v173, v173, v122
    v_cvt_pk_bf16_f32 v8, v172, v173
    v_sub_f32 v174, v174, v122
    v_sub_f32 v175, v175, v122
    v_cvt_pk_bf16_f32 v9, v174, v175
    v_lshlrev_b32 v172, 16, v8
    v_and_b32 v173, 0xffff0000, v8
    v_mul_f32 v172, v172, v123
    v_mul_f32 v173, v173, v123
    v_lshlrev_b32 v174, 16, v9
    v_and_b32 v175, 0xffff0000, v9
    v_mul_f32 v174, v174, v123
    v_mul_f32 v175, v175, v123
    v_sub_f32 v176, v176, v124
    v_sub_f32 v177, v177, v124
    v_cvt_pk_bf16_f32 v8, v176, v177
    v_sub_f32 v178, v178, v124
    v_sub_f32 v179, v179, v124
    v_cvt_pk_bf16_f32 v9, v178, v179
    v_lshlrev_b32 v176, 16, v8
    v_and_b32 v177, 0xffff0000, v8
    v_mul_f32 v176, v176, v125
    v_mul_f32 v177, v177, v125
    v_lshlrev_b32 v178, 16, v9
    v_and_b32 v179, 0xffff0000, v9
    v_mul_f32 v178, v178, v125
    v_mul_f32 v179, v179, v125
    v_sub_f32 v180, v180, v126
    v_sub_f32 v181, v181, v126
    v_cvt_pk_bf16_f32 v8, v180, v181
    v_sub_f32 v182, v182, v126
    v_sub_f32 v183, v183, v126
    v_cvt_pk_bf16_f32 v9, v182, v183
    v_lshlrev_b32 v180, 16, v8
    v_and_b32 v181, 0xffff0000, v8
    v_mul_f32 v180, v180, v127
    v_mul_f32 v181, v181, v127
    v_lshlrev_b32 v182, 16, v9
    v_and_b32 v183, 0xffff0000, v9
    v_mul_f32 v182, v182, v127
    v_mul_f32 v183, v183, v127
    v_sub_f32 v184, v184, v128
    v_sub_f32 v185, v185, v128
    v_cvt_pk_bf16_f32 v8, v184, v185
    v_sub_f32 v186, v186, v128
    v_sub_f32 v187, v187, v128
    v_cvt_pk_bf16_f32 v9, v186, v187
    v_lshlrev_b32 v184, 16, v8
    v_and_b32 v185, 0xffff0000, v8
    v_mul_f32 v184, v184, v129
    v_mul_f32 v185, v185, v129
    v_lshlrev_b32 v186, 16, v9
    v_and_b32 v187, 0xffff0000, v9
    v_mul_f32 v186, v186, v129
    v_mul_f32 v187, v187, v129
    v_sub_f32 v188, v188, v130
    v_sub_f32 v189, v189, v130
    v_cvt_pk_bf16_f32 v8, v188, v189
    v_sub_f32 v190, v190, v130
    v_sub_f32 v191, v191, v130
    v_cvt_pk_bf16_f32 v9, v190, v191
    v_lshlrev_b32 v188, 16, v8
    v_and_b32 v189, 0xffff0000, v8
    v_mul_f32 v188, v188, v131
    v_mul_f32 v189, v189, v131
    v_lshlrev_b32 v190, 16, v9
    v_and_b32 v191, 0xffff0000, v9
    v_mul_f32 v190, v190, v131
    v_mul_f32 v191, v191, v131
    v_sub_f32 v192, v192, v132
    v_sub_f32 v193, v193, v132
    v_cvt_pk_bf16_f32 v8, v192, v193
    v_sub_f32 v194, v194, v132
    v_sub_f32 v195, v195, v132
    v_cvt_pk_bf16_f32 v9, v194, v195
    v_lshlrev_b32 v192, 16, v8
    v_and_b32 v193, 0xffff0000, v8
    v_mul_f32 v192, v192, v133
    v_mul_f32 v193, v193, v133
    v_lshlrev_b32 v194, 16, v9
    v_and_b32 v195, 0xffff0000, v9
    v_mul_f32 v194, v194, v133
    v_mul_f32 v195, v195, v133
    v_sub_f32 v196, v196, v134
    v_sub_f32 v197, v197, v134
    v_cvt_pk_bf16_f32 v8, v196, v197
    v_sub_f32 v198, v198, v134
    v_sub_f32 v199, v199, v134
    v_cvt_pk_bf16_f32 v9, v198, v199
    v_lshlrev_b32 v196, 16, v8
    v_and_b32 v197, 0xffff0000, v8
    v_mul_f32 v196, v196, v135
    v_mul_f32 v197, v197, v135
    v_lshlrev_b32 v198, 16, v9
    v_and_b32 v199, 0xffff0000, v9
    v_mul_f32 v198, v198, v135
    v_mul_f32 v199, v199, v135
    v_cvt_pk_bf16_f32 v152, v168, v172
    v_cvt_pk_bf16_f32 v153, v176, v180
    v_cvt_pk_bf16_f32 v154, v184, v188
    v_cvt_pk_bf16_f32 v155, v192, v196
    v_cvt_pk_bf16_f32 v156, v169, v173
    v_cvt_pk_bf16_f32 v157, v177, v181
    v_cvt_pk_bf16_f32 v158, v185, v189
    v_cvt_pk_bf16_f32 v159, v193, v197
    v_cvt_pk_bf16_f32 v160, v170, v174
    v_cvt_pk_bf16_f32 v161, v178, v182
    v_cvt_pk_bf16_f32 v162, v186, v190
    v_cvt_pk_bf16_f32 v163, v194, v198
    v_cvt_pk_bf16_f32 v164, v171, v175
    v_cvt_pk_bf16_f32 v165, v179, v183
    v_cvt_pk_bf16_f32 v166, v187, v191
    v_cvt_pk_bf16_f32 v167, v195, v199
    v_subrev_u32 v6, 256, v0
    v_bfe_u32 v7, v6, 2, 2
    v_lshlrev_b32 v6, 6, v6
    v_xor_b32 v8, 0, v7
    v_lshl_add_u32 v20, v8, 4, v6
    v_add_u32 v9, 139264, v20
    ds_write_b128 v9, v[152:155]
    v_xor_b32 v8, 1, v7
    v_lshl_add_u32 v21, v8, 4, v6
    v_add_u32 v9, 139264, v21
    ds_write_b128 v9, v[156:159]
    v_xor_b32 v8, 2, v7
    v_lshl_add_u32 v22, v8, 4, v6
    v_add_u32 v9, 139264, v22
    ds_write_b128 v9, v[160:163]
    v_xor_b32 v8, 3, v7
    v_lshl_add_u32 v23, v8, 4, v6
    v_add_u32 v9, 139264, v23
    ds_write_b128 v9, v[164:167]
    v_mov_b32 v8, 0
    v_mov_b32 v9, 0
    v_subrev_u32 v6, 256, v0
    v_lshlrev_b32 v6, 3, v6
    v_add_u32 v6, 137216, v6
    ds_write_b64 v6, v[8:9]
L_CV_B2:
    s_waitcnt lgkmcnt(0)
    s_barrier
    s_cmp_ge_u32 s3, 4
    s_cbranch_scc1 L_CV_HELP
    s_mul_i32 s15, s3, 34272
    v_and_b32 v8, 3, v2
    v_sub_u32 v8, 3, v8
    v_mul_u32_u24 v8, 4160, v8
    v_lshrrev_b32 v9, 2, v2
    v_lshlrev_b32 v9, 3, v9
    v_lshl_add_u32 v9, v3, 4, v9
    v_sub_u32 v9, 72, v9
    v_add3_u32 v10, v8, v9, s15
    v_lshlrev_b32 v8, 1, v2
    v_add_u32 v8, 1, v8
    v_sub_u32 v8, v8, v3
    v_ashrrev_i32 v9, 2, v8
    v_lshlrev_b32 v8, 6, v8
    v_add_u32 v8, 137472, v8
    v_subrev_u32 v11, 0, v9
    v_and_b32 v11, 3, v11
    v_xor_b32 v11, s3, v11
    v_lshl_add_u32 v12, v11, 4, v8
    v_subrev_u32 v11, 1, v9
    v_and_b32 v11, 3, v11
    v_xor_b32 v11, s3, v11
    v_lshl_add_u32 v13, v11, 4, v8
    v_subrev_u32 v11, 2, v9
    v_and_b32 v11, 3, v11
    v_xor_b32 v11, s3, v11
    v_lshl_add_u32 v14, v11, 4, v8
    v_subrev_u32 v11, 3, v9
    v_and_b32 v11, 3, v11
    v_xor_b32 v11, s3, v11
    v_lshl_add_u32 v15, v11, 4, v8
    ds_read_b64 v[24:25], v10 offset:4032
    ds_read_b64 v[26:27], v10 offset:4040
    ds_read_b128 v[56:59], v12 offset:1792
    ds_read_b64 v[28:29], v10 offset:3520
    ds_read_b64 v[30:31], v10 offset:3528
    ds_read_b128 v[60:63], v12 offset:3840
    ds_read_b64 v[32:33], v10 offset:3008
    ds_read_b64 v[34:35], v10 offset:3016
    ds_read_b128 v[64:67], v12 offset:5888
    ds_read_b64 v[36:37], v10 offset:2496
    ds_read_b64 v[38:39], v10 offset:2504
    ds_read_b128 v[68:71], v12 offset:7936
    ds_read_b64 v[40:41], v10 offset:1984
    ds_read_b64 v[42:43], v10 offset:1992
    ds_read_b128 v[72:75], v12 offset:9984
    ds_read_b64 v[44:45], v10 offset:1472
    ds_read_b64 v[46:47], v10 offset:1480
    ds_read_b128 v[76:79], v12 offset:12032
    ds_read_b64 v[48:49], v10 offset:960
    ds_read_b64 v[50:51], v10 offset:968
    ds_read_b128 v[80:83], v12 offset:14080
    ds_read_b64 v[52:53], v10 offset:448
    ds_read_b64 v[54:55], v10 offset:456
    ds_read_b128 v[84:87], v12 offset:16128
    v_lshrrev_b32 v16, 1, v3
    v_lshl_add_u32 v16, v2, 1, v16
    v_bfe_u32 v17, v16, 2, 2
    v_xor_b32 v17, s3, v17
    v_lshlrev_b32 v16, 6, v16
    v_lshl_add_u32 v16, v17, 4, v16
    v_and_b32 v17, 1, v3
    v_lshl_add_u32 v16, v17, 3, v16
    v_add_u32 v16, 50944, v16
    s_waitcnt lgkmcnt(0)
    v_mfma_f32_16x16x32_bf16 v[160:163], v[24:27], v[56:59], 0
    ds_read_b64 v[88:89], v10 offset:3968
    v_mfma_f32_16x16x32_bf16 v[164:167], v[24:27], v[60:63], 0
    ds_read_b64 v[90:91], v10 offset:3976
    v_mfma_f32_16x16x32_bf16 v[164:167], v[28:31], v[56:59], v[164:167]
    ds_read_b128 v[120:123], v13 offset:1536
    v_mfma_f32_16x16x32_bf16 v[168:171], v[24:27], v[64:67], 0
    ds_read_b64 v[92:93], v10 offset:3456
    v_mfma_f32_16x16x32_bf16 v[168:171], v[28:31], v[60:63], v[168:171]
    ds_read_b64 v[94:95], v10 offset:3464
    v_mfma_f32_16x16x32_bf16 v[168:171], v[32:35], v[56:59], v[168:171]
    ds_read_b128 v[124:127], v13 offset:3584
    v_mfma_f32_16x16x32_bf16 v[172:175], v[24:27], v[68:71], 0
    ds_read_b64 v[96:97], v10 offset:2944
    v_mfma_f32_16x16x32_bf16 v[172:175], v[28:31], v[64:67], v[172:175]
    ds_read_b64 v[98:99], v10 offset:2952
    v_mfma_f32_16x16x32_bf16 v[172:175], v[32:35], v[60:63], v[172:175]
    ds_read_b128 v[128:131], v13 offset:5632
    v_mfma_f32_16x16x32_bf16 v[172:175], v[36:39], v[56:59], v[172:175]
    ds_read_b64 v[100:101], v10 offset:2432
    v_mfma_f32_16x16x32_bf16 v[176:179], v[24:27], v[72:75], 0
    ds_read_b64 v[102:103], v10 offset:2440
    v_mfma_f32_16x16x32_bf16 v[176:179], v[28:31], v[68:71], v[176:179]
    ds_read_b128 v[132:135], v13 offset:7680
    v_mfma_f32_16x16x32_bf16 v[176:179], v[32:35], v[64:67], v[176:179]
    ds_read_b64 v[104:105], v10 offset:1920
    v_mfma_f32_16x16x32_bf16 v[176:179], v[36:39], v[60:63], v[176:179]
    ds_read_b64 v[106:107], v10 offset:1928
    v_mfma_f32_16x16x32_bf16 v[176:179], v[40:43], v[56:59], v[176:179]
    ds_read_b128 v[136:139], v13 offset:9728
    v_mfma_f32_16x16x32_bf16 v[180:183], v[24:27], v[76:79], 0
    ds_read_b64 v[108:109], v10 offset:1408
    v_mfma_f32_16x16x32_bf16 v[180:183], v[28:31], v[72:75], v[180:183]
    ds_read_b64 v[110:111], v10 offset:1416
    v_mfma_f32_16x16x32_bf16 v[180:183], v[32:35], v[68:71], v[180:183]
    ds_read_b128 v[140:143], v13 offset:11776
    v_mfma_f32_16x16x32_bf16 v[180:183], v[36:39], v[64:67], v[180:183]
    ds_read_b64 v[112:113], v10 offset:896
    v_mfma_f32_16x16x32_bf16 v[180:183], v[40:43], v[60:63], v[180:183]
    ds_read_b64 v[114:115], v10 offset:904
    v_mfma_f32_16x16x32_bf16 v[180:183], v[44:47], v[56:59], v[180:183]
    ds_read_b128 v[144:147], v13 offset:13824
    v_mfma_f32_16x16x32_bf16 v[184:187], v[24:27], v[80:83], 0
    ds_read_b64 v[116:117], v10 offset:384
    v_mfma_f32_16x16x32_bf16 v[184:187], v[28:31], v[76:79], v[184:187]
    ds_read_b64 v[118:119], v10 offset:392
    v_mfma_f32_16x16x32_bf16 v[184:187], v[32:35], v[72:75], v[184:187]
    ds_read_b128 v[148:151], v13 offset:15872
    v_mfma_f32_16x16x32_bf16 v[184:187], v[36:39], v[68:71], v[184:187]
    v_mfma_f32_16x16x32_bf16 v[184:187], v[40:43], v[64:67], v[184:187]
    v_mfma_f32_16x16x32_bf16 v[184:187], v[44:47], v[60:63], v[184:187]
    v_mfma_f32_16x16x32_bf16 v[184:187], v[48:51], v[56:59], v[184:187]
    v_mfma_f32_16x16x32_bf16 v[188:191], v[24:27], v[84:87], 0
    v_mfma_f32_16x16x32_bf16 v[188:191], v[28:31], v[80:83], v[188:191]
    v_mfma_f32_16x16x32_bf16 v[188:191], v[32:35], v[76:79], v[188:191]
    v_mfma_f32_16x16x32_bf16 v[188:191], v[36:39], v[72:75], v[188:191]
    v_mfma_f32_16x16x32_bf16 v[188:191], v[40:43], v[68:71], v[188:191]
    v_mfma_f32_16x16x32_bf16 v[188:191], v[44:47], v[64:67], v[188:191]
    v_mfma_f32_16x16x32_bf16 v[188:191], v[48:51], v[60:63], v[188:191]
    v_mfma_f32_16x16x32_bf16 v[188:191], v[52:55], v[56:59], v[188:191]
    s_waitcnt lgkmcnt(0)
    v_mfma_f32_16x16x32_bf16 v[160:163], v[88:91], v[120:123], v[160:163]
    ds_read_b64 v[24:25], v10 offset:3904
    v_mfma_f32_16x16x32_bf16 v[164:167], v[88:91], v[124:127], v[164:167]
    ds_read_b64 v[26:27], v10 offset:3912
    v_mfma_f32_16x16x32_bf16 v[164:167], v[92:95], v[120:123], v[164:167]
    ds_read_b128 v[56:59], v14 offset:1280
    v_mfma_f32_16x16x32_bf16 v[168:171], v[88:91], v[128:131], v[168:171]
    ds_read_b64 v[28:29], v10 offset:3392
    v_mfma_f32_16x16x32_bf16 v[168:171], v[92:95], v[124:127], v[168:171]
    ds_read_b64 v[30:31], v10 offset:3400
    v_mfma_f32_16x16x32_bf16 v[168:171], v[96:99], v[120:123], v[168:171]
    ds_read_b128 v[60:63], v14 offset:3328
    v_mfma_f32_16x16x32_bf16 v[172:175], v[88:91], v[132:135], v[172:175]
    ds_read_b64 v[32:33], v10 offset:2880
    v_mfma_f32_16x16x32_bf16 v[172:175], v[92:95], v[128:131], v[172:175]
    ds_read_b64 v[34:35], v10 offset:2888
    v_mfma_f32_16x16x32_bf16 v[172:175], v[96:99], v[124:127], v[172:175]
    ds_read_b128 v[64:67], v14 offset:5376
    v_mfma_f32_16x16x32_bf16 v[172:175], v[100:103], v[120:123], v[172:175]
    ds_read_b64 v[36:37], v10 offset:2368
    v_mfma_f32_16x16x32_bf16 v[176:179], v[88:91], v[136:139], v[176:179]
    ds_read_b64 v[38:39], v10 offset:2376
    v_mfma_f32_16x16x32_bf16 v[176:179], v[92:95], v[132:135], v[176:179]
    ds_read_b128 v[68:71], v14 offset:7424
    v_mfma_f32_16x16x32_bf16 v[176:179], v[96:99], v[128:131], v[176:179]
    ds_read_b64 v[40:41], v10 offset:1856
    v_mfma_f32_16x16x32_bf16 v[176:179], v[100:103], v[124:127], v[176:179]
    ds_read_b64 v[42:43], v10 offset:1864
    v_mfma_f32_16x16x32_bf16 v[176:179], v[104:107], v[120:123], v[176:179]
    ds_read_b128 v[72:75], v14 offset:9472
    v_mfma_f32_16x16x32_bf16 v[180:183], v[88:91], v[140:143], v[180:183]
    ds_read_b64 v[44:45], v10 offset:1344
    v_mfma_f32_16x16x32_bf16 v[180:183], v[92:95], v[136:139], v[180:183]
    ds_read_b64 v[46:47], v10 offset:1352
    v_mfma_f32_16x16x32_bf16 v[180:183], v[96:99], v[132:135], v[180:183]
    ds_read_b128 v[76:79], v14 offset:11520
    v_mfma_f32_16x16x32_bf16 v[180:183], v[100:103], v[128:131], v[180:183]
    ds_read_b64 v[48:49], v10 offset:832
    v_mfma_f32_16x16x32_bf16 v[180:183], v[104:107], v[124:127], v[180:183]
    ds_read_b64 v[50:51], v10 offset:840
    v_mfma_f32_16x16x32_bf16 v[180:183], v[108:111], v[120:123], v[180:183]
    ds_read_b128 v[80:83], v14 offset:13568
    v_mfma_f32_16x16x32_bf16 v[184:187], v[88:91], v[144:147], v[184:187]
    ds_read_b64 v[52:53], v10 offset:320
    v_mfma_f32_16x16x32_bf16 v[184:187], v[92:95], v[140:143], v[184:187]
    ds_read_b64 v[54:55], v10 offset:328
    v_mfma_f32_16x16x32_bf16 v[184:187], v[96:99], v[136:139], v[184:187]
    ds_read_b128 v[84:87], v14 offset:15616
    v_mfma_f32_16x16x32_bf16 v[184:187], v[100:103], v[132:135], v[184:187]
    v_mfma_f32_16x16x32_bf16 v[184:187], v[104:107], v[128:131], v[184:187]
    v_mfma_f32_16x16x32_bf16 v[184:187], v[108:111], v[124:127], v[184:187]
    v_mfma_f32_16x16x32_bf16 v[184:187], v[112:115], v[120:123], v[184:187]
    v_mfma_f32_16x16x32_bf16 v[188:191], v[88:91], v[148:151], v[188:191]
    v_mfma_f32_16x16x32_bf16 v[188:191], v[92:95], v[144:147], v[188:191]
    v_mfma_f32_16x16x32_bf16 v[188:191], v[96:99], v[140:143], v[188:191]
    v_mfma_f32_16x16x32_bf16 v[188:191], v[100:103], v[136:139], v[188:191]
    v_mfma_f32_16x16x32_bf16 v[188:191], v[104:107], v[132:135], v[188:191]
    v_mfma_f32_16x16x32_bf16 v[188:191], v[108:111], v[128:131], v[188:191]
    v_mfma_f32_16x16x32_bf16 v[188:191], v[112:115], v[124:127], v[188:191]
    v_mfma_f32_16x16x32_bf16 v[188:191], v[116:119], v[120:123], v[188:191]
    s_waitcnt lgkmcnt(0)
    v_mfma_f32_16x16x32_bf16 v[160:163], v[24:27], v[56:59], v[160:163]
    ds_read_b64 v[88:89], v10 offset:3840
    v_mfma_f32_16x16x32_bf16 v[164:167], v[24:27], v[60:63], v[164:167]
    ds_read_b64 v[90:91], v10 offset:3848
    v_mfma_f32_16x16x32_bf16 v[164:167], v[28:31], v[56:59], v[164:167]
    ds_read_b128 v[120:123], v15 offset:1024
    v_mfma_f32_16x16x32_bf16 v[168:171], v[24:27], v[64:67], v[168:171]
    ds_read_b64 v[92:93], v10 offset:3328
    v_mfma_f32_16x16x32_bf16 v[168:171], v[28:31], v[60:63], v[168:171]
    ds_read_b64 v[94:95], v10 offset:3336
    v_mfma_f32_16x16x32_bf16 v[168:171], v[32:35], v[56:59], v[168:171]
    ds_read_b128 v[124:127], v15 offset:3072
    v_mfma_f32_16x16x32_bf16 v[172:175], v[24:27], v[68:71], v[172:175]
    ds_read_b64 v[96:97], v10 offset:2816
    v_mfma_f32_16x16x32_bf16 v[172:175], v[28:31], v[64:67], v[172:175]
    ds_read_b64 v[98:99], v10 offset:2824
    v_mfma_f32_16x16x32_bf16 v[172:175], v[32:35], v[60:63], v[172:175]
    ds_read_b128 v[128:131], v15 offset:5120
    v_mfma_f32_16x16x32_bf16 v[172:175], v[36:39], v[56:59], v[172:175]
    ds_read_b64 v[100:101], v10 offset:2304
    v_mfma_f32_16x16x32_bf16 v[176:179], v[24:27], v[72:75], v[176:179]
    ds_read_b64 v[102:103], v10 offset:2312
    v_mfma_f32_16x16x32_bf16 v[176:179], v[28:31], v[68:71], v[176:179]
    ds_read_b128 v[132:135], v15 offset:7168
    v_mfma_f32_16x16x32_bf16 v[176:179], v[32:35], v[64:67], v[176:179]
    ds_read_b64 v[104:105], v10 offset:1792
    v_mfma_f32_16x16x32_bf16 v[176:179], v[36:39], v[60:63], v[176:179]
    ds_read_b64 v[106:107], v10 offset:1800
    v_mfma_f32_16x16x32_bf16 v[176:179], v[40:43], v[56:59], v[176:179]
    ds_read_b128 v[136:139], v15 offset:9216
    v_mfma_f32_16x16x32_bf16 v[180:183], v[24:27], v[76:79], v[180:183]
    ds_read_b64 v[108:109], v10 offset:1280
    v_mfma_f32_16x16x32_bf16 v[180:183], v[28:31], v[72:75], v[180:183]
    ds_read_b64 v[110:111], v10 offset:1288
    v_mfma_f32_16x16x32_bf16 v[180:183], v[32:35], v[68:71], v[180:183]
    ds_read_b128 v[140:143], v15 offset:11264
    v_mfma_f32_16x16x32_bf16 v[180:183], v[36:39], v[64:67], v[180:183]
    ds_read_b64 v[112:113], v10 offset:768
    v_mfma_f32_16x16x32_bf16 v[180:183], v[40:43], v[60:63], v[180:183]
    ds_read_b64 v[114:115], v10 offset:776
    v_mfma_f32_16x16x32_bf16 v[180:183], v[44:47], v[56:59], v[180:183]
    ds_read_b128 v[144:147], v15 offset:13312
    v_mfma_f32_16x16x32_bf16 v[184:187], v[24:27], v[80:83], v[184:187]
    ds_read_b64 v[116:117], v10 offset:256
    v_mfma_f32_16x16x32_bf16 v[184:187], v[28:31], v[76:79], v[184:187]
    ds_read_b64 v[118:119], v10 offset:264
    v_mfma_f32_16x16x32_bf16 v[184:187], v[32:35], v[72:75], v[184:187]
    ds_read_b128 v[148:151], v15 offset:15360
    v_mfma_f32_16x16x32_bf16 v[184:187], v[36:39], v[68:71], v[184:187]
    v_mfma_f32_16x16x32_bf16 v[184:187], v[40:43], v[64:67], v[184:187]
    v_mfma_f32_16x16x32_bf16 v[184:187], v[44:47], v[60:63], v[184:187]
    v_mfma_f32_16x16x32_bf16 v[184:187], v[48:51], v[56:59], v[184:187]
    v_mfma_f32_16x16x32_bf16 v[188:191], v[24:27], v[84:87], v[188:191]
    v_mfma_f32_16x16x32_bf16 v[188:191], v[28:31], v[80:83], v[188:191]
    v_mfma_f32_16x16x32_bf16 v[188:191], v[32:35], v[76:79], v[188:191]
    v_mfma_f32_16x16x32_bf16 v[188:191], v[36:39], v[72:75], v[188:191]
    v_mfma_f32_16x16x32_bf16 v[188:191], v[40:43], v[68:71], v[188:191]
    v_mfma_f32_16x16x32_bf16 v[188:191], v[44:47], v[64:67], v[188:191]
    v_mfma_f32_16x16x32_bf16 v[188:191], v[48:51], v[60:63], v[188:191]
    v_mfma_f32_16x16x32_bf16 v[188:191], v[52:55], v[56:59], v[188:191]
    s_waitcnt lgkmcnt(0)
    v_mfma_f32_16x16x32_bf16 v[160:163], v[88:91], v[120:123], v[160:163]
    ds_read_b64 v[24:25], v10 offset:3776
    v_mfma_f32_16x16x32_bf16 v[164:167], v[88:91], v[124:127], v[164:167]
    ds_read_b64 v[26:27], v10 offset:3784
    v_mfma_f32_16x16x32_bf16 v[164:167], v[92:95], v[120:123], v[164:167]
    ds_read_b128 v[56:59], v12 offset:768
    v_mfma_f32_16x16x32_bf16 v[168:171], v[88:91], v[128:131], v[168:171]
    ds_read_b64 v[28:29], v10 offset:3264
    v_mfma_f32_16x16x32_bf16 v[168:171], v[92:95], v[124:127], v[168:171]
    ds_read_b64 v[30:31], v10 offset:3272
    v_mfma_f32_16x16x32_bf16 v[168:171], v[96:99], v[120:123], v[168:171]
    ds_read_b128 v[60:63], v12 offset:2816
    v_mfma_f32_16x16x32_bf16 v[172:175], v[88:91], v[132:135], v[172:175]
    ds_read_b64 v[32:33], v10 offset:2752
    v_mfma_f32_16x16x32_bf16 v[172:175], v[92:95], v[128:131], v[172:175]
    ds_read_b64 v[34:35], v10 offset:2760
    v_mfma_f32_16x16x32_bf16 v[172:175], v[96:99], v[124:127], v[172:175]
    ds_read_b128 v[64:67], v12 offset:4864
    v_mfma_f32_16x16x32_bf16 v[172:175], v[100:103], v[120:123], v[172:175]
    ds_read_b64 v[36:37], v10 offset:2240
    v_mfma_f32_16x16x32_bf16 v[176:179], v[88:91], v[136:139], v[176:179]
    ds_read_b64 v[38:39], v10 offset:2248
    v_mfma_f32_16x16x32_bf16 v[176:179], v[92:95], v[132:135], v[176:179]
    ds_read_b128 v[68:71], v12 offset:6912
    v_mfma_f32_16x16x32_bf16 v[176:179], v[96:99], v[128:131], v[176:179]
    ds_read_b64 v[40:41], v10 offset:1728
    v_mfma_f32_16x16x32_bf16 v[176:179], v[100:103], v[124:127], v[176:179]
    ds_read_b64 v[42:43], v10 offset:1736
    v_mfma_f32_16x16x32_bf16 v[176:179], v[104:107], v[120:123], v[176:179]
    ds_read_b128 v[72:75], v12 offset:8960
    v_mfma_f32_16x16x32_bf16 v[180:183], v[88:91], v[140:143], v[180:183]
    ds_read_b64 v[44:45], v10 offset:1216
    v_mfma_f32_16x16x32_bf16 v[180:183], v[92:95], v[136:139], v[180:183]
    ds_read_b64 v[46:47], v10 offset:1224
    v_mfma_f32_16x16x32_bf16 v[180:183], v[96:99], v[132:135], v[180:183]
    ds_read_b128 v[76:79], v12 offset:11008
    v_mfma_f32_16x16x32_bf16 v[180:183], v[100:103], v[128:131], v[180:183]
    ds_read_b64 v[48:49], v10 offset:704
    v_mfma_f32_16x16x32_bf16 v[180:183], v[104:107], v[124:127], v[180:183]
    ds_read_b64 v[50:51], v10 offset:712
    v_mfma_f32_16x16x32_bf16 v[180:183], v[108:111], v[120:123], v[180:183]
    ds_read_b128 v[80:83], v12 offset:13056
    v_mfma_f32_16x16x32_bf16 v[184:187], v[88:91], v[144:147], v[184:187]
    ds_read_b64 v[52:53], v10 offset:192
    v_mfma_f32_16x16x32_bf16 v[184:187], v[92:95], v[140:143], v[184:187]
    ds_read_b64 v[54:55], v10 offset:200
    v_mfma_f32_16x16x32_bf16 v[184:187], v[96:99], v[136:139], v[184:187]
    ds_read_b128 v[84:87], v12 offset:15104
    v_mfma_f32_16x16x32_bf16 v[184:187], v[100:103], v[132:135], v[184:187]
    v_mfma_f32_16x16x32_bf16 v[184:187], v[104:107], v[128:131], v[184:187]
    v_mfma_f32_16x16x32_bf16 v[184:187], v[108:111], v[124:127], v[184:187]
    v_mfma_f32_16x16x32_bf16 v[184:187], v[112:115], v[120:123], v[184:187]
    v_mfma_f32_16x16x32_bf16 v[188:191], v[88:91], v[148:151], v[188:191]
    v_mfma_f32_16x16x32_bf16 v[188:191], v[92:95], v[144:147], v[188:191]
    v_mfma_f32_16x16x32_bf16 v[188:191], v[96:99], v[140:143], v[188:191]
    v_mfma_f32_16x16x32_bf16 v[188:191], v[100:103], v[136:139], v[188:191]
    v_mfma_f32_16x16x32_bf16 v[188:191], v[104:107], v[132:135], v[188:191]
    v_mfma_f32_16x16x32_bf16 v[188:191], v[108:111], v[128:131], v[188:191]
    v_mfma_f32_16x16x32_bf16 v[188:191], v[112:115], v[124:127], v[188:191]
    v_mfma_f32_16x16x32_bf16 v[188:191], v[116:119], v[120:123], v[188:191]
    s_waitcnt lgkmcnt(0)
    v_mfma_f32_16x16x32_bf16 v[160:163], v[24:27], v[56:59], v[160:163]
    ds_read_b64 v[88:89], v10 offset:3712
    v_mfma_f32_16x16x32_bf16 v[164:167], v[24:27], v[60:63], v[164:167]
    ds_read_b64 v[90:91], v10 offset:3720
    v_mfma_f32_16x16x32_bf16 v[164:167], v[28:31], v[56:59], v[164:167]
    ds_read_b128 v[120:123], v13 offset:512
    v_mfma_f32_16x16x32_bf16 v[168:171], v[24:27], v[64:67], v[168:171]
    ds_read_b64 v[92:93], v10 offset:3200
    v_mfma_f32_16x16x32_bf16 v[168:171], v[28:31], v[60:63], v[168:171]
    ds_read_b64 v[94:95], v10 offset:3208
    v_mfma_f32_16x16x32_bf16 v[168:171], v[32:35], v[56:59], v[168:171]
    ds_read_b128 v[124:127], v13 offset:2560
    v_mfma_f32_16x16x32_bf16 v[172:175], v[24:27], v[68:71], v[172:175]
    ds_read_b64 v[96:97], v10 offset:2688
    v_mfma_f32_16x16x32_bf16 v[172:175], v[28:31], v[64:67], v[172:175]
    ds_read_b64 v[98:99], v10 offset:2696
    v_mfma_f32_16x16x32_bf16 v[172:175], v[32:35], v[60:63], v[172:175]
    ds_read_b128 v[128:131], v13 offset:4608
    v_mfma_f32_16x16x32_bf16 v[172:175], v[36:39], v[56:59], v[172:175]
    ds_read_b64 v[100:101], v10 offset:2176
    v_mfma_f32_16x16x32_bf16 v[176:179], v[24:27], v[72:75], v[176:179]
    ds_read_b64 v[102:103], v10 offset:2184
    v_mfma_f32_16x16x32_bf16 v[176:179], v[28:31], v[68:71], v[176:179]
    ds_read_b128 v[132:135], v13 offset:6656
    v_mfma_f32_16x16x32_bf16 v[176:179], v[32:35], v[64:67], v[176:179]
    ds_read_b64 v[104:105], v10 offset:1664
    v_mfma_f32_16x16x32_bf16 v[176:179], v[36:39], v[60:63], v[176:179]
    ds_read_b64 v[106:107], v10 offset:1672
    v_mfma_f32_16x16x32_bf16 v[176:179], v[40:43], v[56:59], v[176:179]
    ds_read_b128 v[136:139], v13 offset:8704
    v_mfma_f32_16x16x32_bf16 v[180:183], v[24:27], v[76:79], v[180:183]
    ds_read_b64 v[108:109], v10 offset:1152
    v_mfma_f32_16x16x32_bf16 v[180:183], v[28:31], v[72:75], v[180:183]
    ds_read_b64 v[110:111], v10 offset:1160
    v_mfma_f32_16x16x32_bf16 v[180:183], v[32:35], v[68:71], v[180:183]
    ds_read_b128 v[140:143], v13 offset:10752
    v_mfma_f32_16x16x32_bf16 v[180:183], v[36:39], v[64:67], v[180:183]
    ds_read_b64 v[112:113], v10 offset:640
    v_mfma_f32_16x16x32_bf16 v[180:183], v[40:43], v[60:63], v[180:183]
    ds_read_b64 v[114:115], v10 offset:648
    v_mfma_f32_16x16x32_bf16 v[180:183], v[44:47], v[56:59], v[180:183]
    ds_read_b128 v[144:147], v13 offset:12800
    v_mfma_f32_16x16x32_bf16 v[184:187], v[24:27], v[80:83], v[184:187]
    ds_read_b64 v[116:117], v10 offset:128
    v_mfma_f32_16x16x32_bf16 v[184:187], v[28:31], v[76:79], v[184:187]
    ds_read_b64 v[118:119], v10 offset:136
    v_mfma_f32_16x16x32_bf16 v[184:187], v[32:35], v[72:75], v[184:187]
    ds_read_b128 v[148:151], v13 offset:14848
    v_mfma_f32_16x16x32_bf16 v[184:187], v[36:39], v[68:71], v[184:187]
    v_mfma_f32_16x16x32_bf16 v[184:187], v[40:43], v[64:67], v[184:187]
    v_mfma_f32_16x16x32_bf16 v[184:187], v[44:47], v[60:63], v[184:187]
    v_mfma_f32_16x16x32_bf16 v[184:187], v[48:51], v[56:59], v[184:187]
    v_mfma_f32_16x16x32_bf16 v[188:191], v[24:27], v[84:87], v[188:191]
    v_mfma_f32_16x16x32_bf16 v[188:191], v[28:31], v[80:83], v[188:191]
    v_mfma_f32_16x16x32_bf16 v[188:191], v[32:35], v[76:79], v[188:191]
    v_mfma_f32_16x16x32_bf16 v[188:191], v[36:39], v[72:75], v[188:191]
    v_mfma_f32_16x16x32_bf16 v[188:191], v[40:43], v[68:71], v[188:191]
    v_mfma_f32_16x16x32_bf16 v[188:191], v[44:47], v[64:67], v[188:191]
    v_mfma_f32_16x16x32_bf16 v[188:191], v[48:51], v[60:63], v[188:191]
    v_mfma_f32_16x16x32_bf16 v[188:191], v[52:55], v[56:59], v[188:191]
    s_waitcnt lgkmcnt(0)
    v_mfma_f32_16x16x32_bf16 v[160:163], v[88:91], v[120:123], v[160:163]
    ds_read_b64 v[24:25], v10 offset:3648
    v_mfma_f32_16x16x32_bf16 v[164:167], v[88:91], v[124:127], v[164:167]
    ds_read_b64 v[26:27], v10 offset:3656
    v_mfma_f32_16x16x32_bf16 v[164:167], v[92:95], v[120:123], v[164:167]
    ds_read_b128 v[56:59], v14 offset:256
    v_mfma_f32_16x16x32_bf16 v[168:171], v[88:91], v[128:131], v[168:171]
    ds_read_b64 v[28:29], v10 offset:3136
    v_mfma_f32_16x16x32_bf16 v[168:171], v[92:95], v[124:127], v[168:171]
    ds_read_b64 v[30:31], v10 offset:3144
    v_mfma_f32_16x16x32_bf16 v[168:171], v[96:99], v[120:123], v[168:171]
    ds_read_b128 v[60:63], v14 offset:2304
    v_mfma_f32_16x16x32_bf16 v[172:175], v[88:91], v[132:135], v[172:175]
    ds_read_b64 v[32:33], v10 offset:2624
    v_mfma_f32_16x16x32_bf16 v[172:175], v[92:95], v[128:131], v[172:175]
    ds_read_b64 v[34:35], v10 offset:2632
    v_mfma_f32_16x16x32_bf16 v[172:175], v[96:99], v[124:127], v[172:175]
    ds_read_b128 v[64:67], v14 offset:4352
    v_mfma_f32_16x16x32_bf16 v[172:175], v[100:103], v[120:123], v[172:175]
    ds_read_b64 v[36:37], v10 offset:2112
    v_mfma_f32_16x16x32_bf16 v[176:179], v[88:91], v[136:139], v[176:179]
    ds_read_b64 v[38:39], v10 offset:2120
    v_mfma_f32_16x16x32_bf16 v[176:179], v[92:95], v[132:135], v[176:179]
    ds_read_b128 v[68:71], v14 offset:6400
    v_mfma_f32_16x16x32_bf16 v[176:179], v[96:99], v[128:131], v[176:179]
    ds_read_b64 v[40:41], v10 offset:1600
    v_mfma_f32_16x16x32_bf16 v[176:179], v[100:103], v[124:127], v[176:179]
    ds_read_b64 v[42:43], v10 offset:1608
    v_mfma_f32_16x16x32_bf16 v[176:179], v[104:107], v[120:123], v[176:179]
    ds_read_b128 v[72:75], v14 offset:8448
    v_mfma_f32_16x16x32_bf16 v[180:183], v[88:91], v[140:143], v[180:183]
    ds_read_b64 v[44:45], v10 offset:1088
    v_mfma_f32_16x16x32_bf16 v[180:183], v[92:95], v[136:139], v[180:183]
    ds_read_b64 v[46:47], v10 offset:1096
    v_mfma_f32_16x16x32_bf16 v[180:183], v[96:99], v[132:135], v[180:183]
    ds_read_b128 v[76:79], v14 offset:10496
    v_mfma_f32_16x16x32_bf16 v[180:183], v[100:103], v[128:131], v[180:183]
    ds_read_b64 v[48:49], v10 offset:576
    v_mfma_f32_16x16x32_bf16 v[180:183], v[104:107], v[124:127], v[180:183]
    ds_read_b64 v[50:51], v10 offset:584
    v_mfma_f32_16x16x32_bf16 v[180:183], v[108:111], v[120:123], v[180:183]
    ds_read_b128 v[80:83], v14 offset:12544
    v_mfma_f32_16x16x32_bf16 v[184:187], v[88:91], v[144:147], v[184:187]
    ds_read_b64 v[52:53], v10 offset:64
    v_mfma_f32_16x16x32_bf16 v[184:187], v[92:95], v[140:143], v[184:187]
    ds_read_b64 v[54:55], v10 offset:72
    v_mfma_f32_16x16x32_bf16 v[184:187], v[96:99], v[136:139], v[184:187]
    ds_read_b128 v[84:87], v14 offset:14592
    v_mfma_f32_16x16x32_bf16 v[184:187], v[100:103], v[132:135], v[184:187]
    v_mfma_f32_16x16x32_bf16 v[184:187], v[104:107], v[128:131], v[184:187]
    v_mfma_f32_16x16x32_bf16 v[184:187], v[108:111], v[124:127], v[184:187]
    v_mfma_f32_16x16x32_bf16 v[184:187], v[112:115], v[120:123], v[184:187]
    v_mfma_f32_16x16x32_bf16 v[188:191], v[88:91], v[148:151], v[188:191]
    v_mfma_f32_16x16x32_bf16 v[188:191], v[92:95], v[144:147], v[188:191]
    v_mfma_f32_16x16x32_bf16 v[188:191], v[96:99], v[140:143], v[188:191]
    v_mfma_f32_16x16x32_bf16 v[188:191], v[100:103], v[136:139], v[188:191]
    v_mfma_f32_16x16x32_bf16 v[188:191], v[104:107], v[132:135], v[188:191]
    v_mfma_f32_16x16x32_bf16 v[188:191], v[108:111], v[128:131], v[188:191]
    v_mfma_f32_16x16x32_bf16 v[188:191], v[112:115], v[124:127], v[188:191]
    v_mfma_f32_16x16x32_bf16 v[188:191], v[116:119], v[120:123], v[188:191]
    s_waitcnt lgkmcnt(0)
    v_mfma_f32_16x16x32_bf16 v[160:163], v[24:27], v[56:59], v[160:163]
    ds_read_b64 v[88:89], v10 offset:3584
    v_mfma_f32_16x16x32_bf16 v[164:167], v[24:27], v[60:63], v[164:167]
    ds_read_b64 v[90:91], v10 offset:3592
    v_mfma_f32_16x16x32_bf16 v[164:167], v[28:31], v[56:59], v[164:167]
    ds_read_b128 v[120:123], v15 offset:0
    v_mfma_f32_16x16x32_bf16 v[168:171], v[24:27], v[64:67], v[168:171]
    ds_read_b64 v[92:93], v10 offset:3072
    v_mfma_f32_16x16x32_bf16 v[168:171], v[28:31], v[60:63], v[168:171]
    ds_read_b64 v[94:95], v10 offset:3080
    v_mfma_f32_16x16x32_bf16 v[168:171], v[32:35], v[56:59], v[168:171]
    ds_read_b128 v[124:127], v15 offset:2048
    v_mfma_f32_16x16x32_bf16 v[172:175], v[24:27], v[68:71], v[172:175]
    ds_read_b64 v[96:97], v10 offset:2560
    v_mfma_f32_16x16x32_bf16 v[172:175], v[28:31], v[64:67], v[172:175]
    ds_read_b64 v[98:99], v10 offset:2568
    v_mfma_f32_16x16x32_bf16 v[172:175], v[32:35], v[60:63], v[172:175]
    ds_read_b128 v[128:131], v15 offset:4096
    v_mfma_f32_16x16x32_bf16 v[172:175], v[36:39], v[56:59], v[172:175]
    ds_read_b64 v[100:101], v10 offset:2048
    v_mfma_f32_16x16x32_bf16 v[176:179], v[24:27], v[72:75], v[176:179]
    ds_read_b64 v[102:103], v10 offset:2056
    v_mfma_f32_16x16x32_bf16 v[176:179], v[28:31], v[68:71], v[176:179]
    ds_read_b128 v[132:135], v15 offset:6144
    v_mfma_f32_16x16x32_bf16 v[176:179], v[32:35], v[64:67], v[176:179]
    ds_read_b64 v[104:105], v10 offset:1536
    v_mfma_f32_16x16x32_bf16 v[176:179], v[36:39], v[60:63], v[176:179]
    ds_read_b64 v[106:107], v10 offset:1544
    v_mfma_f32_16x16x32_bf16 v[176:179], v[40:43], v[56:59], v[176:179]
    ds_read_b128 v[136:139], v15 offset:8192
    v_mfma_f32_16x16x32_bf16 v[180:183], v[24:27], v[76:79], v[180:183]
    ds_read_b64 v[108:109], v10 offset:1024
    v_mfma_f32_16x16x32_bf16 v[180:183], v[28:31], v[72:75], v[180:183]
    ds_read_b64 v[110:111], v10 offset:1032
    v_mfma_f32_16x16x32_bf16 v[180:183], v[32:35], v[68:71], v[180:183]
    ds_read_b128 v[140:143], v15 offset:10240
    v_mfma_f32_16x16x32_bf16 v[180:183], v[36:39], v[64:67], v[180:183]
    ds_read_b64 v[112:113], v10 offset:512
    v_mfma_f32_16x16x32_bf16 v[180:183], v[40:43], v[60:63], v[180:183]
    ds_read_b64 v[114:115], v10 offset:520
    v_mfma_f32_16x16x32_bf16 v[180:183], v[44:47], v[56:59], v[180:183]
    ds_read_b128 v[144:147], v15 offset:12288
    v_mfma_f32_16x16x32_bf16 v[184:187], v[24:27], v[80:83], v[184:187]
    ds_read_b64 v[116:117], v10 offset:0
    v_mfma_f32_16x16x32_bf16 v[184:187], v[28:31], v[76:79], v[184:187]
    ds_read_b64 v[118:119], v10 offset:8
    v_mfma_f32_16x16x32_bf16 v[184:187], v[32:35], v[72:75], v[184:187]
    ds_read_b128 v[148:151], v15 offset:14336
    v_mfma_f32_16x16x32_bf16 v[184:187], v[36:39], v[68:71], v[184:187]
    v_mfma_f32_16x16x32_bf16 v[184:187], v[40:43], v[64:67], v[184:187]
    v_mfma_f32_16x16x32_bf16 v[184:187], v[44:47], v[60:63], v[184:187]
    v_mfma_f32_16x16x32_bf16 v[184:187], v[48:51], v[56:59], v[184:187]
    v_mfma_f32_16x16x32_bf16 v[188:191], v[24:27], v[84:87], v[188:191]
    v_mfma_f32_16x16x32_bf16 v[188:191], v[28:31], v[80:83], v[188:191]
    v_mfma_f32_16x16x32_bf16 v[188:191], v[32:35], v[76:79], v[188:191]
    v_mfma_f32_16x16x32_bf16 v[188:191], v[36:39], v[72:75], v[188:191]
    v_mfma_f32_16x16x32_bf16 v[188:191], v[40:43], v[68:71], v[188:191]
    v_mfma_f32_16x16x32_bf16 v[188:191], v[44:47], v[64:67], v[188:191]
    v_mfma_f32_16x16x32_bf16 v[188:191], v[48:51], v[60:63], v[188:191]
    v_mfma_f32_16x16x32_bf16 v[188:191], v[52:55], v[56:59], v[188:191]
    v_mov_b32 v18, 158788
LW_25:
    ds_read_b32 v19, v18
    s_waitcnt lgkmcnt(0)
    v_readfirstlane_b32 s13, v19
    s_cmp_ge_u32 s13, 4
    s_cbranch_scc1 LWD_26
    s_sleep 1
    s_branch LW_25
LWD_26:
    s_waitcnt lgkmcnt(0)
    v_mfma_f32_16x16x32_bf16 v[160:163], v[88:91], v[120:123], v[160:163]
    ds_read_b64 v[200:201], v16 offset:0
    v_mfma_f32_16x16x32_bf16 v[164:167], v[88:91], v[124:127], v[164:167]
    ds_read_b64 v[202:203], v16 offset:2048
    v_mfma_f32_16x16x32_bf16 v[164:167], v[92:95], v[120:123], v[164:167]
    ds_read_b64 v[204:205], v16 offset:4096
    v_mfma_f32_16x16x32_bf16 v[168:171], v[88:91], v[128:131], v[168:171]
    ds_read_b64 v[206:207], v16 offset:6144
    v_mfma_f32_16x16x32_bf16 v[168:171], v[92:95], v[124:127], v[168:171]
    ds_read_b64 v[208:209], v16 offset:8192
    v_mfma_f32_16x16x32_bf16 v[168:171], v[96:99], v[120:123], v[168:171]
    ds_read_b64 v[210:211], v16 offset:10240
    v_mfma_f32_16x16x32_bf16 v[172:175], v[88:91], v[132:135], v[172:175]
    ds_read_b64 v[212:213], v16 offset:12288
    v_mfma_f32_16x16x32_bf16 v[172:175], v[92:95], v[128:131], v[172:175]
    ds_read_b64 v[214:215], v16 offset:14336
    v_mfma_f32_16x16x32_bf16 v[172:175], v[96:99], v[124:127], v[172:175]
    v_mfma_f32_16x16x32_bf16 v[172:175], v[100:103], v[120:123], v[172:175]
    v_mfma_f32_16x16x32_bf16 v[176:179], v[88:91], v[136:139], v[176:179]
    v_mfma_f32_16x16x32_bf16 v[176:179], v[92:95], v[132:135], v[176:179]
    v_mfma_f32_16x16x32_bf16 v[176:179], v[96:99], v[128:131], v[176:179]
    v_mfma_f32_16x16x32_bf16 v[176:179], v[100:103], v[124:127], v[176:179]
    v_mfma_f32_16x16x32_bf16 v[176:179], v[104:107], v[120:123], v[176:179]
    v_mfma_f32_16x16x32_bf16 v[180:183], v[88:91], v[140:143], v[180:183]
    v_mfma_f32_16x16x32_bf16 v[180:183], v[92:95], v[136:139], v[180:183]
    v_mfma_f32_16x16x32_bf16 v[180:183], v[96:99], v[132:135], v[180:183]
    v_mfma_f32_16x16x32_bf16 v[180:183], v[100:103], v[128:131], v[180:183]
    v_mfma_f32_16x16x32_bf16 v[180:183], v[104:107], v[124:127], v[180:183]
    v_mfma_f32_16x16x32_bf16 v[180:183], v[108:111], v[120:123], v[180:183]
    v_mfma_f32_16x16x32_bf16 v[184:187], v[88:91], v[144:147], v[184:187]
    v_mfma_f32_16x16x32_bf16 v[184:187], v[92:95], v[140:143], v[184:187]
    v_mfma_f32_16x16x32_bf16 v[184:187], v[96:99], v[136:139], v[184:187]
    v_mfma_f32_16x16x32_bf16 v[184:187], v[100:103], v[132:135], v[184:187]
    v_mfma_f32_16x16x32_bf16 v[184:187], v[104:107], v[128:131], v[184:187]
    v_mfma_f32_16x16x32_bf16 v[184:187], v[108:111], v[124:127], v[184:187]
    v_mfma_f32_16x16x32_bf16 v[184:187], v[112:115], v[120:123], v[184:187]
    v_mfma_f32_16x16x32_bf16 v[188:191], v[88:91], v[148:151], v[188:191]
    v_mfma_f32_16x16x32_bf16 v[188:191], v[92:95], v[144:147], v[188:191]
    v_mfma_f32_16x16x32_bf16 v[188:191], v[96:99], v[140:143], v[188:191]
    v_mfma_f32_16x16x32_bf16 v[188:191], v[100:103], v[136:139], v[188:191]
    v_mfma_f32_16x16x32_bf16 v[188:191], v[104:107], v[132:135], v[188:191]
    v_mfma_f32_16x16x32_bf16 v[188:191], v[108:111], v[128:131], v[188:191]
    v_mfma_f32_16x16x32_bf16 v[188:191], v[112:115], v[124:127], v[188:191]
    v_mfma_f32_16x16x32_bf16 v[188:191], v[116:119], v[120:123], v[188:191]
    s_waitcnt lgkmcnt(0)
    s_mov_b64 exec, 1
    v_mov_b32 v4, 158816
    v_mov_b32 v5, 1
    ds_add_u32 v4, v5
    s_mov_b64 exec, -1
    s_nop 1
    v_lshlrev_b32 v20, 16, v200
    v_and_b32 v21, 0xffff0000, v200
    v_lshlrev_b32 v22, 16, v201
    v_and_b32 v23, 0xffff0000, v201
    v_pk_add_f32 v[20:21], v[20:21], v[160:161]
    v_pk_add_f32 v[22:23], v[22:23], v[162:163]
    v_cvt_pk_bf16_f32 v24, v20, v21
    v_cvt_pk_bf16_f32 v25, v22, v23
    v_lshlrev_b32 v20, 16, v202
    v_and_b32 v21, 0xffff0000, v202
    v_lshlrev_b32 v22, 16, v203
    v_and_b32 v23, 0xffff0000, v203
    v_pk_add_f32 v[20:21], v[20:21], v[164:165]
    v_pk_add_f32 v[22:23], v[22:23], v[166:167]
    v_cvt_pk_bf16_f32 v26, v20, v21
    v_cvt_pk_bf16_f32 v27, v22, v23
    v_lshlrev_b32 v20, 16, v204
    v_and_b32 v21, 0xffff0000, v204
    v_lshlrev_b32 v22, 16, v205
    v_and_b32 v23, 0xffff0000, v205
    v_pk_add_f32 v[20:21], v[20:21], v[168:169]
    v_pk_add_f32 v[22:23], v[22:23], v[170:171]
    v_cvt_pk_bf16_f32 v28, v20, v21
    v_cvt_pk_bf16_f32 v29, v22, v23
    v_lshlrev_b32 v20, 16, v206
    v_and_b32 v21, 0xffff0000, v206
    v_lshlrev_b32 v22, 16, v207
    v_and_b32 v23, 0xffff0000, v207
    v_pk_add_f32 v[20:21], v[20:21], v[172:173]
    v_pk_add_f32 v[22:23], v[22:23], v[174:175]
    v_cvt_pk_bf16_f32 v30, v20, v21
    v_cvt_pk_bf16_f32 v31, v22, v23
    v_lshlrev_b32 v20, 16, v208
    v_and_b32 v21, 0xffff0000, v208
    v_lshlrev_b32 v22, 16, v209
    v_and_b32 v23, 0xffff0000, v209
    v_pk_add_f32 v[20:21], v[20:21], v[176:177]
    v_pk_add_f32 v[22:23], v[22:23], v[178:179]
    v_cvt_pk_bf16_f32 v32, v20, v21
    v_cvt_pk_bf16_f32 v33, v22, v23
    v_lshlrev_b32 v20, 16, v210
    v_and_b32 v21, 0xffff0000, v210
    v_lshlrev_b32 v22, 16, v211
    v_and_b32 v23, 0xffff0000, v211
    v_pk_add_f32 v[20:21], v[20:21], v[180:181]
    v_pk_add_f32 v[22:23], v[22:23], v[182:183]
    v_cvt_pk_bf16_f32 v34, v20, v21
    v_cvt_pk_bf16_f32 v35, v22, v23
    v_lshlrev_b32 v20, 16, v212
    v_and_b32 v21, 0xffff0000, v212
    v_lshlrev_b32 v22, 16, v213
    v_and_b32 v23, 0xffff0000, v213
    v_pk_add_f32 v[20:21], v[20:21], v[184:185]
    v_pk_add_f32 v[22:23], v[22:23], v[186:187]
    v_cvt_pk_bf16_f32 v36, v20, v21
    v_cvt_pk_bf16_f32 v37, v22, v23
    v_lshlrev_b32 v20, 16, v214
    v_and_b32 v21, 0xffff0000, v214
    v_lshlrev_b32 v22, 16, v215
    v_and_b32 v23, 0xffff0000, v215
    v_pk_add_f32 v[20:21], v[20:21], v[188:189]
    v_pk_add_f32 v[22:23], v[22:23], v[190:191]
    v_cvt_pk_bf16_f32 v38, v20, v21
    v_cvt_pk_bf16_f32 v39, v22, v23
    v_lshlrev_b32 v8, 5, v2
    v_lshl_add_u32 v8, v3, 3, v8
    s_lshl_b32 s46, s3, 12
    s_add_u32 s46, s46, 142336
    v_add_u32 v8, s46, v8
    v_mov_b32 v4, 158816
LW_27:
    ds_read_b32 v5, v4
    s_waitcnt lgkmcnt(0)
    v_readfirstlane_b32 s13, v5
    s_cmp_ge_u32 s13, 4
    s_cbranch_scc1 LWD_28
    s_sleep 1
    s_branch LW_27
LWD_28:
    ds_write_b64 v8, v[24:25] offset:0
    ds_write_b64 v8, v[26:27] offset:512
    ds_write_b64 v8, v[28:29] offset:1024
    ds_write_b64 v8, v[30:31] offset:1536
    ds_write_b64 v8, v[32:33] offset:2048
    ds_write_b64 v8, v[34:35] offset:2560
    ds_write_b64 v8, v[36:37] offset:3072
    ds_write_b64 v8, v[38:39] offset:3584
    s_waitcnt lgkmcnt(0)
    s_mov_b64 exec, 1
    v_mov_b32 v4, 158808
    v_mov_b32 v5, 1
    ds_add_u32 v4, v5
    s_mov_b64 exec, -1
    v_mov_b32 v4, 158808
LW_29:
    ds_read_b32 v5, v4
    s_waitcnt lgkmcnt(0)
    v_readfirstlane_b32 s13, v5
    s_cmp_ge_u32 s13, 4
    s_cbranch_scc1 LWD_30
    s_sleep 1
    s_branch LW_29
LWD_30:
    v_lshlrev_b32 v252, 2, v0
    v_add_u32 v252, 142336, v252
    v_lshlrev_b32 v253, 4, v0
    s_lshl_b32 s14, s12, 14
    s_add_u32 s14, s14, 0x100000
    s_mov_b32 s46, 0x5040100
    s_mov_b32 s47, 0x7060302
    ds_read_b32 v8, v252 offset:0
    ds_read_b32 v9, v252 offset:4096
    ds_read_b32 v10, v252 offset:8192
    ds_read_b32 v11, v252 offset:12288
    ds_read_b32 v12, v252 offset:1024
    ds_read_b32 v13, v252 offset:5120
    ds_read_b32 v14, v252 offset:9216
    ds_read_b32 v15, v252 offset:13312
    ds_read_b32 v16, v252 offset:2048
    ds_read_b32 v17, v252 offset:6144
    ds_read_b32 v18, v252 offset:10240
    ds_read_b32 v19, v252 offset:14336
    ds_read_b32 v20, v252 offset:3072
    ds_read_b32 v21, v252 offset:7168
    ds_read_b32 v22, v252 offset:11264
    ds_read_b32 v23, v252 offset:15360
    s_waitcnt lgkmcnt(12)
    v_perm_b32 v32, v9, v8, s46
    v_perm_b32 v33, v11, v10, s46
    v_perm_b32 v34, v9, v8, s47
    v_perm_b32 v35, v11, v10, s47
    buffer_store_dwordx4 v[32:35], v253, s[8:11], s14 offen sc1
    s_add_u32 s14, s14, 4096
    s_waitcnt lgkmcnt(8)
    v_perm_b32 v36, v13, v12, s46
    v_perm_b32 v37, v15, v14, s46
    v_perm_b32 v38, v13, v12, s47
    v_perm_b32 v39, v15, v14, s47
    buffer_store_dwordx4 v[36:39], v253, s[8:11], s14 offen sc1
    s_add_u32 s14, s14, 4096
    s_waitcnt lgkmcnt(4)
    v_perm_b32 v40, v17, v16, s46
    v_perm_b32 v41, v19, v18, s46
    v_perm_b32 v42, v17, v16, s47
    v_perm_b32 v43, v19, v18, s47
    buffer_store_dwordx4 v[40:43], v253, s[8:11], s14 offen sc1
    s_add_u32 s14, s14, 4096
    s_waitcnt lgkmcnt(0)
    v_perm_b32 v44, v21, v20, s46
    v_perm_b32 v45, v23, v22, s46
    v_perm_b32 v46, v21, v20, s47
    v_perm_b32 v47, v23, v22, s47
    buffer_store_dwordx4 v[44:47], v253, s[8:11], s14 offen sc1
    s_mov_b64 exec, 1
    v_mov_b32 v4, 158792
    v_mov_b32 v5, 1
    ds_add_u32 v4, v5
    s_mov_b64 exec, -1
    s_cmp_lg_u32 s65, 8
    s_cbranch_scc1 L_CV_NH
    s_cmp_lg_u32 s3, 0
    s_cbranch_scc1 L_CV_NH
    s_lshl_b32 s13, s64, 7
    s_add_u32 s13, s13, 0x20800
    s_mov_b64 s[68:69], exec
    s_mov_b64 exec, 1
    v_mov_b32 v4, 0
    v_mov_b32 v5, 1
    buffer_store_dword v5, v4, s[8:11], s13 offen sc1
    s_mov_b64 exec, s[68:69]
L_CV_NH:
    s_branch L_PHASE_B
L_CV_HELP:
    s_setprio 0
    v_add_u32 v9, 50944, v20
    ds_write_b128 v9, v[136:139]
    v_add_u32 v9, 50944, v21
    ds_write_b128 v9, v[140:143]
    v_add_u32 v9, 50944, v22
    ds_write_b128 v9, v[144:147]
    v_add_u32 v9, 50944, v23
    ds_write_b128 v9, v[148:151]
    s_waitcnt lgkmcnt(0)
    s_mov_b64 exec, 1
    v_mov_b32 v8, 158788
    v_mov_b32 v9, 1
    ds_add_u32 v8, v9
    s_mov_b64 exec, -1
    s_cmp_lg_u32 s3, 4
    s_cbranch_scc1 L_CV_NCP
    s_mov_b64 s[68:69], exec
    s_mov_b64 exec, 1
    s_lshl_b32 s13, s64, 7
    s_add_u32 s13, s13, 0x20000
    v_mov_b32 v248, 0
    v_mov_b32 v249, 1
    buffer_atomic_add v249, v248, s[8:11], s13 offen sc1
    s_mov_b64 exec, s[68:69]
L_CV_NCP:
    s_and_b32 s46, s3, 3
    s_add_u32 s46, s46, 0
    s_mul_i32 s46, s46, 110592
    buffer_load_dwordx4 v[24:27], v240, s[48:51], s46 offen
    buffer_load_dwordx4 v[28:31], v241, s[48:51], s46 offen
    buffer_load_dwordx4 v[32:35], v242, s[48:51], s46 offen
    buffer_load_dwordx4 v[36:39], v243, s[48:51], s46 offen
    buffer_load_dwordx4 v[40:43], v244, s[48:51], s46 offen
    buffer_load_dwordx4 v[44:47], v245, s[48:51], s46 offen
    buffer_load_dwordx4 v[48:51], v246, s[48:51], s46 offen
    s_and_b32 s46, s3, 3
    s_add_u32 s46, s46, 4
    s_mul_i32 s46, s46, 110592
    buffer_load_dwordx4 v[52:55], v240, s[48:51], s46 offen
    buffer_load_dwordx4 v[56:59], v241, s[48:51], s46 offen
    buffer_load_dwordx4 v[60:63], v242, s[48:51], s46 offen
    buffer_load_dwordx4 v[64:67], v243, s[48:51], s46 offen
    buffer_load_dwordx4 v[68:71], v244, s[48:51], s46 offen
    buffer_load_dwordx4 v[72:75], v245, s[48:51], s46 offen
    buffer_load_dwordx4 v[76:79], v246, s[48:51], s46 offen
    s_and_b32 s46, s3, 3
    s_add_u32 s46, s46, 8
    s_mul_i32 s46, s46, 110592
    buffer_load_dwordx4 v[80:83], v240, s[48:51], s46 offen
    buffer_load_dwordx4 v[84:87], v241, s[48:51], s46 offen
    buffer_load_dwordx4 v[88:91], v242, s[48:51], s46 offen
    buffer_load_dwordx4 v[92:95], v243, s[48:51], s46 offen
    buffer_load_dwordx4 v[96:99], v244, s[48:51], s46 offen
    buffer_load_dwordx4 v[100:103], v245, s[48:51], s46 offen
    buffer_load_dwordx4 v[104:107], v246, s[48:51], s46 offen
    s_and_b32 s46, s3, 3
    s_add_u32 s46, s46, 12
    s_mul_i32 s46, s46, 110592
    buffer_load_dwordx4 v[108:111], v240, s[48:51], s46 offen
    buffer_load_dwordx4 v[112:115], v241, s[48:51], s46 offen
    buffer_load_dwordx4 v[116:119], v242, s[48:51], s46 offen
    buffer_load_dwordx4 v[120:123], v243, s[48:51], s46 offen
    buffer_load_dwordx4 v[124:127], v244, s[48:51], s46 offen
    buffer_load_dwordx4 v[128:131], v245, s[48:51], s46 offen
    buffer_load_dwordx4 v[132:135], v246, s[48:51], s46 offen
    s_and_b32 s46, s3, 3
    s_add_u32 s46, s46, 16
    s_mul_i32 s46, s46, 110592
    buffer_load_dwordx4 v[200:203], v240, s[48:51], s46 offen
    buffer_load_dwordx4 v[204:207], v241, s[48:51], s46 offen
    buffer_load_dwordx4 v[208:211], v242, s[48:51], s46 offen
    buffer_load_dwordx4 v[212:215], v243, s[48:51], s46 offen
    buffer_load_dwordx4 v[216:219], v244, s[48:51], s46 offen
    buffer_load_dwordx4 v[220:223], v245, s[48:51], s46 offen
    buffer_load_dwordx4 v[224:227], v246, s[48:51], s46 offen
    v_lshlrev_b32 v252, 4, v1
    v_mov_b32 v248, -1
    v_mov_b32 v249, -1
    v_mov_b32 v250, -1
    v_mov_b32 v251, -1
    s_lshl_b32 s27, s66, 3
    s_and_b32 s28, s3, 3
    s_lshl_b32 s28, s28, 1
    s_add_u32 s27, s27, s28
    s_lshl_b32 s27, s27, 10
    s_add_u32 s27, s27, 0x400000
    s_mul_i32 s28, s67, 7
    s_lshr_b32 s28, s28, 1
    s_lshl_b32 s28, s28, 17
    s_add_u32 s29, s27, s28
    s_bitcmp1_b32 s67, 0
    s_cbranch_scc1 HPS_31
    buffer_store_dwordx4 v[248:251], v252, s[8:11], s29 offen offset:0 sc1
    buffer_store_dwordx4 v[248:251], v252, s[8:11], s29 offen offset:1024 sc1
HPS_31:
    s_add_u32 s29, s29, 131072
    buffer_store_dwordx4 v[248:251], v252, s[8:11], s29 offen offset:0 sc1
    buffer_store_dwordx4 v[248:251], v252, s[8:11], s29 offen offset:1024 sc1
    s_add_u32 s29, s29, 131072
    buffer_store_dwordx4 v[248:251], v252, s[8:11], s29 offen offset:0 sc1
    buffer_store_dwordx4 v[248:251], v252, s[8:11], s29 offen offset:1024 sc1
    s_add_u32 s29, s29, 131072
    buffer_store_dwordx4 v[248:251], v252, s[8:11], s29 offen offset:0 sc1
    buffer_store_dwordx4 v[248:251], v252, s[8:11], s29 offen offset:1024 sc1
    v_mov_b32 v4, 158816
LW_32:
    ds_read_b32 v5, v4
    s_waitcnt lgkmcnt(0)
    v_readfirstlane_b32 s13, v5
    s_cmp_ge_u32 s13, 4
    s_cbranch_scc1 LWD_33
    s_sleep 1
    s_branch LW_32
LWD_33:
    s_bitcmp1_b32 s67, 0
    s_cbranch_scc1 L_CV_V6
    s_waitcnt vmcnt(8)
    s_branch L_CV_V8
L_CV_V6:
    s_waitcnt vmcnt(6)
L_CV_V8:
    v_lshlrev_b32 v4, 4, v1
    s_and_b32 s46, s3, 3
    s_add_u32 s46, s46, 0
    s_mul_i32 s46, s46, 7168
    v_add_u32 v5, s46, v4
    ds_write_b128 v5, v[24:27] offset:0
    ds_write_b128 v5, v[28:31] offset:1024
    ds_write_b128 v5, v[32:35] offset:2048
    ds_write_b128 v5, v[36:39] offset:3072
    ds_write_b128 v5, v[40:43] offset:4096
    ds_write_b128 v5, v[44:47] offset:5120
    ds_write_b128 v5, v[48:51] offset:6144
    s_and_b32 s46, s3, 3
    s_add_u32 s46, s46, 4
    s_mul_i32 s46, s46, 7168
    v_add_u32 v5, s46, v4
    ds_write_b128 v5, v[52:55] offset:0
    ds_write_b128 v5, v[56:59] offset:1024
    ds_write_b128 v5, v[60:63] offset:2048
    ds_write_b128 v5, v[64:67] offset:3072
    ds_write_b128 v5, v[68:71] offset:4096
    ds_write_b128 v5, v[72:75] offset:5120
    ds_write_b128 v5, v[76:79] offset:6144
    s_and_b32 s46, s3, 3
    s_add_u32 s46, s46, 8
    s_mul_i32 s46, s46, 7168
    v_add_u32 v5, s46, v4
    ds_write_b128 v5, v[80:83] offset:0
    ds_write_b128 v5, v[84:87] offset:1024
    ds_write_b128 v5, v[88:91] offset:2048
    ds_write_b128 v5, v[92:95] offset:3072
    ds_write_b128 v5, v[96:99] offset:4096
    ds_write_b128 v5, v[100:103] offset:5120
    ds_write_b128 v5, v[104:107] offset:6144
    s_and_b32 s46, s3, 3
    s_add_u32 s46, s46, 12
    s_mul_i32 s46, s46, 7168
    v_add_u32 v5, s46, v4
    ds_write_b128 v5, v[108:111] offset:0
    ds_write_b128 v5, v[112:115] offset:1024
    ds_write_b128 v5, v[116:119] offset:2048
    ds_write_b128 v5, v[120:123] offset:3072
    ds_write_b128 v5, v[124:127] offset:4096
    ds_write_b128 v5, v[128:131] offset:5120
    ds_write_b128 v5, v[132:135] offset:6144
    s_cmp_lg_u32 s3, 7
    s_cbranch_scc1 L_CV_W4
    v_mov_b32 v6, 158792
LW_34:
    ds_read_b32 v7, v6
    s_waitcnt lgkmcnt(0)
    v_readfirstlane_b32 s13, v7
    s_cmp_ge_u32 s13, 4
    s_cbranch_scc1 LWD_35
    s_sleep 1
    s_branch LW_34
LWD_35:
L_CV_W4:
    v_lshlrev_b32 v4, 4, v1
    s_and_b32 s46, s3, 3
    s_add_u32 s46, s46, 16
    s_mul_i32 s46, s46, 7168
    v_add_u32 v5, s46, v4
    ds_write_b128 v5, v[200:203] offset:0
    ds_write_b128 v5, v[204:207] offset:1024
    ds_write_b128 v5, v[208:211] offset:2048
    ds_write_b128 v5, v[212:215] offset:3072
    ds_write_b128 v5, v[216:219] offset:4096
    ds_write_b128 v5, v[220:223] offset:5120
    ds_write_b128 v5, v[224:227] offset:6144
    s_waitcnt vmcnt(0)
    s_mov_b64 exec, 1
    v_mov_b32 v248, 158812
    v_mov_b32 v249, 1
    ds_add_rtn_u32 v249, v248, v249
    s_waitcnt lgkmcnt(0)
    v_readfirstlane_b32 s13, v249
    s_mov_b64 exec, -1
    s_cmp_lg_u32 s13, 3
    s_cbranch_scc1 L_CV_NGP
    s_mov_b64 s[68:69], exec
    s_mov_b64 exec, 1
    s_lshl_b32 s13, s64, 7
    s_add_u32 s13, s13, 0x20400
    v_mov_b32 v248, 0
    v_mov_b32 v249, 1
    buffer_atomic_add v249, v248, s[8:11], s13 offen sc1
    s_mov_b64 exec, s[68:69]
L_CV_NGP:
L_PHASE_B:
    s_cmp_lg_u32 s3, 0
    s_cbranch_scc1 L_B_W
    v_mov_b32 v8, 158784
LW_36:
    ds_read_b32 v9, v8
    s_waitcnt lgkmcnt(0)
    v_readfirstlane_b32 s13, v9
    s_cmp_ge_u32 s13, 1
    s_cbranch_scc1 LWD_37
    s_sleep 1
    s_branch LW_36
LWD_37:
    s_lshl_b32 s46, s64, 7
    s_add_u32 s46, s46, 0x20800
    s_mov_b64 s[68:69], exec
    s_mov_b32 exec_lo, 0x1
    s_mov_b32 exec_hi, 0x0
    v_lshlrev_b32 v12, 2, v1
    s_mov_b32 s47, 0
POLL_38:
    buffer_load_dword v8, v12, s[8:11], s46 offen sc1
    s_waitcnt vmcnt(0)
    v_cmp_ne_u32 vcc, 0, v8
    s_cmp_eq_u64 vcc, exec
    s_cbranch_scc1 POLLD_39
    s_sleep 8
    s_add_u32 s47, s47, 1
    s_cmp_lt_u32 s47, 262144
    s_cbranch_scc1 POLL_38
POLLD_39:
    s_mov_b64 exec, s[68:69]
    s_mov_b64 s[68:69], exec
    s_mov_b64 exec, 0xff
    v_lshlrev_b32 v9, 7, v1
    s_mov_b32 s46, 0x20000
    s_mov_b32 s47, 0
PS_40:
    buffer_load_dword v8, v9, s[8:11], s46 offen sc1
    s_waitcnt vmcnt(0)
    v_cmp_le_u32 vcc, 32, v8
    s_cmp_eq_u64 vcc, exec
    s_cbranch_scc1 PSD_41
    s_sleep 16
    s_add_u32 s47, s47, 1
    s_cmp_lt_u32 s47, 262144
    s_cbranch_scc1 PS_40
PSD_41:
    s_mov_b64 exec, s[68:69]
L_B_W:
    s_waitcnt lgkmcnt(0)
    s_barrier
    s_cmp_ge_u32 s3, 4
    s_cbranch_scc1 L_B_LOAD
    s_lshl_b32 s12, s66, 7
    s_lshl_b32 s13, s3, 5
    s_add_u32 s12, s12, s13
    v_lshlrev_b32 v5, 14, v3
    v_lshl_add_u32 v5, v2, 4, v5
    s_lshl_b32 s13, s12, 3
    v_add_u32 v5, s13, v5
    v_lshlrev_b32 v4, 4, v1
    s_mov_b32 s13, 0x100000
    buffer_load_dwordx4 v[16:19], v5, s[8:11], s13 offen sc1
    s_mov_b32 s13, 0x110000
    buffer_load_dwordx4 v[20:23], v5, s[8:11], s13 offen sc1
    s_mov_b32 s13, 0x120000
    buffer_load_dwordx4 v[24:27], v5, s[8:11], s13 offen sc1
    s_mov_b32 s13, 0x130000
    buffer_load_dwordx4 v[28:31], v5, s[8:11], s13 offen sc1
    s_mov_b32 s13, 0x140000
    buffer_load_dwordx4 v[32:35], v5, s[8:11], s13 offen sc1
    s_mov_b32 s13, 0x150000
    buffer_load_dwordx4 v[36:39], v5, s[8:11], s13 offen sc1
    s_mov_b32 s13, 0x160000
    buffer_load_dwordx4 v[40:43], v5, s[8:11], s13 offen sc1
    s_mov_b32 s13, 0x170000
    buffer_load_dwordx4 v[44:47], v5, s[8:11], s13 offen sc1
    v_lshrrev_b32 v6, 2, v2
    v_lshl_add_u32 v6, v3, 2, v6
    v_mul_u32_u24 v6, 224, v6
    v_and_b32 v7, 3, v2
    v_lshl_add_u32 v8, v7, 3, v6
    v_add_u32 v9, 57344, v8
    v_add_u32 v10, 114688, v8
    v_mov_b32 v11, 158736
    v_mov_b32 v12, 1
    ds_read_b64_tr_b16 v[120:121], v8 offset:0
    ds_read_b64_tr_b16 v[122:123], v8 offset:3584
    ds_read_b64_tr_b16 v[124:125], v8 offset:32
    ds_read_b64_tr_b16 v[126:127], v8 offset:3616
    ds_read_b64_tr_b16 v[128:129], v8 offset:64
    ds_read_b64_tr_b16 v[130:131], v8 offset:3648
    ds_read_b64_tr_b16 v[132:133], v8 offset:96
    ds_read_b64_tr_b16 v[134:135], v8 offset:3680
    ds_read_b64_tr_b16 v[136:137], v8 offset:128
    ds_read_b64_tr_b16 v[138:139], v8 offset:3712
    ds_read_b64_tr_b16 v[140:141], v8 offset:160
    ds_read_b64_tr_b16 v[142:143], v8 offset:3744
    ds_read_b64_tr_b16 v[144:145], v8 offset:192
    ds_read_b64_tr_b16 v[146:147], v8 offset:3776
    s_waitcnt vmcnt(6)
    v_max3_u32 v6, v16, v18, v20
    v_max_u32 v6, v6, v22
    v_cmp_eq_u32 vcc, -1, v6
    s_cbranch_vccnz HBAD_42
HOK_43:
    s_mov_b64 exec, 1
    v_mov_b32 v6, 158748
    v_mov_b32 v7, 1
    ds_add_u32 v6, v7
    s_mov_b64 exec, -1
    v_swap_b32 v18, v20
    v_swap_b32 v19, v21
    s_nop 1
    s_waitcnt lgkmcnt(0)
    v_mfma_f32_16x16x32_bf16 v[64:67], v[120:123], v[16:19], 0
    ds_read_b64_tr_b16 v[148:149], v8 offset:7168
    v_mfma_f32_16x16x32_bf16 v[68:71], v[120:123], v[20:23], 0
    ds_read_b64_tr_b16 v[150:151], v8 offset:10752
    s_mov_b32 s13, 0x180000
    buffer_load_dwordx4 v[48:51], v5, s[8:11], s13 offen sc1
    v_mfma_f32_16x16x32_bf16 v[72:75], v[124:127], v[16:19], 0
    ds_read_b64_tr_b16 v[152:153], v8 offset:7200
    v_mfma_f32_16x16x32_bf16 v[76:79], v[124:127], v[20:23], 0
    ds_read_b64_tr_b16 v[154:155], v8 offset:10784
    s_waitcnt vmcnt(5)
    v_max3_u32 v6, v24, v26, v28
    v_max_u32 v6, v6, v30
    v_cmp_eq_u32 vcc, -1, v6
    v_mfma_f32_16x16x32_bf16 v[80:83], v[128:131], v[16:19], 0
    ds_read_b64_tr_b16 v[156:157], v8 offset:7232
    v_mfma_f32_16x16x32_bf16 v[84:87], v[128:131], v[20:23], 0
    ds_read_b64_tr_b16 v[158:159], v8 offset:10816
    s_mov_b32 s13, 0x190000
    buffer_load_dwordx4 v[52:55], v5, s[8:11], s13 offen sc1
    v_mfma_f32_16x16x32_bf16 v[88:91], v[132:135], v[16:19], 0
    ds_read_b64_tr_b16 v[160:161], v8 offset:7264
    v_mfma_f32_16x16x32_bf16 v[92:95], v[132:135], v[20:23], 0
    ds_read_b64_tr_b16 v[162:163], v8 offset:10848
    v_mfma_f32_16x16x32_bf16 v[96:99], v[136:139], v[16:19], 0
    ds_read_b64_tr_b16 v[164:165], v8 offset:7296
    s_mov_b32 s13, 0x1a0000
    buffer_load_dwordx4 v[56:59], v5, s[8:11], s13 offen sc1
    v_mfma_f32_16x16x32_bf16 v[100:103], v[136:139], v[20:23], 0
    ds_read_b64_tr_b16 v[166:167], v8 offset:10880
    s_cbranch_vccnz HBAD_44
HOK_45:
    v_mfma_f32_16x16x32_bf16 v[104:107], v[140:143], v[16:19], 0
    ds_read_b64_tr_b16 v[168:169], v8 offset:7328
    v_mfma_f32_16x16x32_bf16 v[108:111], v[140:143], v[20:23], 0
    ds_read_b64_tr_b16 v[170:171], v8 offset:10912
    v_swap_b32 v26, v28
    v_swap_b32 v27, v29
    v_mfma_f32_16x16x32_bf16 v[112:115], v[144:147], v[16:19], 0
    ds_read_b64_tr_b16 v[172:173], v8 offset:7360
    s_mov_b32 s13, 0x1b0000
    buffer_load_dwordx4 v[60:63], v5, s[8:11], s13 offen sc1
    v_mfma_f32_16x16x32_bf16 v[116:119], v[144:147], v[20:23], 0
    ds_read_b64_tr_b16 v[174:175], v8 offset:10944
    s_waitcnt lgkmcnt(0)
    v_mfma_f32_16x16x32_bf16 v[64:67], v[148:151], v[24:27], v[64:67]
    ds_read_b64_tr_b16 v[120:121], v8 offset:14336
    v_mfma_f32_16x16x32_bf16 v[68:71], v[148:151], v[28:31], v[68:71]
    ds_read_b64_tr_b16 v[122:123], v8 offset:17920
    s_mov_b32 s13, 0x1c0000
    buffer_load_dwordx4 v[176:179], v5, s[8:11], s13 offen sc1
    v_mfma_f32_16x16x32_bf16 v[72:75], v[152:155], v[24:27], v[72:75]
    ds_read_b64_tr_b16 v[124:125], v8 offset:14368
    v_mfma_f32_16x16x32_bf16 v[76:79], v[152:155], v[28:31], v[76:79]
    ds_read_b64_tr_b16 v[126:127], v8 offset:17952
    s_waitcnt vmcnt(7)
    v_max3_u32 v6, v32, v34, v36
    v_max_u32 v6, v6, v38
    v_cmp_eq_u32 vcc, -1, v6
    v_mfma_f32_16x16x32_bf16 v[80:83], v[156:159], v[24:27], v[80:83]
    ds_read_b64_tr_b16 v[128:129], v8 offset:14400
    v_mfma_f32_16x16x32_bf16 v[84:87], v[156:159], v[28:31], v[84:87]
    ds_read_b64_tr_b16 v[130:131], v8 offset:17984
    s_mov_b32 s13, 0x1d0000
    buffer_load_dwordx4 v[180:183], v5, s[8:11], s13 offen sc1
    v_mfma_f32_16x16x32_bf16 v[88:91], v[160:163], v[24:27], v[88:91]
    ds_read_b64_tr_b16 v[132:133], v8 offset:14432
    v_mfma_f32_16x16x32_bf16 v[92:95], v[160:163], v[28:31], v[92:95]
    ds_read_b64_tr_b16 v[134:135], v8 offset:18016
    v_mfma_f32_16x16x32_bf16 v[96:99], v[164:167], v[24:27], v[96:99]
    ds_read_b64_tr_b16 v[136:137], v8 offset:14464
    s_mov_b32 s13, 0x1e0000
    buffer_load_dwordx4 v[184:187], v5, s[8:11], s13 offen sc1
    v_mfma_f32_16x16x32_bf16 v[100:103], v[164:167], v[28:31], v[100:103]
    ds_read_b64_tr_b16 v[138:139], v8 offset:18048
    s_cbranch_vccnz HBAD_46
HOK_47:
    v_mfma_f32_16x16x32_bf16 v[104:107], v[168:171], v[24:27], v[104:107]
    ds_read_b64_tr_b16 v[140:141], v8 offset:14496
    v_mfma_f32_16x16x32_bf16 v[108:111], v[168:171], v[28:31], v[108:111]
    ds_read_b64_tr_b16 v[142:143], v8 offset:18080
    v_swap_b32 v34, v36
    v_swap_b32 v35, v37
    v_mfma_f32_16x16x32_bf16 v[112:115], v[172:175], v[24:27], v[112:115]
    ds_read_b64_tr_b16 v[144:145], v8 offset:14528
    s_mov_b32 s13, 0x1f0000
    buffer_load_dwordx4 v[188:191], v5, s[8:11], s13 offen sc1
    v_mfma_f32_16x16x32_bf16 v[116:119], v[172:175], v[28:31], v[116:119]
    ds_read_b64_tr_b16 v[146:147], v8 offset:18112
    s_waitcnt lgkmcnt(0)
    v_mfma_f32_16x16x32_bf16 v[64:67], v[120:123], v[32:35], v[64:67]
    ds_read_b64_tr_b16 v[148:149], v8 offset:21504
    v_mfma_f32_16x16x32_bf16 v[68:71], v[120:123], v[36:39], v[68:71]
    ds_read_b64_tr_b16 v[150:151], v8 offset:25088
    s_mov_b32 s13, 0x200000
    buffer_load_dwordx4 v[192:195], v5, s[8:11], s13 offen sc1
    v_mfma_f32_16x16x32_bf16 v[72:75], v[124:127], v[32:35], v[72:75]
    ds_read_b64_tr_b16 v[152:153], v8 offset:21536
    v_mfma_f32_16x16x32_bf16 v[76:79], v[124:127], v[36:39], v[76:79]
    ds_read_b64_tr_b16 v[154:155], v8 offset:25120
    s_waitcnt vmcnt(9)
    v_max3_u32 v6, v40, v42, v44
    v_max_u32 v6, v6, v46
    v_cmp_eq_u32 vcc, -1, v6
    v_mfma_f32_16x16x32_bf16 v[80:83], v[128:131], v[32:35], v[80:83]
    ds_read_b64_tr_b16 v[156:157], v8 offset:21568
    v_mfma_f32_16x16x32_bf16 v[84:87], v[128:131], v[36:39], v[84:87]
    ds_read_b64_tr_b16 v[158:159], v8 offset:25152
    s_mov_b32 s13, 0x210000
    buffer_load_dwordx4 v[196:199], v5, s[8:11], s13 offen sc1
    v_mfma_f32_16x16x32_bf16 v[88:91], v[132:135], v[32:35], v[88:91]
    ds_read_b64_tr_b16 v[160:161], v8 offset:21600
    v_mfma_f32_16x16x32_bf16 v[92:95], v[132:135], v[36:39], v[92:95]
    ds_read_b64_tr_b16 v[162:163], v8 offset:25184
    v_mfma_f32_16x16x32_bf16 v[96:99], v[136:139], v[32:35], v[96:99]
    ds_read_b64_tr_b16 v[164:165], v8 offset:21632
    s_mov_b32 s13, 0x220000
    buffer_load_dwordx4 v[200:203], v5, s[8:11], s13 offen sc1
    v_mfma_f32_16x16x32_bf16 v[100:103], v[136:139], v[36:39], v[100:103]
    ds_read_b64_tr_b16 v[166:167], v8 offset:25216
    s_cbranch_vccnz HBAD_48
HOK_49:
    v_mfma_f32_16x16x32_bf16 v[104:107], v[140:143], v[32:35], v[104:107]
    ds_read_b64_tr_b16 v[168:169], v8 offset:21664
    v_mfma_f32_16x16x32_bf16 v[108:111], v[140:143], v[36:39], v[108:111]
    ds_read_b64_tr_b16 v[170:171], v8 offset:25248
    v_swap_b32 v42, v44
    v_swap_b32 v43, v45
    v_mfma_f32_16x16x32_bf16 v[112:115], v[144:147], v[32:35], v[112:115]
    ds_read_b64_tr_b16 v[172:173], v8 offset:21696
    s_mov_b32 s13, 0x230000
    buffer_load_dwordx4 v[204:207], v5, s[8:11], s13 offen sc1
    v_mfma_f32_16x16x32_bf16 v[116:119], v[144:147], v[36:39], v[116:119]
    ds_read_b64_tr_b16 v[174:175], v8 offset:25280
    s_waitcnt lgkmcnt(0)
    v_mfma_f32_16x16x32_bf16 v[64:67], v[148:151], v[40:43], v[64:67]
    ds_read_b64_tr_b16 v[120:121], v8 offset:28672
    v_mfma_f32_16x16x32_bf16 v[68:71], v[148:151], v[44:47], v[68:71]
    ds_read_b64_tr_b16 v[122:123], v8 offset:32256
    s_mov_b32 s13, 0x240000
    buffer_load_dwordx4 v[208:211], v5, s[8:11], s13 offen sc1
    v_mfma_f32_16x16x32_bf16 v[72:75], v[152:155], v[40:43], v[72:75]
    ds_read_b64_tr_b16 v[124:125], v8 offset:28704
    v_mfma_f32_16x16x32_bf16 v[76:79], v[152:155], v[44:47], v[76:79]
    ds_read_b64_tr_b16 v[126:127], v8 offset:32288
    s_waitcnt vmcnt(11)
    v_max3_u32 v6, v48, v50, v52
    v_max_u32 v6, v6, v54
    v_cmp_eq_u32 vcc, -1, v6
    v_mfma_f32_16x16x32_bf16 v[80:83], v[156:159], v[40:43], v[80:83]
    ds_read_b64_tr_b16 v[128:129], v8 offset:28736
    v_mfma_f32_16x16x32_bf16 v[84:87], v[156:159], v[44:47], v[84:87]
    ds_read_b64_tr_b16 v[130:131], v8 offset:32320
    s_mov_b32 s13, 0x250000
    buffer_load_dwordx4 v[212:215], v5, s[8:11], s13 offen sc1
    v_mfma_f32_16x16x32_bf16 v[88:91], v[160:163], v[40:43], v[88:91]
    ds_read_b64_tr_b16 v[132:133], v8 offset:28768
    v_mfma_f32_16x16x32_bf16 v[92:95], v[160:163], v[44:47], v[92:95]
    ds_read_b64_tr_b16 v[134:135], v8 offset:32352
    v_mfma_f32_16x16x32_bf16 v[96:99], v[164:167], v[40:43], v[96:99]
    ds_read_b64_tr_b16 v[136:137], v8 offset:28800
    s_mov_b32 s13, 0x260000
    buffer_load_dwordx4 v[216:219], v5, s[8:11], s13 offen sc1
    v_mfma_f32_16x16x32_bf16 v[100:103], v[164:167], v[44:47], v[100:103]
    ds_read_b64_tr_b16 v[138:139], v8 offset:32384
    s_cbranch_vccnz HBAD_50
HOK_51:
    v_mfma_f32_16x16x32_bf16 v[104:107], v[168:171], v[40:43], v[104:107]
    ds_read_b64_tr_b16 v[140:141], v8 offset:28832
    v_mfma_f32_16x16x32_bf16 v[108:111], v[168:171], v[44:47], v[108:111]
    ds_read_b64_tr_b16 v[142:143], v8 offset:32416
    v_swap_b32 v50, v52
    v_swap_b32 v51, v53
    v_mfma_f32_16x16x32_bf16 v[112:115], v[172:175], v[40:43], v[112:115]
    ds_read_b64_tr_b16 v[144:145], v8 offset:28864
    s_mov_b32 s13, 0x270000
    buffer_load_dwordx4 v[220:223], v5, s[8:11], s13 offen sc1
    v_mfma_f32_16x16x32_bf16 v[116:119], v[172:175], v[44:47], v[116:119]
    ds_read_b64_tr_b16 v[146:147], v8 offset:32448
    s_waitcnt lgkmcnt(0)
    v_mfma_f32_16x16x32_bf16 v[64:67], v[120:123], v[48:51], v[64:67]
    ds_read_b64_tr_b16 v[148:149], v8 offset:35840
    v_mfma_f32_16x16x32_bf16 v[68:71], v[120:123], v[52:55], v[68:71]
    ds_read_b64_tr_b16 v[150:151], v8 offset:39424
    s_mov_b32 s13, 0x280000
    buffer_load_dwordx4 v[224:227], v5, s[8:11], s13 offen sc1
    v_mfma_f32_16x16x32_bf16 v[72:75], v[124:127], v[48:51], v[72:75]
    ds_read_b64_tr_b16 v[152:153], v8 offset:35872
    v_mfma_f32_16x16x32_bf16 v[76:79], v[124:127], v[52:55], v[76:79]
    ds_read_b64_tr_b16 v[154:155], v8 offset:39456
    s_waitcnt vmcnt(13)
    v_max3_u32 v6, v56, v58, v60
    v_max_u32 v6, v6, v62
    v_cmp_eq_u32 vcc, -1, v6
    v_mfma_f32_16x16x32_bf16 v[80:83], v[128:131], v[48:51], v[80:83]
    ds_read_b64_tr_b16 v[156:157], v8 offset:35904
    v_mfma_f32_16x16x32_bf16 v[84:87], v[128:131], v[52:55], v[84:87]
    ds_read_b64_tr_b16 v[158:159], v8 offset:39488
    s_mov_b32 s13, 0x290000
    buffer_load_dwordx4 v[228:231], v5, s[8:11], s13 offen sc1
    v_mfma_f32_16x16x32_bf16 v[88:91], v[132:135], v[48:51], v[88:91]
    ds_read_b64_tr_b16 v[160:161], v8 offset:35936
    v_mfma_f32_16x16x32_bf16 v[92:95], v[132:135], v[52:55], v[92:95]
    ds_read_b64_tr_b16 v[162:163], v8 offset:39520
    v_mfma_f32_16x16x32_bf16 v[96:99], v[136:139], v[48:51], v[96:99]
    ds_read_b64_tr_b16 v[164:165], v8 offset:35968
    s_mov_b32 s13, 0x2a0000
    buffer_load_dwordx4 v[16:19], v5, s[8:11], s13 offen sc1
    v_mfma_f32_16x16x32_bf16 v[100:103], v[136:139], v[52:55], v[100:103]
    ds_read_b64_tr_b16 v[166:167], v8 offset:39552
    s_cbranch_vccnz HBAD_52
HOK_53:
    v_mfma_f32_16x16x32_bf16 v[104:107], v[140:143], v[48:51], v[104:107]
    ds_read_b64_tr_b16 v[168:169], v8 offset:36000
    v_mfma_f32_16x16x32_bf16 v[108:111], v[140:143], v[52:55], v[108:111]
    ds_read_b64_tr_b16 v[170:171], v8 offset:39584
    v_swap_b32 v58, v60
    v_swap_b32 v59, v61
    v_mfma_f32_16x16x32_bf16 v[112:115], v[144:147], v[48:51], v[112:115]
    ds_read_b64_tr_b16 v[172:173], v8 offset:36032
    s_mov_b32 s13, 0x2b0000
    buffer_load_dwordx4 v[20:23], v5, s[8:11], s13 offen sc1
    v_mfma_f32_16x16x32_bf16 v[116:119], v[144:147], v[52:55], v[116:119]
    ds_read_b64_tr_b16 v[174:175], v8 offset:39616
    s_waitcnt lgkmcnt(0)
    v_mfma_f32_16x16x32_bf16 v[64:67], v[148:151], v[56:59], v[64:67]
    ds_read_b64_tr_b16 v[120:121], v8 offset:43008
    v_mfma_f32_16x16x32_bf16 v[68:71], v[148:151], v[60:63], v[68:71]
    ds_read_b64_tr_b16 v[122:123], v8 offset:46592
    s_mov_b32 s13, 0x2c0000
    buffer_load_dwordx4 v[24:27], v5, s[8:11], s13 offen sc1
    v_mfma_f32_16x16x32_bf16 v[72:75], v[152:155], v[56:59], v[72:75]
    ds_read_b64_tr_b16 v[124:125], v8 offset:43040
    v_mfma_f32_16x16x32_bf16 v[76:79], v[152:155], v[60:63], v[76:79]
    ds_read_b64_tr_b16 v[126:127], v8 offset:46624
    s_waitcnt vmcnt(15)
    v_max3_u32 v6, v176, v178, v180
    v_max_u32 v6, v6, v182
    v_cmp_eq_u32 vcc, -1, v6
    v_mfma_f32_16x16x32_bf16 v[80:83], v[156:159], v[56:59], v[80:83]
    ds_read_b64_tr_b16 v[128:129], v8 offset:43072
    v_mfma_f32_16x16x32_bf16 v[84:87], v[156:159], v[60:63], v[84:87]
    ds_read_b64_tr_b16 v[130:131], v8 offset:46656
    s_mov_b32 s13, 0x2d0000
    buffer_load_dwordx4 v[28:31], v5, s[8:11], s13 offen sc1
    v_mfma_f32_16x16x32_bf16 v[88:91], v[160:163], v[56:59], v[88:91]
    ds_read_b64_tr_b16 v[132:133], v8 offset:43104
    v_mfma_f32_16x16x32_bf16 v[92:95], v[160:163], v[60:63], v[92:95]
    ds_read_b64_tr_b16 v[134:135], v8 offset:46688
    v_mfma_f32_16x16x32_bf16 v[96:99], v[164:167], v[56:59], v[96:99]
    ds_read_b64_tr_b16 v[136:137], v8 offset:43136
    s_mov_b32 s13, 0x2e0000
    buffer_load_dwordx4 v[32:35], v5, s[8:11], s13 offen sc1
    v_mfma_f32_16x16x32_bf16 v[100:103], v[164:167], v[60:63], v[100:103]
    ds_read_b64_tr_b16 v[138:139], v8 offset:46720
    s_cbranch_vccnz HBAD_54
HOK_55:
    v_mfma_f32_16x16x32_bf16 v[104:107], v[168:171], v[56:59], v[104:107]
    ds_read_b64_tr_b16 v[140:141], v8 offset:43168
    v_mfma_f32_16x16x32_bf16 v[108:111], v[168:171], v[60:63], v[108:111]
    ds_read_b64_tr_b16 v[142:143], v8 offset:46752
    v_swap_b32 v178, v180
    v_swap_b32 v179, v181
    v_mfma_f32_16x16x32_bf16 v[112:115], v[172:175], v[56:59], v[112:115]
    ds_read_b64_tr_b16 v[144:145], v8 offset:43200
    s_mov_b32 s13, 0x2f0000
    buffer_load_dwordx4 v[36:39], v5, s[8:11], s13 offen sc1
    v_mfma_f32_16x16x32_bf16 v[116:119], v[172:175], v[60:63], v[116:119]
    ds_read_b64_tr_b16 v[146:147], v8 offset:46784
    s_waitcnt lgkmcnt(0)
    v_mfma_f32_16x16x32_bf16 v[64:67], v[120:123], v[176:179], v[64:67]
    ds_read_b64_tr_b16 v[148:149], v8 offset:50176
    v_mfma_f32_16x16x32_bf16 v[68:71], v[120:123], v[180:183], v[68:71]
    ds_read_b64_tr_b16 v[150:151], v8 offset:53760
    s_mov_b32 s13, 0x300000
    buffer_load_dwordx4 v[40:43], v5, s[8:11], s13 offen sc1
    v_mfma_f32_16x16x32_bf16 v[72:75], v[124:127], v[176:179], v[72:75]
    ds_read_b64_tr_b16 v[152:153], v8 offset:50208
    v_mfma_f32_16x16x32_bf16 v[76:79], v[124:127], v[180:183], v[76:79]
    ds_read_b64_tr_b16 v[154:155], v8 offset:53792
    s_waitcnt vmcnt(17)
    v_max3_u32 v6, v184, v186, v188
    v_max_u32 v6, v6, v190
    v_cmp_eq_u32 vcc, -1, v6
    v_mfma_f32_16x16x32_bf16 v[80:83], v[128:131], v[176:179], v[80:83]
    ds_read_b64_tr_b16 v[156:157], v8 offset:50240
    v_mfma_f32_16x16x32_bf16 v[84:87], v[128:131], v[180:183], v[84:87]
    ds_read_b64_tr_b16 v[158:159], v8 offset:53824
    s_mov_b32 s13, 0x310000
    buffer_load_dwordx4 v[44:47], v5, s[8:11], s13 offen sc1
    v_mfma_f32_16x16x32_bf16 v[88:91], v[132:135], v[176:179], v[88:91]
    ds_read_b64_tr_b16 v[160:161], v8 offset:50272
    v_mfma_f32_16x16x32_bf16 v[92:95], v[132:135], v[180:183], v[92:95]
    ds_read_b64_tr_b16 v[162:163], v8 offset:53856
    v_mfma_f32_16x16x32_bf16 v[96:99], v[136:139], v[176:179], v[96:99]
    ds_read_b64_tr_b16 v[164:165], v8 offset:50304
    s_mov_b32 s13, 0x320000
    buffer_load_dwordx4 v[48:51], v5, s[8:11], s13 offen sc1
    v_mfma_f32_16x16x32_bf16 v[100:103], v[136:139], v[180:183], v[100:103]
    ds_read_b64_tr_b16 v[166:167], v8 offset:53888
    s_cbranch_vccnz HBAD_56
HOK_57:
    v_mfma_f32_16x16x32_bf16 v[104:107], v[140:143], v[176:179], v[104:107]
    ds_read_b64_tr_b16 v[168:169], v8 offset:50336
    v_mfma_f32_16x16x32_bf16 v[108:111], v[140:143], v[180:183], v[108:111]
    ds_read_b64_tr_b16 v[170:171], v8 offset:53920
    v_swap_b32 v186, v188
    v_swap_b32 v187, v189
    v_mfma_f32_16x16x32_bf16 v[112:115], v[144:147], v[176:179], v[112:115]
    ds_read_b64_tr_b16 v[172:173], v8 offset:50368
    s_mov_b32 s13, 0x330000
    buffer_load_dwordx4 v[52:55], v5, s[8:11], s13 offen sc1
    v_mfma_f32_16x16x32_bf16 v[116:119], v[144:147], v[180:183], v[116:119]
    ds_read_b64_tr_b16 v[174:175], v8 offset:53952
    s_waitcnt lgkmcnt(0)
    v_mfma_f32_16x16x32_bf16 v[64:67], v[148:151], v[184:187], v[64:67]
    ds_read_b64_tr_b16 v[120:121], v9 offset:0
    v_mfma_f32_16x16x32_bf16 v[68:71], v[148:151], v[188:191], v[68:71]
    ds_read_b64_tr_b16 v[122:123], v9 offset:3584
    s_mov_b32 s13, 0x340000
    buffer_load_dwordx4 v[56:59], v5, s[8:11], s13 offen sc1
    v_mfma_f32_16x16x32_bf16 v[72:75], v[152:155], v[184:187], v[72:75]
    ds_read_b64_tr_b16 v[124:125], v9 offset:32
    v_mfma_f32_16x16x32_bf16 v[76:79], v[152:155], v[188:191], v[76:79]
    ds_read_b64_tr_b16 v[126:127], v9 offset:3616
    s_waitcnt vmcnt(19)
    v_max3_u32 v6, v192, v194, v196
    v_max_u32 v6, v6, v198
    v_cmp_eq_u32 vcc, -1, v6
    v_mfma_f32_16x16x32_bf16 v[80:83], v[156:159], v[184:187], v[80:83]
    ds_read_b64_tr_b16 v[128:129], v9 offset:64
    v_mfma_f32_16x16x32_bf16 v[84:87], v[156:159], v[188:191], v[84:87]
    ds_read_b64_tr_b16 v[130:131], v9 offset:3648
    s_mov_b32 s13, 0x350000
    buffer_load_dwordx4 v[60:63], v5, s[8:11], s13 offen sc1
    v_mfma_f32_16x16x32_bf16 v[88:91], v[160:163], v[184:187], v[88:91]
    ds_read_b64_tr_b16 v[132:133], v9 offset:96
    v_mfma_f32_16x16x32_bf16 v[92:95], v[160:163], v[188:191], v[92:95]
    ds_read_b64_tr_b16 v[134:135], v9 offset:3680
    v_mfma_f32_16x16x32_bf16 v[96:99], v[164:167], v[184:187], v[96:99]
    ds_read_b64_tr_b16 v[136:137], v9 offset:128
    s_mov_b32 s13, 0x360000
    buffer_load_dwordx4 v[176:179], v5, s[8:11], s13 offen sc1
    v_mfma_f32_16x16x32_bf16 v[100:103], v[164:167], v[188:191], v[100:103]
    ds_read_b64_tr_b16 v[138:139], v9 offset:3712
    s_cbranch_vccnz HBAD_58
HOK_59:
    v_mfma_f32_16x16x32_bf16 v[104:107], v[168:171], v[184:187], v[104:107]
    ds_read_b64_tr_b16 v[140:141], v9 offset:160
    v_mfma_f32_16x16x32_bf16 v[108:111], v[168:171], v[188:191], v[108:111]
    ds_read_b64_tr_b16 v[142:143], v9 offset:3744
    v_swap_b32 v194, v196
    v_swap_b32 v195, v197
    v_mfma_f32_16x16x32_bf16 v[112:115], v[172:175], v[184:187], v[112:115]
    ds_read_b64_tr_b16 v[144:145], v9 offset:192
    s_mov_b32 s13, 0x370000
    buffer_load_dwordx4 v[180:183], v5, s[8:11], s13 offen sc1
    s_mov_b64 exec, 1
    ds_add_u32 v11, v12
    s_mov_b64 exec, -1
    v_mfma_f32_16x16x32_bf16 v[116:119], v[172:175], v[188:191], v[116:119]
    ds_read_b64_tr_b16 v[146:147], v9 offset:3776
    s_waitcnt lgkmcnt(0)
    v_mfma_f32_16x16x32_bf16 v[64:67], v[120:123], v[192:195], v[64:67]
    ds_read_b64_tr_b16 v[148:149], v9 offset:7168
    v_mfma_f32_16x16x32_bf16 v[68:71], v[120:123], v[196:199], v[68:71]
    ds_read_b64_tr_b16 v[150:151], v9 offset:10752
    v_mfma_f32_16x16x32_bf16 v[72:75], v[124:127], v[192:195], v[72:75]
    ds_read_b64_tr_b16 v[152:153], v9 offset:7200
    v_mfma_f32_16x16x32_bf16 v[76:79], v[124:127], v[196:199], v[76:79]
    ds_read_b64_tr_b16 v[154:155], v9 offset:10784
    s_waitcnt vmcnt(20)
    v_max3_u32 v6, v200, v202, v204
    v_max_u32 v6, v6, v206
    v_cmp_eq_u32 vcc, -1, v6
    v_mfma_f32_16x16x32_bf16 v[80:83], v[128:131], v[192:195], v[80:83]
    ds_read_b64_tr_b16 v[156:157], v9 offset:7232
    v_mfma_f32_16x16x32_bf16 v[84:87], v[128:131], v[196:199], v[84:87]
    ds_read_b64_tr_b16 v[158:159], v9 offset:10816
    v_mfma_f32_16x16x32_bf16 v[88:91], v[132:135], v[192:195], v[88:91]
    ds_read_b64_tr_b16 v[160:161], v9 offset:7264
    v_mfma_f32_16x16x32_bf16 v[92:95], v[132:135], v[196:199], v[92:95]
    ds_read_b64_tr_b16 v[162:163], v9 offset:10848
    v_mfma_f32_16x16x32_bf16 v[96:99], v[136:139], v[192:195], v[96:99]
    ds_read_b64_tr_b16 v[164:165], v9 offset:7296
    v_mfma_f32_16x16x32_bf16 v[100:103], v[136:139], v[196:199], v[100:103]
    ds_read_b64_tr_b16 v[166:167], v9 offset:10880
    s_cbranch_vccnz HBAD_60
HOK_61:
    v_mfma_f32_16x16x32_bf16 v[104:107], v[140:143], v[192:195], v[104:107]
    ds_read_b64_tr_b16 v[168:169], v9 offset:7328
    v_mfma_f32_16x16x32_bf16 v[108:111], v[140:143], v[196:199], v[108:111]
    ds_read_b64_tr_b16 v[170:171], v9 offset:10912
    v_swap_b32 v202, v204
    v_swap_b32 v203, v205
    v_mfma_f32_16x16x32_bf16 v[112:115], v[144:147], v[192:195], v[112:115]
    ds_read_b64_tr_b16 v[172:173], v9 offset:7360
    v_mfma_f32_16x16x32_bf16 v[116:119], v[144:147], v[196:199], v[116:119]
    ds_read_b64_tr_b16 v[174:175], v9 offset:10944
    s_waitcnt lgkmcnt(0)
    v_mfma_f32_16x16x32_bf16 v[64:67], v[148:151], v[200:203], v[64:67]
    ds_read_b64_tr_b16 v[120:121], v9 offset:14336
    v_mfma_f32_16x16x32_bf16 v[68:71], v[148:151], v[204:207], v[68:71]
    ds_read_b64_tr_b16 v[122:123], v9 offset:17920
    v_mfma_f32_16x16x32_bf16 v[72:75], v[152:155], v[200:203], v[72:75]
    ds_read_b64_tr_b16 v[124:125], v9 offset:14368
    v_mfma_f32_16x16x32_bf16 v[76:79], v[152:155], v[204:207], v[76:79]
    ds_read_b64_tr_b16 v[126:127], v9 offset:17952
    s_waitcnt vmcnt(18)
    v_max3_u32 v6, v208, v210, v212
    v_max_u32 v6, v6, v214
    v_cmp_eq_u32 vcc, -1, v6
    v_mfma_f32_16x16x32_bf16 v[80:83], v[156:159], v[200:203], v[80:83]
    ds_read_b64_tr_b16 v[128:129], v9 offset:14400
    v_mfma_f32_16x16x32_bf16 v[84:87], v[156:159], v[204:207], v[84:87]
    ds_read_b64_tr_b16 v[130:131], v9 offset:17984
    v_mfma_f32_16x16x32_bf16 v[88:91], v[160:163], v[200:203], v[88:91]
    ds_read_b64_tr_b16 v[132:133], v9 offset:14432
    v_mfma_f32_16x16x32_bf16 v[92:95], v[160:163], v[204:207], v[92:95]
    ds_read_b64_tr_b16 v[134:135], v9 offset:18016
    v_mfma_f32_16x16x32_bf16 v[96:99], v[164:167], v[200:203], v[96:99]
    ds_read_b64_tr_b16 v[136:137], v9 offset:14464
    v_mfma_f32_16x16x32_bf16 v[100:103], v[164:167], v[204:207], v[100:103]
    ds_read_b64_tr_b16 v[138:139], v9 offset:18048
    s_cbranch_vccnz HBAD_62
HOK_63:
    v_mfma_f32_16x16x32_bf16 v[104:107], v[168:171], v[200:203], v[104:107]
    ds_read_b64_tr_b16 v[140:141], v9 offset:14496
    v_mfma_f32_16x16x32_bf16 v[108:111], v[168:171], v[204:207], v[108:111]
    ds_read_b64_tr_b16 v[142:143], v9 offset:18080
    v_swap_b32 v210, v212
    v_swap_b32 v211, v213
    v_mfma_f32_16x16x32_bf16 v[112:115], v[172:175], v[200:203], v[112:115]
    ds_read_b64_tr_b16 v[144:145], v9 offset:14528
    v_mfma_f32_16x16x32_bf16 v[116:119], v[172:175], v[204:207], v[116:119]
    ds_read_b64_tr_b16 v[146:147], v9 offset:18112
    s_waitcnt lgkmcnt(0)
    v_mfma_f32_16x16x32_bf16 v[64:67], v[120:123], v[208:211], v[64:67]
    ds_read_b64_tr_b16 v[148:149], v9 offset:21504
    v_mfma_f32_16x16x32_bf16 v[68:71], v[120:123], v[212:215], v[68:71]
    ds_read_b64_tr_b16 v[150:151], v9 offset:25088
    v_mfma_f32_16x16x32_bf16 v[72:75], v[124:127], v[208:211], v[72:75]
    ds_read_b64_tr_b16 v[152:153], v9 offset:21536
    v_mfma_f32_16x16x32_bf16 v[76:79], v[124:127], v[212:215], v[76:79]
    ds_read_b64_tr_b16 v[154:155], v9 offset:25120
    s_waitcnt vmcnt(16)
    v_max3_u32 v6, v216, v218, v220
    v_max_u32 v6, v6, v222
    v_cmp_eq_u32 vcc, -1, v6
    v_mfma_f32_16x16x32_bf16 v[80:83], v[128:131], v[208:211], v[80:83]
    ds_read_b64_tr_b16 v[156:157], v9 offset:21568
    v_mfma_f32_16x16x32_bf16 v[84:87], v[128:131], v[212:215], v[84:87]
    ds_read_b64_tr_b16 v[158:159], v9 offset:25152
    v_mfma_f32_16x16x32_bf16 v[88:91], v[132:135], v[208:211], v[88:91]
    ds_read_b64_tr_b16 v[160:161], v9 offset:21600
    v_mfma_f32_16x16x32_bf16 v[92:95], v[132:135], v[212:215], v[92:95]
    ds_read_b64_tr_b16 v[162:163], v9 offset:25184
    v_mfma_f32_16x16x32_bf16 v[96:99], v[136:139], v[208:211], v[96:99]
    ds_read_b64_tr_b16 v[164:165], v9 offset:21632
    v_mfma_f32_16x16x32_bf16 v[100:103], v[136:139], v[212:215], v[100:103]
    ds_read_b64_tr_b16 v[166:167], v9 offset:25216
    s_cbranch_vccnz HBAD_64
HOK_65:
    v_mfma_f32_16x16x32_bf16 v[104:107], v[140:143], v[208:211], v[104:107]
    ds_read_b64_tr_b16 v[168:169], v9 offset:21664
    v_mfma_f32_16x16x32_bf16 v[108:111], v[140:143], v[212:215], v[108:111]
    ds_read_b64_tr_b16 v[170:171], v9 offset:25248
    v_swap_b32 v218, v220
    v_swap_b32 v219, v221
    v_mfma_f32_16x16x32_bf16 v[112:115], v[144:147], v[208:211], v[112:115]
    ds_read_b64_tr_b16 v[172:173], v9 offset:21696
    v_mfma_f32_16x16x32_bf16 v[116:119], v[144:147], v[212:215], v[116:119]
    ds_read_b64_tr_b16 v[174:175], v9 offset:25280
    s_waitcnt lgkmcnt(0)
    v_mfma_f32_16x16x32_bf16 v[64:67], v[148:151], v[216:219], v[64:67]
    ds_read_b64_tr_b16 v[120:121], v9 offset:28672
    v_mfma_f32_16x16x32_bf16 v[68:71], v[148:151], v[220:223], v[68:71]
    ds_read_b64_tr_b16 v[122:123], v9 offset:32256
    v_mfma_f32_16x16x32_bf16 v[72:75], v[152:155], v[216:219], v[72:75]
    ds_read_b64_tr_b16 v[124:125], v9 offset:28704
    v_mfma_f32_16x16x32_bf16 v[76:79], v[152:155], v[220:223], v[76:79]
    ds_read_b64_tr_b16 v[126:127], v9 offset:32288
    s_waitcnt vmcnt(14)
    v_max3_u32 v6, v224, v226, v228
    v_max_u32 v6, v6, v230
    v_cmp_eq_u32 vcc, -1, v6
    v_mfma_f32_16x16x32_bf16 v[80:83], v[156:159], v[216:219], v[80:83]
    ds_read_b64_tr_b16 v[128:129], v9 offset:28736
    v_mfma_f32_16x16x32_bf16 v[84:87], v[156:159], v[220:223], v[84:87]
    ds_read_b64_tr_b16 v[130:131], v9 offset:32320
    v_mfma_f32_16x16x32_bf16 v[88:91], v[160:163], v[216:219], v[88:91]
    ds_read_b64_tr_b16 v[132:133], v9 offset:28768
    v_mfma_f32_16x16x32_bf16 v[92:95], v[160:163], v[220:223], v[92:95]
    ds_read_b64_tr_b16 v[134:135], v9 offset:32352
    v_mfma_f32_16x16x32_bf16 v[96:99], v[164:167], v[216:219], v[96:99]
    ds_read_b64_tr_b16 v[136:137], v9 offset:28800
    v_mfma_f32_16x16x32_bf16 v[100:103], v[164:167], v[220:223], v[100:103]
    ds_read_b64_tr_b16 v[138:139], v9 offset:32384
    s_cbranch_vccnz HBAD_66
HOK_67:
    v_mfma_f32_16x16x32_bf16 v[104:107], v[168:171], v[216:219], v[104:107]
    ds_read_b64_tr_b16 v[140:141], v9 offset:28832
    v_mfma_f32_16x16x32_bf16 v[108:111], v[168:171], v[220:223], v[108:111]
    ds_read_b64_tr_b16 v[142:143], v9 offset:32416
    v_swap_b32 v226, v228
    v_swap_b32 v227, v229
    v_mfma_f32_16x16x32_bf16 v[112:115], v[172:175], v[216:219], v[112:115]
    ds_read_b64_tr_b16 v[144:145], v9 offset:28864
    v_mfma_f32_16x16x32_bf16 v[116:119], v[172:175], v[220:223], v[116:119]
    ds_read_b64_tr_b16 v[146:147], v9 offset:32448
    s_waitcnt lgkmcnt(0)
    v_mfma_f32_16x16x32_bf16 v[64:67], v[120:123], v[224:227], v[64:67]
    ds_read_b64_tr_b16 v[148:149], v9 offset:35840
    v_mfma_f32_16x16x32_bf16 v[68:71], v[120:123], v[228:231], v[68:71]
    ds_read_b64_tr_b16 v[150:151], v9 offset:39424
    v_mfma_f32_16x16x32_bf16 v[72:75], v[124:127], v[224:227], v[72:75]
    ds_read_b64_tr_b16 v[152:153], v9 offset:35872
    v_mfma_f32_16x16x32_bf16 v[76:79], v[124:127], v[228:231], v[76:79]
    ds_read_b64_tr_b16 v[154:155], v9 offset:39456
    s_waitcnt vmcnt(12)
    v_max3_u32 v6, v16, v18, v20
    v_max_u32 v6, v6, v22
    v_cmp_eq_u32 vcc, -1, v6
    v_mfma_f32_16x16x32_bf16 v[80:83], v[128:131], v[224:227], v[80:83]
    ds_read_b64_tr_b16 v[156:157], v9 offset:35904
    v_mfma_f32_16x16x32_bf16 v[84:87], v[128:131], v[228:231], v[84:87]
    ds_read_b64_tr_b16 v[158:159], v9 offset:39488
    v_mfma_f32_16x16x32_bf16 v[88:91], v[132:135], v[224:227], v[88:91]
    ds_read_b64_tr_b16 v[160:161], v9 offset:35936
    v_mfma_f32_16x16x32_bf16 v[92:95], v[132:135], v[228:231], v[92:95]
    ds_read_b64_tr_b16 v[162:163], v9 offset:39520
    v_mfma_f32_16x16x32_bf16 v[96:99], v[136:139], v[224:227], v[96:99]
    ds_read_b64_tr_b16 v[164:165], v9 offset:35968
    v_mfma_f32_16x16x32_bf16 v[100:103], v[136:139], v[228:231], v[100:103]
    ds_read_b64_tr_b16 v[166:167], v9 offset:39552
    s_cbranch_vccnz HBAD_68
HOK_69:
    v_mfma_f32_16x16x32_bf16 v[104:107], v[140:143], v[224:227], v[104:107]
    ds_read_b64_tr_b16 v[168:169], v9 offset:36000
    v_mfma_f32_16x16x32_bf16 v[108:111], v[140:143], v[228:231], v[108:111]
    ds_read_b64_tr_b16 v[170:171], v9 offset:39584
    v_swap_b32 v18, v20
    v_swap_b32 v19, v21
    v_mfma_f32_16x16x32_bf16 v[112:115], v[144:147], v[224:227], v[112:115]
    ds_read_b64_tr_b16 v[172:173], v9 offset:36032
    v_mfma_f32_16x16x32_bf16 v[116:119], v[144:147], v[228:231], v[116:119]
    ds_read_b64_tr_b16 v[174:175], v9 offset:39616
    s_waitcnt lgkmcnt(0)
    v_mfma_f32_16x16x32_bf16 v[64:67], v[148:151], v[16:19], v[64:67]
    ds_read_b64_tr_b16 v[120:121], v9 offset:43008
    v_mfma_f32_16x16x32_bf16 v[68:71], v[148:151], v[20:23], v[68:71]
    ds_read_b64_tr_b16 v[122:123], v9 offset:46592
    v_mfma_f32_16x16x32_bf16 v[72:75], v[152:155], v[16:19], v[72:75]
    ds_read_b64_tr_b16 v[124:125], v9 offset:43040
    v_mfma_f32_16x16x32_bf16 v[76:79], v[152:155], v[20:23], v[76:79]
    ds_read_b64_tr_b16 v[126:127], v9 offset:46624
    s_waitcnt vmcnt(10)
    v_max3_u32 v6, v24, v26, v28
    v_max_u32 v6, v6, v30
    v_cmp_eq_u32 vcc, -1, v6
    v_mfma_f32_16x16x32_bf16 v[80:83], v[156:159], v[16:19], v[80:83]
    ds_read_b64_tr_b16 v[128:129], v9 offset:43072
    v_mfma_f32_16x16x32_bf16 v[84:87], v[156:159], v[20:23], v[84:87]
    ds_read_b64_tr_b16 v[130:131], v9 offset:46656
    v_mfma_f32_16x16x32_bf16 v[88:91], v[160:163], v[16:19], v[88:91]
    ds_read_b64_tr_b16 v[132:133], v9 offset:43104
    v_mfma_f32_16x16x32_bf16 v[92:95], v[160:163], v[20:23], v[92:95]
    ds_read_b64_tr_b16 v[134:135], v9 offset:46688
    v_mfma_f32_16x16x32_bf16 v[96:99], v[164:167], v[16:19], v[96:99]
    ds_read_b64_tr_b16 v[136:137], v9 offset:43136
    v_mfma_f32_16x16x32_bf16 v[100:103], v[164:167], v[20:23], v[100:103]
    ds_read_b64_tr_b16 v[138:139], v9 offset:46720
    s_cbranch_vccnz HBAD_70
HOK_71:
    v_mfma_f32_16x16x32_bf16 v[104:107], v[168:171], v[16:19], v[104:107]
    ds_read_b64_tr_b16 v[140:141], v9 offset:43168
    v_mfma_f32_16x16x32_bf16 v[108:111], v[168:171], v[20:23], v[108:111]
    ds_read_b64_tr_b16 v[142:143], v9 offset:46752
    v_swap_b32 v26, v28
    v_swap_b32 v27, v29
    v_mfma_f32_16x16x32_bf16 v[112:115], v[172:175], v[16:19], v[112:115]
    ds_read_b64_tr_b16 v[144:145], v9 offset:43200
    v_mfma_f32_16x16x32_bf16 v[116:119], v[172:175], v[20:23], v[116:119]
    ds_read_b64_tr_b16 v[146:147], v9 offset:46784
    s_waitcnt lgkmcnt(0)
    v_mfma_f32_16x16x32_bf16 v[64:67], v[120:123], v[24:27], v[64:67]
    ds_read_b64_tr_b16 v[148:149], v9 offset:50176
    v_mfma_f32_16x16x32_bf16 v[68:71], v[120:123], v[28:31], v[68:71]
    ds_read_b64_tr_b16 v[150:151], v9 offset:53760
    v_mfma_f32_16x16x32_bf16 v[72:75], v[124:127], v[24:27], v[72:75]
    ds_read_b64_tr_b16 v[152:153], v9 offset:50208
    v_mfma_f32_16x16x32_bf16 v[76:79], v[124:127], v[28:31], v[76:79]
    ds_read_b64_tr_b16 v[154:155], v9 offset:53792
    s_waitcnt vmcnt(8)
    v_max3_u32 v6, v32, v34, v36
    v_max_u32 v6, v6, v38
    v_cmp_eq_u32 vcc, -1, v6
    v_mfma_f32_16x16x32_bf16 v[80:83], v[128:131], v[24:27], v[80:83]
    ds_read_b64_tr_b16 v[156:157], v9 offset:50240
    v_mfma_f32_16x16x32_bf16 v[84:87], v[128:131], v[28:31], v[84:87]
    ds_read_b64_tr_b16 v[158:159], v9 offset:53824
    v_mfma_f32_16x16x32_bf16 v[88:91], v[132:135], v[24:27], v[88:91]
    ds_read_b64_tr_b16 v[160:161], v9 offset:50272
    v_mfma_f32_16x16x32_bf16 v[92:95], v[132:135], v[28:31], v[92:95]
    ds_read_b64_tr_b16 v[162:163], v9 offset:53856
    v_mfma_f32_16x16x32_bf16 v[96:99], v[136:139], v[24:27], v[96:99]
    ds_read_b64_tr_b16 v[164:165], v9 offset:50304
    v_mfma_f32_16x16x32_bf16 v[100:103], v[136:139], v[28:31], v[100:103]
    ds_read_b64_tr_b16 v[166:167], v9 offset:53888
    s_cbranch_vccnz HBAD_72
HOK_73:
    v_mfma_f32_16x16x32_bf16 v[104:107], v[140:143], v[24:27], v[104:107]
    ds_read_b64_tr_b16 v[168:169], v9 offset:50336
    v_mfma_f32_16x16x32_bf16 v[108:111], v[140:143], v[28:31], v[108:111]
    ds_read_b64_tr_b16 v[170:171], v9 offset:53920
    v_swap_b32 v34, v36
    v_swap_b32 v35, v37
    v_mfma_f32_16x16x32_bf16 v[112:115], v[144:147], v[24:27], v[112:115]
    ds_read_b64_tr_b16 v[172:173], v9 offset:50368
    v_mfma_f32_16x16x32_bf16 v[116:119], v[144:147], v[28:31], v[116:119]
    ds_read_b64_tr_b16 v[174:175], v9 offset:53952
    s_waitcnt lgkmcnt(0)
    v_mfma_f32_16x16x32_bf16 v[64:67], v[148:151], v[32:35], v[64:67]
    ds_read_b64_tr_b16 v[120:121], v10 offset:0
    v_mfma_f32_16x16x32_bf16 v[68:71], v[148:151], v[36:39], v[68:71]
    ds_read_b64_tr_b16 v[122:123], v10 offset:3584
    v_mfma_f32_16x16x32_bf16 v[72:75], v[152:155], v[32:35], v[72:75]
    ds_read_b64_tr_b16 v[124:125], v10 offset:32
    v_mfma_f32_16x16x32_bf16 v[76:79], v[152:155], v[36:39], v[76:79]
    ds_read_b64_tr_b16 v[126:127], v10 offset:3616
    s_waitcnt vmcnt(6)
    v_max3_u32 v6, v40, v42, v44
    v_max_u32 v6, v6, v46
    v_cmp_eq_u32 vcc, -1, v6
    v_mfma_f32_16x16x32_bf16 v[80:83], v[156:159], v[32:35], v[80:83]
    ds_read_b64_tr_b16 v[128:129], v10 offset:64
    v_mfma_f32_16x16x32_bf16 v[84:87], v[156:159], v[36:39], v[84:87]
    ds_read_b64_tr_b16 v[130:131], v10 offset:3648
    v_mfma_f32_16x16x32_bf16 v[88:91], v[160:163], v[32:35], v[88:91]
    ds_read_b64_tr_b16 v[132:133], v10 offset:96
    v_mfma_f32_16x16x32_bf16 v[92:95], v[160:163], v[36:39], v[92:95]
    ds_read_b64_tr_b16 v[134:135], v10 offset:3680
    v_mfma_f32_16x16x32_bf16 v[96:99], v[164:167], v[32:35], v[96:99]
    ds_read_b64_tr_b16 v[136:137], v10 offset:128
    v_mfma_f32_16x16x32_bf16 v[100:103], v[164:167], v[36:39], v[100:103]
    ds_read_b64_tr_b16 v[138:139], v10 offset:3712
    s_cbranch_vccnz HBAD_74
HOK_75:
    v_mfma_f32_16x16x32_bf16 v[104:107], v[168:171], v[32:35], v[104:107]
    ds_read_b64_tr_b16 v[140:141], v10 offset:160
    v_mfma_f32_16x16x32_bf16 v[108:111], v[168:171], v[36:39], v[108:111]
    ds_read_b64_tr_b16 v[142:143], v10 offset:3744
    v_swap_b32 v42, v44
    v_swap_b32 v43, v45
    v_mfma_f32_16x16x32_bf16 v[112:115], v[172:175], v[32:35], v[112:115]
    ds_read_b64_tr_b16 v[144:145], v10 offset:192
    v_mfma_f32_16x16x32_bf16 v[116:119], v[172:175], v[36:39], v[116:119]
    ds_read_b64_tr_b16 v[146:147], v10 offset:3776
    s_waitcnt lgkmcnt(0)
    v_mfma_f32_16x16x32_bf16 v[64:67], v[120:123], v[40:43], v[64:67]
    ds_read_b64_tr_b16 v[148:149], v10 offset:7168
    v_mfma_f32_16x16x32_bf16 v[68:71], v[120:123], v[44:47], v[68:71]
    ds_read_b64_tr_b16 v[150:151], v10 offset:10752
    v_mfma_f32_16x16x32_bf16 v[72:75], v[124:127], v[40:43], v[72:75]
    ds_read_b64_tr_b16 v[152:153], v10 offset:7200
    v_mfma_f32_16x16x32_bf16 v[76:79], v[124:127], v[44:47], v[76:79]
    ds_read_b64_tr_b16 v[154:155], v10 offset:10784
    s_waitcnt vmcnt(4)
    v_max3_u32 v6, v48, v50, v52
    v_max_u32 v6, v6, v54
    v_cmp_eq_u32 vcc, -1, v6
    v_mfma_f32_16x16x32_bf16 v[80:83], v[128:131], v[40:43], v[80:83]
    ds_read_b64_tr_b16 v[156:157], v10 offset:7232
    v_mfma_f32_16x16x32_bf16 v[84:87], v[128:131], v[44:47], v[84:87]
    ds_read_b64_tr_b16 v[158:159], v10 offset:10816
    v_mfma_f32_16x16x32_bf16 v[88:91], v[132:135], v[40:43], v[88:91]
    ds_read_b64_tr_b16 v[160:161], v10 offset:7264
    v_mfma_f32_16x16x32_bf16 v[92:95], v[132:135], v[44:47], v[92:95]
    ds_read_b64_tr_b16 v[162:163], v10 offset:10848
    v_mfma_f32_16x16x32_bf16 v[96:99], v[136:139], v[40:43], v[96:99]
    ds_read_b64_tr_b16 v[164:165], v10 offset:7296
    v_mfma_f32_16x16x32_bf16 v[100:103], v[136:139], v[44:47], v[100:103]
    ds_read_b64_tr_b16 v[166:167], v10 offset:10880
    s_cbranch_vccnz HBAD_76
HOK_77:
    v_mfma_f32_16x16x32_bf16 v[104:107], v[140:143], v[40:43], v[104:107]
    ds_read_b64_tr_b16 v[168:169], v10 offset:7328
    v_mfma_f32_16x16x32_bf16 v[108:111], v[140:143], v[44:47], v[108:111]
    ds_read_b64_tr_b16 v[170:171], v10 offset:10912
    v_swap_b32 v50, v52
    v_swap_b32 v51, v53
    v_mfma_f32_16x16x32_bf16 v[112:115], v[144:147], v[40:43], v[112:115]
    ds_read_b64_tr_b16 v[172:173], v10 offset:7360
    v_mfma_f32_16x16x32_bf16 v[116:119], v[144:147], v[44:47], v[116:119]
    ds_read_b64_tr_b16 v[174:175], v10 offset:10944
    s_waitcnt lgkmcnt(0)
    v_mfma_f32_16x16x32_bf16 v[64:67], v[148:151], v[48:51], v[64:67]
    ds_read_b64_tr_b16 v[120:121], v10 offset:14336
    v_mfma_f32_16x16x32_bf16 v[68:71], v[148:151], v[52:55], v[68:71]
    ds_read_b64_tr_b16 v[122:123], v10 offset:17920
    v_mfma_f32_16x16x32_bf16 v[72:75], v[152:155], v[48:51], v[72:75]
    ds_read_b64_tr_b16 v[124:125], v10 offset:14368
    v_mfma_f32_16x16x32_bf16 v[76:79], v[152:155], v[52:55], v[76:79]
    ds_read_b64_tr_b16 v[126:127], v10 offset:17952
    s_waitcnt vmcnt(2)
    v_max3_u32 v6, v56, v58, v60
    v_max_u32 v6, v6, v62
    v_cmp_eq_u32 vcc, -1, v6
    v_mfma_f32_16x16x32_bf16 v[80:83], v[156:159], v[48:51], v[80:83]
    ds_read_b64_tr_b16 v[128:129], v10 offset:14400
    v_mfma_f32_16x16x32_bf16 v[84:87], v[156:159], v[52:55], v[84:87]
    ds_read_b64_tr_b16 v[130:131], v10 offset:17984
    v_mfma_f32_16x16x32_bf16 v[88:91], v[160:163], v[48:51], v[88:91]
    ds_read_b64_tr_b16 v[132:133], v10 offset:14432
    v_mfma_f32_16x16x32_bf16 v[92:95], v[160:163], v[52:55], v[92:95]
    ds_read_b64_tr_b16 v[134:135], v10 offset:18016
    v_mfma_f32_16x16x32_bf16 v[96:99], v[164:167], v[48:51], v[96:99]
    ds_read_b64_tr_b16 v[136:137], v10 offset:14464
    v_mfma_f32_16x16x32_bf16 v[100:103], v[164:167], v[52:55], v[100:103]
    ds_read_b64_tr_b16 v[138:139], v10 offset:18048
    s_cbranch_vccnz HBAD_78
HOK_79:
    v_mfma_f32_16x16x32_bf16 v[104:107], v[168:171], v[48:51], v[104:107]
    ds_read_b64_tr_b16 v[140:141], v10 offset:14496
    v_mfma_f32_16x16x32_bf16 v[108:111], v[168:171], v[52:55], v[108:111]
    ds_read_b64_tr_b16 v[142:143], v10 offset:18080
    v_swap_b32 v58, v60
    v_swap_b32 v59, v61
    v_mfma_f32_16x16x32_bf16 v[112:115], v[172:175], v[48:51], v[112:115]
    ds_read_b64_tr_b16 v[144:145], v10 offset:14528
    v_mfma_f32_16x16x32_bf16 v[116:119], v[172:175], v[52:55], v[116:119]
    ds_read_b64_tr_b16 v[146:147], v10 offset:18112
    s_waitcnt lgkmcnt(0)
    v_mfma_f32_16x16x32_bf16 v[64:67], v[120:123], v[56:59], v[64:67]
    ds_read_b64_tr_b16 v[148:149], v10 offset:21504
    v_mfma_f32_16x16x32_bf16 v[68:71], v[120:123], v[60:63], v[68:71]
    ds_read_b64_tr_b16 v[150:151], v10 offset:25088
    v_mfma_f32_16x16x32_bf16 v[72:75], v[124:127], v[56:59], v[72:75]
    ds_read_b64_tr_b16 v[152:153], v10 offset:21536
    v_mfma_f32_16x16x32_bf16 v[76:79], v[124:127], v[60:63], v[76:79]
    ds_read_b64_tr_b16 v[154:155], v10 offset:25120
    s_waitcnt vmcnt(0)
    v_max3_u32 v6, v176, v178, v180
    v_max_u32 v6, v6, v182
    v_cmp_eq_u32 vcc, -1, v6
    v_mfma_f32_16x16x32_bf16 v[80:83], v[128:131], v[56:59], v[80:83]
    ds_read_b64_tr_b16 v[156:157], v10 offset:21568
    v_mfma_f32_16x16x32_bf16 v[84:87], v[128:131], v[60:63], v[84:87]
    ds_read_b64_tr_b16 v[158:159], v10 offset:25152
    v_mfma_f32_16x16x32_bf16 v[88:91], v[132:135], v[56:59], v[88:91]
    ds_read_b64_tr_b16 v[160:161], v10 offset:21600
    v_mfma_f32_16x16x32_bf16 v[92:95], v[132:135], v[60:63], v[92:95]
    ds_read_b64_tr_b16 v[162:163], v10 offset:25184
    v_mfma_f32_16x16x32_bf16 v[96:99], v[136:139], v[56:59], v[96:99]
    ds_read_b64_tr_b16 v[164:165], v10 offset:21632
    v_mfma_f32_16x16x32_bf16 v[100:103], v[136:139], v[60:63], v[100:103]
    ds_read_b64_tr_b16 v[166:167], v10 offset:25216
    s_cbranch_vccnz HBAD_80
HOK_81:
    v_mfma_f32_16x16x32_bf16 v[104:107], v[140:143], v[56:59], v[104:107]
    ds_read_b64_tr_b16 v[168:169], v10 offset:21664
    v_mfma_f32_16x16x32_bf16 v[108:111], v[140:143], v[60:63], v[108:111]
    ds_read_b64_tr_b16 v[170:171], v10 offset:25248
    v_swap_b32 v178, v180
    v_swap_b32 v179, v181
    v_mfma_f32_16x16x32_bf16 v[112:115], v[144:147], v[56:59], v[112:115]
    ds_read_b64_tr_b16 v[172:173], v10 offset:21696
    v_mfma_f32_16x16x32_bf16 v[116:119], v[144:147], v[60:63], v[116:119]
    ds_read_b64_tr_b16 v[174:175], v10 offset:25280
    s_waitcnt lgkmcnt(0)
    v_mfma_f32_16x16x32_bf16 v[64:67], v[148:151], v[176:179], v[64:67]
    v_mfma_f32_16x16x32_bf16 v[68:71], v[148:151], v[180:183], v[68:71]
    v_mfma_f32_16x16x32_bf16 v[72:75], v[152:155], v[176:179], v[72:75]
    v_mfma_f32_16x16x32_bf16 v[76:79], v[152:155], v[180:183], v[76:79]
    v_mfma_f32_16x16x32_bf16 v[80:83], v[156:159], v[176:179], v[80:83]
    v_mfma_f32_16x16x32_bf16 v[84:87], v[156:159], v[180:183], v[84:87]
    v_mfma_f32_16x16x32_bf16 v[88:91], v[160:163], v[176:179], v[88:91]
    v_mfma_f32_16x16x32_bf16 v[92:95], v[160:163], v[180:183], v[92:95]
    v_mfma_f32_16x16x32_bf16 v[96:99], v[164:167], v[176:179], v[96:99]
    v_mfma_f32_16x16x32_bf16 v[100:103], v[164:167], v[180:183], v[100:103]
    v_mfma_f32_16x16x32_bf16 v[104:107], v[168:171], v[176:179], v[104:107]
    v_mfma_f32_16x16x32_bf16 v[108:111], v[168:171], v[180:183], v[108:111]
    v_mfma_f32_16x16x32_bf16 v[112:115], v[172:175], v[176:179], v[112:115]
    v_mfma_f32_16x16x32_bf16 v[116:119], v[172:175], v[180:183], v[116:119]
    v_mov_b32 v6, 158804
LW_82:
    ds_read_b32 v7, v6
    s_waitcnt lgkmcnt(0)
    v_readfirstlane_b32 s13, v7
    s_cmp_ge_u32 s13, 2
    s_cbranch_scc1 LWD_83
    s_sleep 1
    s_branch LW_82
LWD_83:
    v_lshlrev_b32 v6, 4, v2
    s_lshl_b32 s13, s3, 8
    s_add_u32 s13, s13, 158976
    v_add_u32 v6, s13, v6
    ds_read_b128 v[12:15], v6
    v_lshlrev_b32 v7, 4, v3
    v_add_u32 v7, 158720, v7
    ds_read_b128 v[120:123], v7 offset:1280
    ds_read_b128 v[148:151], v7 offset:1792
    ds_read_b128 v[124:127], v7 offset:1344
    ds_read_b128 v[152:155], v7 offset:1856
    ds_read_b128 v[128:131], v7 offset:1408
    ds_read_b128 v[156:159], v7 offset:1920
    ds_read_b128 v[132:135], v7 offset:1472
    ds_read_b128 v[160:163], v7 offset:1984
    ds_read_b128 v[136:139], v7 offset:1536
    ds_read_b128 v[164:167], v7 offset:2048
    ds_read_b128 v[140:143], v7 offset:1600
    ds_read_b128 v[168:171], v7 offset:2112
    ds_read_b128 v[144:147], v7 offset:1664
    ds_read_b128 v[172:175], v7 offset:2176
    s_lshl_b32 s27, s66, 3
    s_lshl_b32 s28, s3, 1
    s_add_u32 s27, s27, s28
    s_lshl_b32 s27, s27, 10
    s_add_u32 s27, s27, 0x400000
    s_mul_i32 s28, s67, 7
    s_waitcnt lgkmcnt(0)
    s_bitcmp1_b32 s67, 0
    s_cbranch_scc1 L_B_ODD
    s_add_u32 s29, s28, 0
    s_lshr_b32 s29, s29, 1
    s_lshl_b32 s29, s29, 17
    s_add_u32 s29, s29, s27
    v_pk_fma_f32 v[232:233], v[120:121], v[12:13], v[148:149] op_sel:[0,0,0] op_sel_hi:[1,0,1] neg_lo:[0,1,0] neg_hi:[0,1,0]
    v_pk_fma_f32 v[234:235], v[122:123], v[12:13], v[150:151] op_sel:[0,0,0] op_sel_hi:[1,0,1] neg_lo:[0,1,0] neg_hi:[0,1,0]
    v_pk_fma_f32 v[232:233], v[64:65], v[12:13], v[232:233] op_sel:[0,1,0] op_sel_hi:[1,1,1]
    v_pk_fma_f32 v[234:235], v[66:67], v[12:13], v[234:235] op_sel:[0,1,0] op_sel_hi:[1,1,1]
    v_max_f32 v232, 0, v232
    v_max_f32 v233, 0, v233
    v_max_f32 v234, 0, v234
    v_max_f32 v235, 0, v235
    v_pk_mul_f32 v[232:233], v[232:233], v[232:233]
    v_pk_mul_f32 v[234:235], v[234:235], v[234:235]
    v_cvt_pk_bf16_f32 v16, v232, v233
    v_cvt_pk_bf16_f32 v17, v234, v235
    v_pk_fma_f32 v[236:237], v[124:125], v[12:13], v[152:153] op_sel:[0,0,0] op_sel_hi:[1,0,1] neg_lo:[0,1,0] neg_hi:[0,1,0]
    v_pk_fma_f32 v[238:239], v[126:127], v[12:13], v[154:155] op_sel:[0,0,0] op_sel_hi:[1,0,1] neg_lo:[0,1,0] neg_hi:[0,1,0]
    v_pk_fma_f32 v[236:237], v[72:73], v[12:13], v[236:237] op_sel:[0,1,0] op_sel_hi:[1,1,1]
    v_pk_fma_f32 v[238:239], v[74:75], v[12:13], v[238:239] op_sel:[0,1,0] op_sel_hi:[1,1,1]
    v_max_f32 v236, 0, v236
    v_max_f32 v237, 0, v237
    v_max_f32 v238, 0, v238
    v_max_f32 v239, 0, v239
    v_pk_mul_f32 v[236:237], v[236:237], v[236:237]
    v_pk_mul_f32 v[238:239], v[238:239], v[238:239]
    v_cvt_pk_bf16_f32 v18, v236, v237
    v_cvt_pk_bf16_f32 v19, v238, v239
    buffer_store_dwordx4 v[16:19], v4, s[8:11], s29 offen offset:0 sc1
    v_pk_fma_f32 v[244:245], v[120:121], v[14:15], v[148:149] op_sel:[0,0,0] op_sel_hi:[1,0,1] neg_lo:[0,1,0] neg_hi:[0,1,0]
    v_pk_fma_f32 v[246:247], v[122:123], v[14:15], v[150:151] op_sel:[0,0,0] op_sel_hi:[1,0,1] neg_lo:[0,1,0] neg_hi:[0,1,0]
    v_pk_fma_f32 v[244:245], v[68:69], v[14:15], v[244:245] op_sel:[0,1,0] op_sel_hi:[1,1,1]
    v_pk_fma_f32 v[246:247], v[70:71], v[14:15], v[246:247] op_sel:[0,1,0] op_sel_hi:[1,1,1]
    v_max_f32 v244, 0, v244
    v_max_f32 v245, 0, v245
    v_max_f32 v246, 0, v246
    v_max_f32 v247, 0, v247
    v_pk_mul_f32 v[244:245], v[244:245], v[244:245]
    v_pk_mul_f32 v[246:247], v[246:247], v[246:247]
    v_cvt_pk_bf16_f32 v20, v244, v245
    v_cvt_pk_bf16_f32 v21, v246, v247
    v_pk_fma_f32 v[240:241], v[124:125], v[14:15], v[152:153] op_sel:[0,0,0] op_sel_hi:[1,0,1] neg_lo:[0,1,0] neg_hi:[0,1,0]
    v_pk_fma_f32 v[242:243], v[126:127], v[14:15], v[154:155] op_sel:[0,0,0] op_sel_hi:[1,0,1] neg_lo:[0,1,0] neg_hi:[0,1,0]
    v_pk_fma_f32 v[240:241], v[76:77], v[14:15], v[240:241] op_sel:[0,1,0] op_sel_hi:[1,1,1]
    v_pk_fma_f32 v[242:243], v[78:79], v[14:15], v[242:243] op_sel:[0,1,0] op_sel_hi:[1,1,1]
    v_max_f32 v240, 0, v240
    v_max_f32 v241, 0, v241
    v_max_f32 v242, 0, v242
    v_max_f32 v243, 0, v243
    v_pk_mul_f32 v[240:241], v[240:241], v[240:241]
    v_pk_mul_f32 v[242:243], v[242:243], v[242:243]
    v_cvt_pk_bf16_f32 v22, v240, v241
    v_cvt_pk_bf16_f32 v23, v242, v243
    buffer_store_dwordx4 v[20:23], v4, s[8:11], s29 offen offset:1024 sc1
    s_add_u32 s29, s28, 2
    s_lshr_b32 s29, s29, 1
    s_lshl_b32 s29, s29, 17
    s_add_u32 s29, s29, s27
    v_pk_fma_f32 v[232:233], v[128:129], v[12:13], v[156:157] op_sel:[0,0,0] op_sel_hi:[1,0,1] neg_lo:[0,1,0] neg_hi:[0,1,0]
    v_pk_fma_f32 v[234:235], v[130:131], v[12:13], v[158:159] op_sel:[0,0,0] op_sel_hi:[1,0,1] neg_lo:[0,1,0] neg_hi:[0,1,0]
    v_pk_fma_f32 v[232:233], v[80:81], v[12:13], v[232:233] op_sel:[0,1,0] op_sel_hi:[1,1,1]
    v_pk_fma_f32 v[234:235], v[82:83], v[12:13], v[234:235] op_sel:[0,1,0] op_sel_hi:[1,1,1]
    v_max_f32 v232, 0, v232
    v_max_f32 v233, 0, v233
    v_max_f32 v234, 0, v234
    v_max_f32 v235, 0, v235
    v_pk_mul_f32 v[232:233], v[232:233], v[232:233]
    v_pk_mul_f32 v[234:235], v[234:235], v[234:235]
    v_cvt_pk_bf16_f32 v24, v232, v233
    v_cvt_pk_bf16_f32 v25, v234, v235
    v_pk_fma_f32 v[236:237], v[132:133], v[12:13], v[160:161] op_sel:[0,0,0] op_sel_hi:[1,0,1] neg_lo:[0,1,0] neg_hi:[0,1,0]
    v_pk_fma_f32 v[238:239], v[134:135], v[12:13], v[162:163] op_sel:[0,0,0] op_sel_hi:[1,0,1] neg_lo:[0,1,0] neg_hi:[0,1,0]
    v_pk_fma_f32 v[236:237], v[88:89], v[12:13], v[236:237] op_sel:[0,1,0] op_sel_hi:[1,1,1]
    v_pk_fma_f32 v[238:239], v[90:91], v[12:13], v[238:239] op_sel:[0,1,0] op_sel_hi:[1,1,1]
    v_max_f32 v236, 0, v236
    v_max_f32 v237, 0, v237
    v_max_f32 v238, 0, v238
    v_max_f32 v239, 0, v239
    v_pk_mul_f32 v[236:237], v[236:237], v[236:237]
    v_pk_mul_f32 v[238:239], v[238:239], v[238:239]
    v_cvt_pk_bf16_f32 v26, v236, v237
    v_cvt_pk_bf16_f32 v27, v238, v239
    buffer_store_dwordx4 v[24:27], v4, s[8:11], s29 offen offset:0 sc1
    v_pk_fma_f32 v[244:245], v[128:129], v[14:15], v[156:157] op_sel:[0,0,0] op_sel_hi:[1,0,1] neg_lo:[0,1,0] neg_hi:[0,1,0]
    v_pk_fma_f32 v[246:247], v[130:131], v[14:15], v[158:159] op_sel:[0,0,0] op_sel_hi:[1,0,1] neg_lo:[0,1,0] neg_hi:[0,1,0]
    v_pk_fma_f32 v[244:245], v[84:85], v[14:15], v[244:245] op_sel:[0,1,0] op_sel_hi:[1,1,1]
    v_pk_fma_f32 v[246:247], v[86:87], v[14:15], v[246:247] op_sel:[0,1,0] op_sel_hi:[1,1,1]
    v_max_f32 v244, 0, v244
    v_max_f32 v245, 0, v245
    v_max_f32 v246, 0, v246
    v_max_f32 v247, 0, v247
    v_pk_mul_f32 v[244:245], v[244:245], v[244:245]
    v_pk_mul_f32 v[246:247], v[246:247], v[246:247]
    v_cvt_pk_bf16_f32 v28, v244, v245
    v_cvt_pk_bf16_f32 v29, v246, v247
    v_pk_fma_f32 v[240:241], v[132:133], v[14:15], v[160:161] op_sel:[0,0,0] op_sel_hi:[1,0,1] neg_lo:[0,1,0] neg_hi:[0,1,0]
    v_pk_fma_f32 v[242:243], v[134:135], v[14:15], v[162:163] op_sel:[0,0,0] op_sel_hi:[1,0,1] neg_lo:[0,1,0] neg_hi:[0,1,0]
    v_pk_fma_f32 v[240:241], v[92:93], v[14:15], v[240:241] op_sel:[0,1,0] op_sel_hi:[1,1,1]
    v_pk_fma_f32 v[242:243], v[94:95], v[14:15], v[242:243] op_sel:[0,1,0] op_sel_hi:[1,1,1]
    v_max_f32 v240, 0, v240
    v_max_f32 v241, 0, v241
    v_max_f32 v242, 0, v242
    v_max_f32 v243, 0, v243
    v_pk_mul_f32 v[240:241], v[240:241], v[240:241]
    v_pk_mul_f32 v[242:243], v[242:243], v[242:243]
    v_cvt_pk_bf16_f32 v30, v240, v241
    v_cvt_pk_bf16_f32 v31, v242, v243
    buffer_store_dwordx4 v[28:31], v4, s[8:11], s29 offen offset:1024 sc1
    s_add_u32 s29, s28, 4
    s_lshr_b32 s29, s29, 1
    s_lshl_b32 s29, s29, 17
    s_add_u32 s29, s29, s27
    v_pk_fma_f32 v[232:233], v[136:137], v[12:13], v[164:165] op_sel:[0,0,0] op_sel_hi:[1,0,1] neg_lo:[0,1,0] neg_hi:[0,1,0]
    v_pk_fma_f32 v[234:235], v[138:139], v[12:13], v[166:167] op_sel:[0,0,0] op_sel_hi:[1,0,1] neg_lo:[0,1,0] neg_hi:[0,1,0]
    v_pk_fma_f32 v[232:233], v[96:97], v[12:13], v[232:233] op_sel:[0,1,0] op_sel_hi:[1,1,1]
    v_pk_fma_f32 v[234:235], v[98:99], v[12:13], v[234:235] op_sel:[0,1,0] op_sel_hi:[1,1,1]
    v_max_f32 v232, 0, v232
    v_max_f32 v233, 0, v233
    v_max_f32 v234, 0, v234
    v_max_f32 v235, 0, v235
    v_pk_mul_f32 v[232:233], v[232:233], v[232:233]
    v_pk_mul_f32 v[234:235], v[234:235], v[234:235]
    v_cvt_pk_bf16_f32 v32, v232, v233
    v_cvt_pk_bf16_f32 v33, v234, v235
    v_pk_fma_f32 v[236:237], v[140:141], v[12:13], v[168:169] op_sel:[0,0,0] op_sel_hi:[1,0,1] neg_lo:[0,1,0] neg_hi:[0,1,0]
    v_pk_fma_f32 v[238:239], v[142:143], v[12:13], v[170:171] op_sel:[0,0,0] op_sel_hi:[1,0,1] neg_lo:[0,1,0] neg_hi:[0,1,0]
    v_pk_fma_f32 v[236:237], v[104:105], v[12:13], v[236:237] op_sel:[0,1,0] op_sel_hi:[1,1,1]
    v_pk_fma_f32 v[238:239], v[106:107], v[12:13], v[238:239] op_sel:[0,1,0] op_sel_hi:[1,1,1]
    v_max_f32 v236, 0, v236
    v_max_f32 v237, 0, v237
    v_max_f32 v238, 0, v238
    v_max_f32 v239, 0, v239
    v_pk_mul_f32 v[236:237], v[236:237], v[236:237]
    v_pk_mul_f32 v[238:239], v[238:239], v[238:239]
    v_cvt_pk_bf16_f32 v34, v236, v237
    v_cvt_pk_bf16_f32 v35, v238, v239
    buffer_store_dwordx4 v[32:35], v4, s[8:11], s29 offen offset:0 sc1
    v_pk_fma_f32 v[244:245], v[136:137], v[14:15], v[164:165] op_sel:[0,0,0] op_sel_hi:[1,0,1] neg_lo:[0,1,0] neg_hi:[0,1,0]
    v_pk_fma_f32 v[246:247], v[138:139], v[14:15], v[166:167] op_sel:[0,0,0] op_sel_hi:[1,0,1] neg_lo:[0,1,0] neg_hi:[0,1,0]
    v_pk_fma_f32 v[244:245], v[100:101], v[14:15], v[244:245] op_sel:[0,1,0] op_sel_hi:[1,1,1]
    v_pk_fma_f32 v[246:247], v[102:103], v[14:15], v[246:247] op_sel:[0,1,0] op_sel_hi:[1,1,1]
    v_max_f32 v244, 0, v244
    v_max_f32 v245, 0, v245
    v_max_f32 v246, 0, v246
    v_max_f32 v247, 0, v247
    v_pk_mul_f32 v[244:245], v[244:245], v[244:245]
    v_pk_mul_f32 v[246:247], v[246:247], v[246:247]
    v_cvt_pk_bf16_f32 v36, v244, v245
    v_cvt_pk_bf16_f32 v37, v246, v247
    v_pk_fma_f32 v[240:241], v[140:141], v[14:15], v[168:169] op_sel:[0,0,0] op_sel_hi:[1,0,1] neg_lo:[0,1,0] neg_hi:[0,1,0]
    v_pk_fma_f32 v[242:243], v[142:143], v[14:15], v[170:171] op_sel:[0,0,0] op_sel_hi:[1,0,1] neg_lo:[0,1,0] neg_hi:[0,1,0]
    v_pk_fma_f32 v[240:241], v[108:109], v[14:15], v[240:241] op_sel:[0,1,0] op_sel_hi:[1,1,1]
    v_pk_fma_f32 v[242:243], v[110:111], v[14:15], v[242:243] op_sel:[0,1,0] op_sel_hi:[1,1,1]
    v_max_f32 v240, 0, v240
    v_max_f32 v241, 0, v241
    v_max_f32 v242, 0, v242
    v_max_f32 v243, 0, v243
    v_pk_mul_f32 v[240:241], v[240:241], v[240:241]
    v_pk_mul_f32 v[242:243], v[242:243], v[242:243]
    v_cvt_pk_bf16_f32 v38, v240, v241
    v_cvt_pk_bf16_f32 v39, v242, v243
    buffer_store_dwordx4 v[36:39], v4, s[8:11], s29 offen offset:1024 sc1
    s_add_u32 s29, s28, 6
    s_lshr_b32 s29, s29, 1
    s_lshl_b32 s29, s29, 17
    s_add_u32 s29, s29, s27
    v_pk_fma_f32 v[232:233], v[144:145], v[12:13], v[172:173] op_sel:[0,0,0] op_sel_hi:[1,0,1] neg_lo:[0,1,0] neg_hi:[0,1,0]
    v_pk_fma_f32 v[234:235], v[146:147], v[12:13], v[174:175] op_sel:[0,0,0] op_sel_hi:[1,0,1] neg_lo:[0,1,0] neg_hi:[0,1,0]
    v_pk_fma_f32 v[232:233], v[112:113], v[12:13], v[232:233] op_sel:[0,1,0] op_sel_hi:[1,1,1]
    v_pk_fma_f32 v[234:235], v[114:115], v[12:13], v[234:235] op_sel:[0,1,0] op_sel_hi:[1,1,1]
    v_max_f32 v232, 0, v232
    v_max_f32 v233, 0, v233
    v_max_f32 v234, 0, v234
    v_max_f32 v235, 0, v235
    v_pk_mul_f32 v[232:233], v[232:233], v[232:233]
    v_pk_mul_f32 v[234:235], v[234:235], v[234:235]
    v_cvt_pk_bf16_f32 v40, v232, v233
    v_cvt_pk_bf16_f32 v41, v234, v235
    buffer_store_dwordx2 v[40:41], v4, s[8:11], s29 offen offset:0 sc1
    v_pk_fma_f32 v[244:245], v[144:145], v[14:15], v[172:173] op_sel:[0,0,0] op_sel_hi:[1,0,1] neg_lo:[0,1,0] neg_hi:[0,1,0]
    v_pk_fma_f32 v[246:247], v[146:147], v[14:15], v[174:175] op_sel:[0,0,0] op_sel_hi:[1,0,1] neg_lo:[0,1,0] neg_hi:[0,1,0]
    v_pk_fma_f32 v[244:245], v[116:117], v[14:15], v[244:245] op_sel:[0,1,0] op_sel_hi:[1,1,1]
    v_pk_fma_f32 v[246:247], v[118:119], v[14:15], v[246:247] op_sel:[0,1,0] op_sel_hi:[1,1,1]
    v_max_f32 v244, 0, v244
    v_max_f32 v245, 0, v245
    v_max_f32 v246, 0, v246
    v_max_f32 v247, 0, v247
    v_pk_mul_f32 v[244:245], v[244:245], v[244:245]
    v_pk_mul_f32 v[246:247], v[246:247], v[246:247]
    v_cvt_pk_bf16_f32 v44, v244, v245
    v_cvt_pk_bf16_f32 v45, v246, v247
    buffer_store_dwordx2 v[44:45], v4, s[8:11], s29 offen offset:1024 sc1
    s_branch L_B_STD
L_B_ODD:
    s_add_u32 s29, s28, 0
    s_lshr_b32 s29, s29, 1
    s_lshl_b32 s29, s29, 17
    s_add_u32 s29, s29, s27
    v_pk_fma_f32 v[232:233], v[120:121], v[12:13], v[148:149] op_sel:[0,0,0] op_sel_hi:[1,0,1] neg_lo:[0,1,0] neg_hi:[0,1,0]
    v_pk_fma_f32 v[234:235], v[122:123], v[12:13], v[150:151] op_sel:[0,0,0] op_sel_hi:[1,0,1] neg_lo:[0,1,0] neg_hi:[0,1,0]
    v_pk_fma_f32 v[232:233], v[64:65], v[12:13], v[232:233] op_sel:[0,1,0] op_sel_hi:[1,1,1]
    v_pk_fma_f32 v[234:235], v[66:67], v[12:13], v[234:235] op_sel:[0,1,0] op_sel_hi:[1,1,1]
    v_max_f32 v232, 0, v232
    v_max_f32 v233, 0, v233
    v_max_f32 v234, 0, v234
    v_max_f32 v235, 0, v235
    v_pk_mul_f32 v[232:233], v[232:233], v[232:233]
    v_pk_mul_f32 v[234:235], v[234:235], v[234:235]
    v_cvt_pk_bf16_f32 v16, v232, v233
    v_cvt_pk_bf16_f32 v17, v234, v235
    buffer_store_dwordx2 v[16:17], v4, s[8:11], s29 offen offset:8 sc1
    v_pk_fma_f32 v[244:245], v[120:121], v[14:15], v[148:149] op_sel:[0,0,0] op_sel_hi:[1,0,1] neg_lo:[0,1,0] neg_hi:[0,1,0]
    v_pk_fma_f32 v[246:247], v[122:123], v[14:15], v[150:151] op_sel:[0,0,0] op_sel_hi:[1,0,1] neg_lo:[0,1,0] neg_hi:[0,1,0]
    v_pk_fma_f32 v[244:245], v[68:69], v[14:15], v[244:245] op_sel:[0,1,0] op_sel_hi:[1,1,1]
    v_pk_fma_f32 v[246:247], v[70:71], v[14:15], v[246:247] op_sel:[0,1,0] op_sel_hi:[1,1,1]
    v_max_f32 v244, 0, v244
    v_max_f32 v245, 0, v245
    v_max_f32 v246, 0, v246
    v_max_f32 v247, 0, v247
    v_pk_mul_f32 v[244:245], v[244:245], v[244:245]
    v_pk_mul_f32 v[246:247], v[246:247], v[246:247]
    v_cvt_pk_bf16_f32 v20, v244, v245
    v_cvt_pk_bf16_f32 v21, v246, v247
    buffer_store_dwordx2 v[20:21], v4, s[8:11], s29 offen offset:1032 sc1
    s_add_u32 s29, s28, 1
    s_lshr_b32 s29, s29, 1
    s_lshl_b32 s29, s29, 17
    s_add_u32 s29, s29, s27
    v_pk_fma_f32 v[236:237], v[124:125], v[12:13], v[152:153] op_sel:[0,0,0] op_sel_hi:[1,0,1] neg_lo:[0,1,0] neg_hi:[0,1,0]
    v_pk_fma_f32 v[238:239], v[126:127], v[12:13], v[154:155] op_sel:[0,0,0] op_sel_hi:[1,0,1] neg_lo:[0,1,0] neg_hi:[0,1,0]
    v_pk_fma_f32 v[236:237], v[72:73], v[12:13], v[236:237] op_sel:[0,1,0] op_sel_hi:[1,1,1]
    v_pk_fma_f32 v[238:239], v[74:75], v[12:13], v[238:239] op_sel:[0,1,0] op_sel_hi:[1,1,1]
    v_max_f32 v236, 0, v236
    v_max_f32 v237, 0, v237
    v_max_f32 v238, 0, v238
    v_max_f32 v239, 0, v239
    v_pk_mul_f32 v[236:237], v[236:237], v[236:237]
    v_pk_mul_f32 v[238:239], v[238:239], v[238:239]
    v_cvt_pk_bf16_f32 v24, v236, v237
    v_cvt_pk_bf16_f32 v25, v238, v239
    v_pk_fma_f32 v[232:233], v[128:129], v[12:13], v[156:157] op_sel:[0,0,0] op_sel_hi:[1,0,1] neg_lo:[0,1,0] neg_hi:[0,1,0]
    v_pk_fma_f32 v[234:235], v[130:131], v[12:13], v[158:159] op_sel:[0,0,0] op_sel_hi:[1,0,1] neg_lo:[0,1,0] neg_hi:[0,1,0]
    v_pk_fma_f32 v[232:233], v[80:81], v[12:13], v[232:233] op_sel:[0,1,0] op_sel_hi:[1,1,1]
    v_pk_fma_f32 v[234:235], v[82:83], v[12:13], v[234:235] op_sel:[0,1,0] op_sel_hi:[1,1,1]
    v_max_f32 v232, 0, v232
    v_max_f32 v233, 0, v233
    v_max_f32 v234, 0, v234
    v_max_f32 v235, 0, v235
    v_pk_mul_f32 v[232:233], v[232:233], v[232:233]
    v_pk_mul_f32 v[234:235], v[234:235], v[234:235]
    v_cvt_pk_bf16_f32 v26, v232, v233
    v_cvt_pk_bf16_f32 v27, v234, v235
    buffer_store_dwordx4 v[24:27], v4, s[8:11], s29 offen offset:0 sc1
    v_pk_fma_f32 v[240:241], v[124:125], v[14:15], v[152:153] op_sel:[0,0,0] op_sel_hi:[1,0,1] neg_lo:[0,1,0] neg_hi:[0,1,0]
    v_pk_fma_f32 v[242:243], v[126:127], v[14:15], v[154:155] op_sel:[0,0,0] op_sel_hi:[1,0,1] neg_lo:[0,1,0] neg_hi:[0,1,0]
    v_pk_fma_f32 v[240:241], v[76:77], v[14:15], v[240:241] op_sel:[0,1,0] op_sel_hi:[1,1,1]
    v_pk_fma_f32 v[242:243], v[78:79], v[14:15], v[242:243] op_sel:[0,1,0] op_sel_hi:[1,1,1]
    v_max_f32 v240, 0, v240
    v_max_f32 v241, 0, v241
    v_max_f32 v242, 0, v242
    v_max_f32 v243, 0, v243
    v_pk_mul_f32 v[240:241], v[240:241], v[240:241]
    v_pk_mul_f32 v[242:243], v[242:243], v[242:243]
    v_cvt_pk_bf16_f32 v28, v240, v241
    v_cvt_pk_bf16_f32 v29, v242, v243
    v_pk_fma_f32 v[244:245], v[128:129], v[14:15], v[156:157] op_sel:[0,0,0] op_sel_hi:[1,0,1] neg_lo:[0,1,0] neg_hi:[0,1,0]
    v_pk_fma_f32 v[246:247], v[130:131], v[14:15], v[158:159] op_sel:[0,0,0] op_sel_hi:[1,0,1] neg_lo:[0,1,0] neg_hi:[0,1,0]
    v_pk_fma_f32 v[244:245], v[84:85], v[14:15], v[244:245] op_sel:[0,1,0] op_sel_hi:[1,1,1]
    v_pk_fma_f32 v[246:247], v[86:87], v[14:15], v[246:247] op_sel:[0,1,0] op_sel_hi:[1,1,1]
    v_max_f32 v244, 0, v244
    v_max_f32 v245, 0, v245
    v_max_f32 v246, 0, v246
    v_max_f32 v247, 0, v247
    v_pk_mul_f32 v[244:245], v[244:245], v[244:245]
    v_pk_mul_f32 v[246:247], v[246:247], v[246:247]
    v_cvt_pk_bf16_f32 v30, v244, v245
    v_cvt_pk_bf16_f32 v31, v246, v247
    buffer_store_dwordx4 v[28:31], v4, s[8:11], s29 offen offset:1024 sc1
    s_add_u32 s29, s28, 3
    s_lshr_b32 s29, s29, 1
    s_lshl_b32 s29, s29, 17
    s_add_u32 s29, s29, s27
    v_pk_fma_f32 v[236:237], v[132:133], v[12:13], v[160:161] op_sel:[0,0,0] op_sel_hi:[1,0,1] neg_lo:[0,1,0] neg_hi:[0,1,0]
    v_pk_fma_f32 v[238:239], v[134:135], v[12:13], v[162:163] op_sel:[0,0,0] op_sel_hi:[1,0,1] neg_lo:[0,1,0] neg_hi:[0,1,0]
    v_pk_fma_f32 v[236:237], v[88:89], v[12:13], v[236:237] op_sel:[0,1,0] op_sel_hi:[1,1,1]
    v_pk_fma_f32 v[238:239], v[90:91], v[12:13], v[238:239] op_sel:[0,1,0] op_sel_hi:[1,1,1]
    v_max_f32 v236, 0, v236
    v_max_f32 v237, 0, v237
    v_max_f32 v238, 0, v238
    v_max_f32 v239, 0, v239
    v_pk_mul_f32 v[236:237], v[236:237], v[236:237]
    v_pk_mul_f32 v[238:239], v[238:239], v[238:239]
    v_cvt_pk_bf16_f32 v32, v236, v237
    v_cvt_pk_bf16_f32 v33, v238, v239
    v_pk_fma_f32 v[232:233], v[136:137], v[12:13], v[164:165] op_sel:[0,0,0] op_sel_hi:[1,0,1] neg_lo:[0,1,0] neg_hi:[0,1,0]
    v_pk_fma_f32 v[234:235], v[138:139], v[12:13], v[166:167] op_sel:[0,0,0] op_sel_hi:[1,0,1] neg_lo:[0,1,0] neg_hi:[0,1,0]
    v_pk_fma_f32 v[232:233], v[96:97], v[12:13], v[232:233] op_sel:[0,1,0] op_sel_hi:[1,1,1]
    v_pk_fma_f32 v[234:235], v[98:99], v[12:13], v[234:235] op_sel:[0,1,0] op_sel_hi:[1,1,1]
    v_max_f32 v232, 0, v232
    v_max_f32 v233, 0, v233
    v_max_f32 v234, 0, v234
    v_max_f32 v235, 0, v235
    v_pk_mul_f32 v[232:233], v[232:233], v[232:233]
    v_pk_mul_f32 v[234:235], v[234:235], v[234:235]
    v_cvt_pk_bf16_f32 v34, v232, v233
    v_cvt_pk_bf16_f32 v35, v234, v235
    buffer_store_dwordx4 v[32:35], v4, s[8:11], s29 offen offset:0 sc1
    v_pk_fma_f32 v[240:241], v[132:133], v[14:15], v[160:161] op_sel:[0,0,0] op_sel_hi:[1,0,1] neg_lo:[0,1,0] neg_hi:[0,1,0]
    v_pk_fma_f32 v[242:243], v[134:135], v[14:15], v[162:163] op_sel:[0,0,0] op_sel_hi:[1,0,1] neg_lo:[0,1,0] neg_hi:[0,1,0]
    v_pk_fma_f32 v[240:241], v[92:93], v[14:15], v[240:241] op_sel:[0,1,0] op_sel_hi:[1,1,1]
    v_pk_fma_f32 v[242:243], v[94:95], v[14:15], v[242:243] op_sel:[0,1,0] op_sel_hi:[1,1,1]
    v_max_f32 v240, 0, v240
    v_max_f32 v241, 0, v241
    v_max_f32 v242, 0, v242
    v_max_f32 v243, 0, v243
    v_pk_mul_f32 v[240:241], v[240:241], v[240:241]
    v_pk_mul_f32 v[242:243], v[242:243], v[242:243]
    v_cvt_pk_bf16_f32 v36, v240, v241
    v_cvt_pk_bf16_f32 v37, v242, v243
    v_pk_fma_f32 v[244:245], v[136:137], v[14:15], v[164:165] op_sel:[0,0,0] op_sel_hi:[1,0,1] neg_lo:[0,1,0] neg_hi:[0,1,0]
    v_pk_fma_f32 v[246:247], v[138:139], v[14:15], v[166:167] op_sel:[0,0,0] op_sel_hi:[1,0,1] neg_lo:[0,1,0] neg_hi:[0,1,0]
    v_pk_fma_f32 v[244:245], v[100:101], v[14:15], v[244:245] op_sel:[0,1,0] op_sel_hi:[1,1,1]
    v_pk_fma_f32 v[246:247], v[102:103], v[14:15], v[246:247] op_sel:[0,1,0] op_sel_hi:[1,1,1]
    v_max_f32 v244, 0, v244
    v_max_f32 v245, 0, v245
    v_max_f32 v246, 0, v246
    v_max_f32 v247, 0, v247
    v_pk_mul_f32 v[244:245], v[244:245], v[244:245]
    v_pk_mul_f32 v[246:247], v[246:247], v[246:247]
    v_cvt_pk_bf16_f32 v38, v244, v245
    v_cvt_pk_bf16_f32 v39, v246, v247
    buffer_store_dwordx4 v[36:39], v4, s[8:11], s29 offen offset:1024 sc1
    s_add_u32 s29, s28, 5
    s_lshr_b32 s29, s29, 1
    s_lshl_b32 s29, s29, 17
    s_add_u32 s29, s29, s27
    v_pk_fma_f32 v[236:237], v[140:141], v[12:13], v[168:169] op_sel:[0,0,0] op_sel_hi:[1,0,1] neg_lo:[0,1,0] neg_hi:[0,1,0]
    v_pk_fma_f32 v[238:239], v[142:143], v[12:13], v[170:171] op_sel:[0,0,0] op_sel_hi:[1,0,1] neg_lo:[0,1,0] neg_hi:[0,1,0]
    v_pk_fma_f32 v[236:237], v[104:105], v[12:13], v[236:237] op_sel:[0,1,0] op_sel_hi:[1,1,1]
    v_pk_fma_f32 v[238:239], v[106:107], v[12:13], v[238:239] op_sel:[0,1,0] op_sel_hi:[1,1,1]
    v_max_f32 v236, 0, v236
    v_max_f32 v237, 0, v237
    v_max_f32 v238, 0, v238
    v_max_f32 v239, 0, v239
    v_pk_mul_f32 v[236:237], v[236:237], v[236:237]
    v_pk_mul_f32 v[238:239], v[238:239], v[238:239]
    v_cvt_pk_bf16_f32 v40, v236, v237
    v_cvt_pk_bf16_f32 v41, v238, v239
    v_pk_fma_f32 v[232:233], v[144:145], v[12:13], v[172:173] op_sel:[0,0,0] op_sel_hi:[1,0,1] neg_lo:[0,1,0] neg_hi:[0,1,0]
    v_pk_fma_f32 v[234:235], v[146:147], v[12:13], v[174:175] op_sel:[0,0,0] op_sel_hi:[1,0,1] neg_lo:[0,1,0] neg_hi:[0,1,0]
    v_pk_fma_f32 v[232:233], v[112:113], v[12:13], v[232:233] op_sel:[0,1,0] op_sel_hi:[1,1,1]
    v_pk_fma_f32 v[234:235], v[114:115], v[12:13], v[234:235] op_sel:[0,1,0] op_sel_hi:[1,1,1]
    v_max_f32 v232, 0, v232
    v_max_f32 v233, 0, v233
    v_max_f32 v234, 0, v234
    v_max_f32 v235, 0, v235
    v_pk_mul_f32 v[232:233], v[232:233], v[232:233]
    v_pk_mul_f32 v[234:235], v[234:235], v[234:235]
    v_cvt_pk_bf16_f32 v42, v232, v233
    v_cvt_pk_bf16_f32 v43, v234, v235
    buffer_store_dwordx4 v[40:43], v4, s[8:11], s29 offen offset:0 sc1
    v_pk_fma_f32 v[240:241], v[140:141], v[14:15], v[168:169] op_sel:[0,0,0] op_sel_hi:[1,0,1] neg_lo:[0,1,0] neg_hi:[0,1,0]
    v_pk_fma_f32 v[242:243], v[142:143], v[14:15], v[170:171] op_sel:[0,0,0] op_sel_hi:[1,0,1] neg_lo:[0,1,0] neg_hi:[0,1,0]
    v_pk_fma_f32 v[240:241], v[108:109], v[14:15], v[240:241] op_sel:[0,1,0] op_sel_hi:[1,1,1]
    v_pk_fma_f32 v[242:243], v[110:111], v[14:15], v[242:243] op_sel:[0,1,0] op_sel_hi:[1,1,1]
    v_max_f32 v240, 0, v240
    v_max_f32 v241, 0, v241
    v_max_f32 v242, 0, v242
    v_max_f32 v243, 0, v243
    v_pk_mul_f32 v[240:241], v[240:241], v[240:241]
    v_pk_mul_f32 v[242:243], v[242:243], v[242:243]
    v_cvt_pk_bf16_f32 v44, v240, v241
    v_cvt_pk_bf16_f32 v45, v242, v243
    v_pk_fma_f32 v[244:245], v[144:145], v[14:15], v[172:173] op_sel:[0,0,0] op_sel_hi:[1,0,1] neg_lo:[0,1,0] neg_hi:[0,1,0]
    v_pk_fma_f32 v[246:247], v[146:147], v[14:15], v[174:175] op_sel:[0,0,0] op_sel_hi:[1,0,1] neg_lo:[0,1,0] neg_hi:[0,1,0]
    v_pk_fma_f32 v[244:245], v[116:117], v[14:15], v[244:245] op_sel:[0,1,0] op_sel_hi:[1,1,1]
    v_pk_fma_f32 v[246:247], v[118:119], v[14:15], v[246:247] op_sel:[0,1,0] op_sel_hi:[1,1,1]
    v_max_f32 v244, 0, v244
    v_max_f32 v245, 0, v245
    v_max_f32 v246, 0, v246
    v_max_f32 v247, 0, v247
    v_pk_mul_f32 v[244:245], v[244:245], v[244:245]
    v_pk_mul_f32 v[246:247], v[246:247], v[246:247]
    v_cvt_pk_bf16_f32 v46, v244, v245
    v_cvt_pk_bf16_f32 v47, v246, v247
    buffer_store_dwordx4 v[44:47], v4, s[8:11], s29 offen offset:1024 sc1
L_B_STD:
    s_mov_b64 exec, 1
    v_mov_b32 v6, 158760
    v_mov_b32 v7, 1
    ds_add_u32 v6, v7
    s_mov_b64 exec, -1
    v_mov_b32 v6, 158800
LW_84:
    ds_read_b32 v7, v6
    s_waitcnt lgkmcnt(0)
    v_readfirstlane_b32 s13, v7
    s_cmp_ge_u32 s13, 1
    s_cbranch_scc1 LWD_85
    s_sleep 1
    s_branch LW_84
LWD_85:
    s_branch L_PHASE_C
HBAD_42:
    s_mov_b32 s47, 0
HT_86:
    s_sleep 2
    s_mov_b32 s13, 0x100000
    buffer_load_dwordx4 v[16:19], v5, s[8:11], s13 offen sc1
    s_mov_b32 s13, 0x110000
    buffer_load_dwordx4 v[20:23], v5, s[8:11], s13 offen sc1
    s_waitcnt vmcnt(0)
    v_max3_u32 v6, v16, v18, v20
    v_max_u32 v6, v6, v22
    v_cmp_eq_u32 vcc, -1, v6
    s_cbranch_vccz HR_87
    s_add_u32 s47, s47, 1
    s_cmp_lt_u32 s47, 262144
    s_cbranch_scc1 HT_86
HR_87:
    s_mov_b32 s13, 0x120000
    buffer_load_dwordx4 v[24:27], v5, s[8:11], s13 offen sc1
    s_mov_b32 s13, 0x130000
    buffer_load_dwordx4 v[28:31], v5, s[8:11], s13 offen sc1
    s_mov_b32 s13, 0x140000
    buffer_load_dwordx4 v[32:35], v5, s[8:11], s13 offen sc1
    s_mov_b32 s13, 0x150000
    buffer_load_dwordx4 v[36:39], v5, s[8:11], s13 offen sc1
    s_mov_b32 s13, 0x160000
    buffer_load_dwordx4 v[40:43], v5, s[8:11], s13 offen sc1
    s_mov_b32 s13, 0x170000
    buffer_load_dwordx4 v[44:47], v5, s[8:11], s13 offen sc1
    s_waitcnt vmcnt(0)
    s_branch HOK_43
HBAD_44:
    s_mov_b32 s47, 0
HT_88:
    s_sleep 2
    s_mov_b32 s13, 0x120000
    buffer_load_dwordx4 v[24:27], v5, s[8:11], s13 offen sc1
    s_mov_b32 s13, 0x130000
    buffer_load_dwordx4 v[28:31], v5, s[8:11], s13 offen sc1
    s_waitcnt vmcnt(0)
    v_max3_u32 v6, v24, v26, v28
    v_max_u32 v6, v6, v30
    v_cmp_eq_u32 vcc, -1, v6
    s_cbranch_vccz HR_89
    s_add_u32 s47, s47, 1
    s_cmp_lt_u32 s47, 262144
    s_cbranch_scc1 HT_88
HR_89:
    s_mov_b32 s13, 0x140000
    buffer_load_dwordx4 v[32:35], v5, s[8:11], s13 offen sc1
    s_mov_b32 s13, 0x150000
    buffer_load_dwordx4 v[36:39], v5, s[8:11], s13 offen sc1
    s_mov_b32 s13, 0x160000
    buffer_load_dwordx4 v[40:43], v5, s[8:11], s13 offen sc1
    s_mov_b32 s13, 0x170000
    buffer_load_dwordx4 v[44:47], v5, s[8:11], s13 offen sc1
    s_mov_b32 s13, 0x180000
    buffer_load_dwordx4 v[48:51], v5, s[8:11], s13 offen sc1
    s_mov_b32 s13, 0x190000
    buffer_load_dwordx4 v[52:55], v5, s[8:11], s13 offen sc1
    s_mov_b32 s13, 0x1a0000
    buffer_load_dwordx4 v[56:59], v5, s[8:11], s13 offen sc1
    s_mov_b32 s13, 0x1b0000
    buffer_load_dwordx4 v[60:63], v5, s[8:11], s13 offen sc1
    s_waitcnt vmcnt(0)
    s_branch HOK_45
HBAD_46:
    s_mov_b32 s47, 0
HT_90:
    s_sleep 2
    s_mov_b32 s13, 0x140000
    buffer_load_dwordx4 v[32:35], v5, s[8:11], s13 offen sc1
    s_mov_b32 s13, 0x150000
    buffer_load_dwordx4 v[36:39], v5, s[8:11], s13 offen sc1
    s_waitcnt vmcnt(0)
    v_max3_u32 v6, v32, v34, v36
    v_max_u32 v6, v6, v38
    v_cmp_eq_u32 vcc, -1, v6
    s_cbranch_vccz HR_91
    s_add_u32 s47, s47, 1
    s_cmp_lt_u32 s47, 262144
    s_cbranch_scc1 HT_90
HR_91:
    s_mov_b32 s13, 0x160000
    buffer_load_dwordx4 v[40:43], v5, s[8:11], s13 offen sc1
    s_mov_b32 s13, 0x170000
    buffer_load_dwordx4 v[44:47], v5, s[8:11], s13 offen sc1
    s_mov_b32 s13, 0x180000
    buffer_load_dwordx4 v[48:51], v5, s[8:11], s13 offen sc1
    s_mov_b32 s13, 0x190000
    buffer_load_dwordx4 v[52:55], v5, s[8:11], s13 offen sc1
    s_mov_b32 s13, 0x1a0000
    buffer_load_dwordx4 v[56:59], v5, s[8:11], s13 offen sc1
    s_mov_b32 s13, 0x1b0000
    buffer_load_dwordx4 v[60:63], v5, s[8:11], s13 offen sc1
    s_mov_b32 s13, 0x1c0000
    buffer_load_dwordx4 v[176:179], v5, s[8:11], s13 offen sc1
    s_mov_b32 s13, 0x1d0000
    buffer_load_dwordx4 v[180:183], v5, s[8:11], s13 offen sc1
    s_mov_b32 s13, 0x1e0000
    buffer_load_dwordx4 v[184:187], v5, s[8:11], s13 offen sc1
    s_mov_b32 s13, 0x1f0000
    buffer_load_dwordx4 v[188:191], v5, s[8:11], s13 offen sc1
    s_waitcnt vmcnt(0)
    s_branch HOK_47
HBAD_48:
    s_mov_b32 s47, 0
HT_92:
    s_sleep 2
    s_mov_b32 s13, 0x160000
    buffer_load_dwordx4 v[40:43], v5, s[8:11], s13 offen sc1
    s_mov_b32 s13, 0x170000
    buffer_load_dwordx4 v[44:47], v5, s[8:11], s13 offen sc1
    s_waitcnt vmcnt(0)
    v_max3_u32 v6, v40, v42, v44
    v_max_u32 v6, v6, v46
    v_cmp_eq_u32 vcc, -1, v6
    s_cbranch_vccz HR_93
    s_add_u32 s47, s47, 1
    s_cmp_lt_u32 s47, 262144
    s_cbranch_scc1 HT_92
HR_93:
    s_mov_b32 s13, 0x180000
    buffer_load_dwordx4 v[48:51], v5, s[8:11], s13 offen sc1
    s_mov_b32 s13, 0x190000
    buffer_load_dwordx4 v[52:55], v5, s[8:11], s13 offen sc1
    s_mov_b32 s13, 0x1a0000
    buffer_load_dwordx4 v[56:59], v5, s[8:11], s13 offen sc1
    s_mov_b32 s13, 0x1b0000
    buffer_load_dwordx4 v[60:63], v5, s[8:11], s13 offen sc1
    s_mov_b32 s13, 0x1c0000
    buffer_load_dwordx4 v[176:179], v5, s[8:11], s13 offen sc1
    s_mov_b32 s13, 0x1d0000
    buffer_load_dwordx4 v[180:183], v5, s[8:11], s13 offen sc1
    s_mov_b32 s13, 0x1e0000
    buffer_load_dwordx4 v[184:187], v5, s[8:11], s13 offen sc1
    s_mov_b32 s13, 0x1f0000
    buffer_load_dwordx4 v[188:191], v5, s[8:11], s13 offen sc1
    s_mov_b32 s13, 0x200000
    buffer_load_dwordx4 v[192:195], v5, s[8:11], s13 offen sc1
    s_mov_b32 s13, 0x210000
    buffer_load_dwordx4 v[196:199], v5, s[8:11], s13 offen sc1
    s_mov_b32 s13, 0x220000
    buffer_load_dwordx4 v[200:203], v5, s[8:11], s13 offen sc1
    s_mov_b32 s13, 0x230000
    buffer_load_dwordx4 v[204:207], v5, s[8:11], s13 offen sc1
    s_waitcnt vmcnt(0)
    s_branch HOK_49
HBAD_50:
    s_mov_b32 s47, 0
HT_94:
    s_sleep 2
    s_mov_b32 s13, 0x180000
    buffer_load_dwordx4 v[48:51], v5, s[8:11], s13 offen sc1
    s_mov_b32 s13, 0x190000
    buffer_load_dwordx4 v[52:55], v5, s[8:11], s13 offen sc1
    s_waitcnt vmcnt(0)
    v_max3_u32 v6, v48, v50, v52
    v_max_u32 v6, v6, v54
    v_cmp_eq_u32 vcc, -1, v6
    s_cbranch_vccz HR_95
    s_add_u32 s47, s47, 1
    s_cmp_lt_u32 s47, 262144
    s_cbranch_scc1 HT_94
HR_95:
    s_mov_b32 s13, 0x1a0000
    buffer_load_dwordx4 v[56:59], v5, s[8:11], s13 offen sc1
    s_mov_b32 s13, 0x1b0000
    buffer_load_dwordx4 v[60:63], v5, s[8:11], s13 offen sc1
    s_mov_b32 s13, 0x1c0000
    buffer_load_dwordx4 v[176:179], v5, s[8:11], s13 offen sc1
    s_mov_b32 s13, 0x1d0000
    buffer_load_dwordx4 v[180:183], v5, s[8:11], s13 offen sc1
    s_mov_b32 s13, 0x1e0000
    buffer_load_dwordx4 v[184:187], v5, s[8:11], s13 offen sc1
    s_mov_b32 s13, 0x1f0000
    buffer_load_dwordx4 v[188:191], v5, s[8:11], s13 offen sc1
    s_mov_b32 s13, 0x200000
    buffer_load_dwordx4 v[192:195], v5, s[8:11], s13 offen sc1
    s_mov_b32 s13, 0x210000
    buffer_load_dwordx4 v[196:199], v5, s[8:11], s13 offen sc1
    s_mov_b32 s13, 0x220000
    buffer_load_dwordx4 v[200:203], v5, s[8:11], s13 offen sc1
    s_mov_b32 s13, 0x230000
    buffer_load_dwordx4 v[204:207], v5, s[8:11], s13 offen sc1
    s_mov_b32 s13, 0x240000
    buffer_load_dwordx4 v[208:211], v5, s[8:11], s13 offen sc1
    s_mov_b32 s13, 0x250000
    buffer_load_dwordx4 v[212:215], v5, s[8:11], s13 offen sc1
    s_mov_b32 s13, 0x260000
    buffer_load_dwordx4 v[216:219], v5, s[8:11], s13 offen sc1
    s_mov_b32 s13, 0x270000
    buffer_load_dwordx4 v[220:223], v5, s[8:11], s13 offen sc1
    s_waitcnt vmcnt(0)
    s_branch HOK_51
HBAD_52:
    s_mov_b32 s47, 0
HT_96:
    s_sleep 2
    s_mov_b32 s13, 0x1a0000
    buffer_load_dwordx4 v[56:59], v5, s[8:11], s13 offen sc1
    s_mov_b32 s13, 0x1b0000
    buffer_load_dwordx4 v[60:63], v5, s[8:11], s13 offen sc1
    s_waitcnt vmcnt(0)
    v_max3_u32 v6, v56, v58, v60
    v_max_u32 v6, v6, v62
    v_cmp_eq_u32 vcc, -1, v6
    s_cbranch_vccz HR_97
    s_add_u32 s47, s47, 1
    s_cmp_lt_u32 s47, 262144
    s_cbranch_scc1 HT_96
HR_97:
    s_mov_b32 s13, 0x1c0000
    buffer_load_dwordx4 v[176:179], v5, s[8:11], s13 offen sc1
    s_mov_b32 s13, 0x1d0000
    buffer_load_dwordx4 v[180:183], v5, s[8:11], s13 offen sc1
    s_mov_b32 s13, 0x1e0000
    buffer_load_dwordx4 v[184:187], v5, s[8:11], s13 offen sc1
    s_mov_b32 s13, 0x1f0000
    buffer_load_dwordx4 v[188:191], v5, s[8:11], s13 offen sc1
    s_mov_b32 s13, 0x200000
    buffer_load_dwordx4 v[192:195], v5, s[8:11], s13 offen sc1
    s_mov_b32 s13, 0x210000
    buffer_load_dwordx4 v[196:199], v5, s[8:11], s13 offen sc1
    s_mov_b32 s13, 0x220000
    buffer_load_dwordx4 v[200:203], v5, s[8:11], s13 offen sc1
    s_mov_b32 s13, 0x230000
    buffer_load_dwordx4 v[204:207], v5, s[8:11], s13 offen sc1
    s_mov_b32 s13, 0x240000
    buffer_load_dwordx4 v[208:211], v5, s[8:11], s13 offen sc1
    s_mov_b32 s13, 0x250000
    buffer_load_dwordx4 v[212:215], v5, s[8:11], s13 offen sc1
    s_mov_b32 s13, 0x260000
    buffer_load_dwordx4 v[216:219], v5, s[8:11], s13 offen sc1
    s_mov_b32 s13, 0x270000
    buffer_load_dwordx4 v[220:223], v5, s[8:11], s13 offen sc1
    s_mov_b32 s13, 0x280000
    buffer_load_dwordx4 v[224:227], v5, s[8:11], s13 offen sc1
    s_mov_b32 s13, 0x290000
    buffer_load_dwordx4 v[228:231], v5, s[8:11], s13 offen sc1
    s_mov_b32 s13, 0x2a0000
    buffer_load_dwordx4 v[16:19], v5, s[8:11], s13 offen sc1
    s_mov_b32 s13, 0x2b0000
    buffer_load_dwordx4 v[20:23], v5, s[8:11], s13 offen sc1
    s_waitcnt vmcnt(0)
    s_branch HOK_53
HBAD_54:
    s_mov_b32 s47, 0
HT_98:
    s_sleep 2
    s_mov_b32 s13, 0x1c0000
    buffer_load_dwordx4 v[176:179], v5, s[8:11], s13 offen sc1
    s_mov_b32 s13, 0x1d0000
    buffer_load_dwordx4 v[180:183], v5, s[8:11], s13 offen sc1
    s_waitcnt vmcnt(0)
    v_max3_u32 v6, v176, v178, v180
    v_max_u32 v6, v6, v182
    v_cmp_eq_u32 vcc, -1, v6
    s_cbranch_vccz HR_99
    s_add_u32 s47, s47, 1
    s_cmp_lt_u32 s47, 262144
    s_cbranch_scc1 HT_98
HR_99:
    s_mov_b32 s13, 0x1e0000
    buffer_load_dwordx4 v[184:187], v5, s[8:11], s13 offen sc1
    s_mov_b32 s13, 0x1f0000
    buffer_load_dwordx4 v[188:191], v5, s[8:11], s13 offen sc1
    s_mov_b32 s13, 0x200000
    buffer_load_dwordx4 v[192:195], v5, s[8:11], s13 offen sc1
    s_mov_b32 s13, 0x210000
    buffer_load_dwordx4 v[196:199], v5, s[8:11], s13 offen sc1
    s_mov_b32 s13, 0x220000
    buffer_load_dwordx4 v[200:203], v5, s[8:11], s13 offen sc1
    s_mov_b32 s13, 0x230000
    buffer_load_dwordx4 v[204:207], v5, s[8:11], s13 offen sc1
    s_mov_b32 s13, 0x240000
    buffer_load_dwordx4 v[208:211], v5, s[8:11], s13 offen sc1
    s_mov_b32 s13, 0x250000
    buffer_load_dwordx4 v[212:215], v5, s[8:11], s13 offen sc1
    s_mov_b32 s13, 0x260000
    buffer_load_dwordx4 v[216:219], v5, s[8:11], s13 offen sc1
    s_mov_b32 s13, 0x270000
    buffer_load_dwordx4 v[220:223], v5, s[8:11], s13 offen sc1
    s_mov_b32 s13, 0x280000
    buffer_load_dwordx4 v[224:227], v5, s[8:11], s13 offen sc1
    s_mov_b32 s13, 0x290000
    buffer_load_dwordx4 v[228:231], v5, s[8:11], s13 offen sc1
    s_mov_b32 s13, 0x2a0000
    buffer_load_dwordx4 v[16:19], v5, s[8:11], s13 offen sc1
    s_mov_b32 s13, 0x2b0000
    buffer_load_dwordx4 v[20:23], v5, s[8:11], s13 offen sc1
    s_mov_b32 s13, 0x2c0000
    buffer_load_dwordx4 v[24:27], v5, s[8:11], s13 offen sc1
    s_mov_b32 s13, 0x2d0000
    buffer_load_dwordx4 v[28:31], v5, s[8:11], s13 offen sc1
    s_mov_b32 s13, 0x2e0000
    buffer_load_dwordx4 v[32:35], v5, s[8:11], s13 offen sc1
    s_mov_b32 s13, 0x2f0000
    buffer_load_dwordx4 v[36:39], v5, s[8:11], s13 offen sc1
    s_waitcnt vmcnt(0)
    s_branch HOK_55
HBAD_56:
    s_mov_b32 s47, 0
HT_100:
    s_sleep 2
    s_mov_b32 s13, 0x1e0000
    buffer_load_dwordx4 v[184:187], v5, s[8:11], s13 offen sc1
    s_mov_b32 s13, 0x1f0000
    buffer_load_dwordx4 v[188:191], v5, s[8:11], s13 offen sc1
    s_waitcnt vmcnt(0)
    v_max3_u32 v6, v184, v186, v188
    v_max_u32 v6, v6, v190
    v_cmp_eq_u32 vcc, -1, v6
    s_cbranch_vccz HR_101
    s_add_u32 s47, s47, 1
    s_cmp_lt_u32 s47, 262144
    s_cbranch_scc1 HT_100
HR_101:
    s_mov_b32 s13, 0x200000
    buffer_load_dwordx4 v[192:195], v5, s[8:11], s13 offen sc1
    s_mov_b32 s13, 0x210000
    buffer_load_dwordx4 v[196:199], v5, s[8:11], s13 offen sc1
    s_mov_b32 s13, 0x220000
    buffer_load_dwordx4 v[200:203], v5, s[8:11], s13 offen sc1
    s_mov_b32 s13, 0x230000
    buffer_load_dwordx4 v[204:207], v5, s[8:11], s13 offen sc1
    s_mov_b32 s13, 0x240000
    buffer_load_dwordx4 v[208:211], v5, s[8:11], s13 offen sc1
    s_mov_b32 s13, 0x250000
    buffer_load_dwordx4 v[212:215], v5, s[8:11], s13 offen sc1
    s_mov_b32 s13, 0x260000
    buffer_load_dwordx4 v[216:219], v5, s[8:11], s13 offen sc1
    s_mov_b32 s13, 0x270000
    buffer_load_dwordx4 v[220:223], v5, s[8:11], s13 offen sc1
    s_mov_b32 s13, 0x280000
    buffer_load_dwordx4 v[224:227], v5, s[8:11], s13 offen sc1
    s_mov_b32 s13, 0x290000
    buffer_load_dwordx4 v[228:231], v5, s[8:11], s13 offen sc1
    s_mov_b32 s13, 0x2a0000
    buffer_load_dwordx4 v[16:19], v5, s[8:11], s13 offen sc1
    s_mov_b32 s13, 0x2b0000
    buffer_load_dwordx4 v[20:23], v5, s[8:11], s13 offen sc1
    s_mov_b32 s13, 0x2c0000
    buffer_load_dwordx4 v[24:27], v5, s[8:11], s13 offen sc1
    s_mov_b32 s13, 0x2d0000
    buffer_load_dwordx4 v[28:31], v5, s[8:11], s13 offen sc1
    s_mov_b32 s13, 0x2e0000
    buffer_load_dwordx4 v[32:35], v5, s[8:11], s13 offen sc1
    s_mov_b32 s13, 0x2f0000
    buffer_load_dwordx4 v[36:39], v5, s[8:11], s13 offen sc1
    s_mov_b32 s13, 0x300000
    buffer_load_dwordx4 v[40:43], v5, s[8:11], s13 offen sc1
    s_mov_b32 s13, 0x310000
    buffer_load_dwordx4 v[44:47], v5, s[8:11], s13 offen sc1
    s_mov_b32 s13, 0x320000
    buffer_load_dwordx4 v[48:51], v5, s[8:11], s13 offen sc1
    s_mov_b32 s13, 0x330000
    buffer_load_dwordx4 v[52:55], v5, s[8:11], s13 offen sc1
    s_waitcnt vmcnt(0)
    s_branch HOK_57
HBAD_58:
    s_mov_b32 s47, 0
HT_102:
    s_sleep 2
    s_mov_b32 s13, 0x200000
    buffer_load_dwordx4 v[192:195], v5, s[8:11], s13 offen sc1
    s_mov_b32 s13, 0x210000
    buffer_load_dwordx4 v[196:199], v5, s[8:11], s13 offen sc1
    s_waitcnt vmcnt(0)
    v_max3_u32 v6, v192, v194, v196
    v_max_u32 v6, v6, v198
    v_cmp_eq_u32 vcc, -1, v6
    s_cbranch_vccz HR_103
    s_add_u32 s47, s47, 1
    s_cmp_lt_u32 s47, 262144
    s_cbranch_scc1 HT_102
HR_103:
    s_mov_b32 s13, 0x220000
    buffer_load_dwordx4 v[200:203], v5, s[8:11], s13 offen sc1
    s_mov_b32 s13, 0x230000
    buffer_load_dwordx4 v[204:207], v5, s[8:11], s13 offen sc1
    s_mov_b32 s13, 0x240000
    buffer_load_dwordx4 v[208:211], v5, s[8:11], s13 offen sc1
    s_mov_b32 s13, 0x250000
    buffer_load_dwordx4 v[212:215], v5, s[8:11], s13 offen sc1
    s_mov_b32 s13, 0x260000
    buffer_load_dwordx4 v[216:219], v5, s[8:11], s13 offen sc1
    s_mov_b32 s13, 0x270000
    buffer_load_dwordx4 v[220:223], v5, s[8:11], s13 offen sc1
    s_mov_b32 s13, 0x280000
    buffer_load_dwordx4 v[224:227], v5, s[8:11], s13 offen sc1
    s_mov_b32 s13, 0x290000
    buffer_load_dwordx4 v[228:231], v5, s[8:11], s13 offen sc1
    s_mov_b32 s13, 0x2a0000
    buffer_load_dwordx4 v[16:19], v5, s[8:11], s13 offen sc1
    s_mov_b32 s13, 0x2b0000
    buffer_load_dwordx4 v[20:23], v5, s[8:11], s13 offen sc1
    s_mov_b32 s13, 0x2c0000
    buffer_load_dwordx4 v[24:27], v5, s[8:11], s13 offen sc1
    s_mov_b32 s13, 0x2d0000
    buffer_load_dwordx4 v[28:31], v5, s[8:11], s13 offen sc1
    s_mov_b32 s13, 0x2e0000
    buffer_load_dwordx4 v[32:35], v5, s[8:11], s13 offen sc1
    s_mov_b32 s13, 0x2f0000
    buffer_load_dwordx4 v[36:39], v5, s[8:11], s13 offen sc1
    s_mov_b32 s13, 0x300000
    buffer_load_dwordx4 v[40:43], v5, s[8:11], s13 offen sc1
    s_mov_b32 s13, 0x310000
    buffer_load_dwordx4 v[44:47], v5, s[8:11], s13 offen sc1
    s_mov_b32 s13, 0x320000
    buffer_load_dwordx4 v[48:51], v5, s[8:11], s13 offen sc1
    s_mov_b32 s13, 0x330000
    buffer_load_dwordx4 v[52:55], v5, s[8:11], s13 offen sc1
    s_mov_b32 s13, 0x340000
    buffer_load_dwordx4 v[56:59], v5, s[8:11], s13 offen sc1
    s_mov_b32 s13, 0x350000
    buffer_load_dwordx4 v[60:63], v5, s[8:11], s13 offen sc1
    s_mov_b32 s13, 0x360000
    buffer_load_dwordx4 v[176:179], v5, s[8:11], s13 offen sc1
    s_mov_b32 s13, 0x370000
    buffer_load_dwordx4 v[180:183], v5, s[8:11], s13 offen sc1
    s_waitcnt vmcnt(0)
    s_branch HOK_59
HBAD_60:
    s_mov_b32 s47, 0
HT_104:
    s_sleep 2
    s_mov_b32 s13, 0x220000
    buffer_load_dwordx4 v[200:203], v5, s[8:11], s13 offen sc1
    s_mov_b32 s13, 0x230000
    buffer_load_dwordx4 v[204:207], v5, s[8:11], s13 offen sc1
    s_waitcnt vmcnt(0)
    v_max3_u32 v6, v200, v202, v204
    v_max_u32 v6, v6, v206
    v_cmp_eq_u32 vcc, -1, v6
    s_cbranch_vccz HR_105
    s_add_u32 s47, s47, 1
    s_cmp_lt_u32 s47, 262144
    s_cbranch_scc1 HT_104
HR_105:
    s_mov_b32 s13, 0x240000
    buffer_load_dwordx4 v[208:211], v5, s[8:11], s13 offen sc1
    s_mov_b32 s13, 0x250000
    buffer_load_dwordx4 v[212:215], v5, s[8:11], s13 offen sc1
    s_mov_b32 s13, 0x260000
    buffer_load_dwordx4 v[216:219], v5, s[8:11], s13 offen sc1
    s_mov_b32 s13, 0x270000
    buffer_load_dwordx4 v[220:223], v5, s[8:11], s13 offen sc1
    s_mov_b32 s13, 0x280000
    buffer_load_dwordx4 v[224:227], v5, s[8:11], s13 offen sc1
    s_mov_b32 s13, 0x290000
    buffer_load_dwordx4 v[228:231], v5, s[8:11], s13 offen sc1
    s_mov_b32 s13, 0x2a0000
    buffer_load_dwordx4 v[16:19], v5, s[8:11], s13 offen sc1
    s_mov_b32 s13, 0x2b0000
    buffer_load_dwordx4 v[20:23], v5, s[8:11], s13 offen sc1
    s_mov_b32 s13, 0x2c0000
    buffer_load_dwordx4 v[24:27], v5, s[8:11], s13 offen sc1
    s_mov_b32 s13, 0x2d0000
    buffer_load_dwordx4 v[28:31], v5, s[8:11], s13 offen sc1
    s_mov_b32 s13, 0x2e0000
    buffer_load_dwordx4 v[32:35], v5, s[8:11], s13 offen sc1
    s_mov_b32 s13, 0x2f0000
    buffer_load_dwordx4 v[36:39], v5, s[8:11], s13 offen sc1
    s_mov_b32 s13, 0x300000
    buffer_load_dwordx4 v[40:43], v5, s[8:11], s13 offen sc1
    s_mov_b32 s13, 0x310000
    buffer_load_dwordx4 v[44:47], v5, s[8:11], s13 offen sc1
    s_mov_b32 s13, 0x320000
    buffer_load_dwordx4 v[48:51], v5, s[8:11], s13 offen sc1
    s_mov_b32 s13, 0x330000
    buffer_load_dwordx4 v[52:55], v5, s[8:11], s13 offen sc1
    s_mov_b32 s13, 0x340000
    buffer_load_dwordx4 v[56:59], v5, s[8:11], s13 offen sc1
    s_mov_b32 s13, 0x350000
    buffer_load_dwordx4 v[60:63], v5, s[8:11], s13 offen sc1
    s_mov_b32 s13, 0x360000
    buffer_load_dwordx4 v[176:179], v5, s[8:11], s13 offen sc1
    s_mov_b32 s13, 0x370000
    buffer_load_dwordx4 v[180:183], v5, s[8:11], s13 offen sc1
    s_waitcnt vmcnt(0)
    s_branch HOK_61
HBAD_62:
    s_mov_b32 s47, 0
HT_106:
    s_sleep 2
    s_mov_b32 s13, 0x240000
    buffer_load_dwordx4 v[208:211], v5, s[8:11], s13 offen sc1
    s_mov_b32 s13, 0x250000
    buffer_load_dwordx4 v[212:215], v5, s[8:11], s13 offen sc1
    s_waitcnt vmcnt(0)
    v_max3_u32 v6, v208, v210, v212
    v_max_u32 v6, v6, v214
    v_cmp_eq_u32 vcc, -1, v6
    s_cbranch_vccz HR_107
    s_add_u32 s47, s47, 1
    s_cmp_lt_u32 s47, 262144
    s_cbranch_scc1 HT_106
HR_107:
    s_mov_b32 s13, 0x260000
    buffer_load_dwordx4 v[216:219], v5, s[8:11], s13 offen sc1
    s_mov_b32 s13, 0x270000
    buffer_load_dwordx4 v[220:223], v5, s[8:11], s13 offen sc1
    s_mov_b32 s13, 0x280000
    buffer_load_dwordx4 v[224:227], v5, s[8:11], s13 offen sc1
    s_mov_b32 s13, 0x290000
    buffer_load_dwordx4 v[228:231], v5, s[8:11], s13 offen sc1
    s_mov_b32 s13, 0x2a0000
    buffer_load_dwordx4 v[16:19], v5, s[8:11], s13 offen sc1
    s_mov_b32 s13, 0x2b0000
    buffer_load_dwordx4 v[20:23], v5, s[8:11], s13 offen sc1
    s_mov_b32 s13, 0x2c0000
    buffer_load_dwordx4 v[24:27], v5, s[8:11], s13 offen sc1
    s_mov_b32 s13, 0x2d0000
    buffer_load_dwordx4 v[28:31], v5, s[8:11], s13 offen sc1
    s_mov_b32 s13, 0x2e0000
    buffer_load_dwordx4 v[32:35], v5, s[8:11], s13 offen sc1
    s_mov_b32 s13, 0x2f0000
    buffer_load_dwordx4 v[36:39], v5, s[8:11], s13 offen sc1
    s_mov_b32 s13, 0x300000
    buffer_load_dwordx4 v[40:43], v5, s[8:11], s13 offen sc1
    s_mov_b32 s13, 0x310000
    buffer_load_dwordx4 v[44:47], v5, s[8:11], s13 offen sc1
    s_mov_b32 s13, 0x320000
    buffer_load_dwordx4 v[48:51], v5, s[8:11], s13 offen sc1
    s_mov_b32 s13, 0x330000
    buffer_load_dwordx4 v[52:55], v5, s[8:11], s13 offen sc1
    s_mov_b32 s13, 0x340000
    buffer_load_dwordx4 v[56:59], v5, s[8:11], s13 offen sc1
    s_mov_b32 s13, 0x350000
    buffer_load_dwordx4 v[60:63], v5, s[8:11], s13 offen sc1
    s_mov_b32 s13, 0x360000
    buffer_load_dwordx4 v[176:179], v5, s[8:11], s13 offen sc1
    s_mov_b32 s13, 0x370000
    buffer_load_dwordx4 v[180:183], v5, s[8:11], s13 offen sc1
    s_waitcnt vmcnt(0)
    s_branch HOK_63
HBAD_64:
    s_mov_b32 s47, 0
HT_108:
    s_sleep 2
    s_mov_b32 s13, 0x260000
    buffer_load_dwordx4 v[216:219], v5, s[8:11], s13 offen sc1
    s_mov_b32 s13, 0x270000
    buffer_load_dwordx4 v[220:223], v5, s[8:11], s13 offen sc1
    s_waitcnt vmcnt(0)
    v_max3_u32 v6, v216, v218, v220
    v_max_u32 v6, v6, v222
    v_cmp_eq_u32 vcc, -1, v6
    s_cbranch_vccz HR_109
    s_add_u32 s47, s47, 1
    s_cmp_lt_u32 s47, 262144
    s_cbranch_scc1 HT_108
HR_109:
    s_mov_b32 s13, 0x280000
    buffer_load_dwordx4 v[224:227], v5, s[8:11], s13 offen sc1
    s_mov_b32 s13, 0x290000
    buffer_load_dwordx4 v[228:231], v5, s[8:11], s13 offen sc1
    s_mov_b32 s13, 0x2a0000
    buffer_load_dwordx4 v[16:19], v5, s[8:11], s13 offen sc1
    s_mov_b32 s13, 0x2b0000
    buffer_load_dwordx4 v[20:23], v5, s[8:11], s13 offen sc1
    s_mov_b32 s13, 0x2c0000
    buffer_load_dwordx4 v[24:27], v5, s[8:11], s13 offen sc1
    s_mov_b32 s13, 0x2d0000
    buffer_load_dwordx4 v[28:31], v5, s[8:11], s13 offen sc1
    s_mov_b32 s13, 0x2e0000
    buffer_load_dwordx4 v[32:35], v5, s[8:11], s13 offen sc1
    s_mov_b32 s13, 0x2f0000
    buffer_load_dwordx4 v[36:39], v5, s[8:11], s13 offen sc1
    s_mov_b32 s13, 0x300000
    buffer_load_dwordx4 v[40:43], v5, s[8:11], s13 offen sc1
    s_mov_b32 s13, 0x310000
    buffer_load_dwordx4 v[44:47], v5, s[8:11], s13 offen sc1
    s_mov_b32 s13, 0x320000
    buffer_load_dwordx4 v[48:51], v5, s[8:11], s13 offen sc1
    s_mov_b32 s13, 0x330000
    buffer_load_dwordx4 v[52:55], v5, s[8:11], s13 offen sc1
    s_mov_b32 s13, 0x340000
    buffer_load_dwordx4 v[56:59], v5, s[8:11], s13 offen sc1
    s_mov_b32 s13, 0x350000
    buffer_load_dwordx4 v[60:63], v5, s[8:11], s13 offen sc1
    s_mov_b32 s13, 0x360000
    buffer_load_dwordx4 v[176:179], v5, s[8:11], s13 offen sc1
    s_mov_b32 s13, 0x370000
    buffer_load_dwordx4 v[180:183], v5, s[8:11], s13 offen sc1
    s_waitcnt vmcnt(0)
    s_branch HOK_65
HBAD_66:
    s_mov_b32 s47, 0
HT_110:
    s_sleep 2
    s_mov_b32 s13, 0x280000
    buffer_load_dwordx4 v[224:227], v5, s[8:11], s13 offen sc1
    s_mov_b32 s13, 0x290000
    buffer_load_dwordx4 v[228:231], v5, s[8:11], s13 offen sc1
    s_waitcnt vmcnt(0)
    v_max3_u32 v6, v224, v226, v228
    v_max_u32 v6, v6, v230
    v_cmp_eq_u32 vcc, -1, v6
    s_cbranch_vccz HR_111
    s_add_u32 s47, s47, 1
    s_cmp_lt_u32 s47, 262144
    s_cbranch_scc1 HT_110
HR_111:
    s_mov_b32 s13, 0x2a0000
    buffer_load_dwordx4 v[16:19], v5, s[8:11], s13 offen sc1
    s_mov_b32 s13, 0x2b0000
    buffer_load_dwordx4 v[20:23], v5, s[8:11], s13 offen sc1
    s_mov_b32 s13, 0x2c0000
    buffer_load_dwordx4 v[24:27], v5, s[8:11], s13 offen sc1
    s_mov_b32 s13, 0x2d0000
    buffer_load_dwordx4 v[28:31], v5, s[8:11], s13 offen sc1
    s_mov_b32 s13, 0x2e0000
    buffer_load_dwordx4 v[32:35], v5, s[8:11], s13 offen sc1
    s_mov_b32 s13, 0x2f0000
    buffer_load_dwordx4 v[36:39], v5, s[8:11], s13 offen sc1
    s_mov_b32 s13, 0x300000
    buffer_load_dwordx4 v[40:43], v5, s[8:11], s13 offen sc1
    s_mov_b32 s13, 0x310000
    buffer_load_dwordx4 v[44:47], v5, s[8:11], s13 offen sc1
    s_mov_b32 s13, 0x320000
    buffer_load_dwordx4 v[48:51], v5, s[8:11], s13 offen sc1
    s_mov_b32 s13, 0x330000
    buffer_load_dwordx4 v[52:55], v5, s[8:11], s13 offen sc1
    s_mov_b32 s13, 0x340000
    buffer_load_dwordx4 v[56:59], v5, s[8:11], s13 offen sc1
    s_mov_b32 s13, 0x350000
    buffer_load_dwordx4 v[60:63], v5, s[8:11], s13 offen sc1
    s_mov_b32 s13, 0x360000
    buffer_load_dwordx4 v[176:179], v5, s[8:11], s13 offen sc1
    s_mov_b32 s13, 0x370000
    buffer_load_dwordx4 v[180:183], v5, s[8:11], s13 offen sc1
    s_waitcnt vmcnt(0)
    s_branch HOK_67
HBAD_68:
    s_mov_b32 s47, 0
HT_112:
    s_sleep 2
    s_mov_b32 s13, 0x2a0000
    buffer_load_dwordx4 v[16:19], v5, s[8:11], s13 offen sc1
    s_mov_b32 s13, 0x2b0000
    buffer_load_dwordx4 v[20:23], v5, s[8:11], s13 offen sc1
    s_waitcnt vmcnt(0)
    v_max3_u32 v6, v16, v18, v20
    v_max_u32 v6, v6, v22
    v_cmp_eq_u32 vcc, -1, v6
    s_cbranch_vccz HR_113
    s_add_u32 s47, s47, 1
    s_cmp_lt_u32 s47, 262144
    s_cbranch_scc1 HT_112
HR_113:
    s_mov_b32 s13, 0x2c0000
    buffer_load_dwordx4 v[24:27], v5, s[8:11], s13 offen sc1
    s_mov_b32 s13, 0x2d0000
    buffer_load_dwordx4 v[28:31], v5, s[8:11], s13 offen sc1
    s_mov_b32 s13, 0x2e0000
    buffer_load_dwordx4 v[32:35], v5, s[8:11], s13 offen sc1
    s_mov_b32 s13, 0x2f0000
    buffer_load_dwordx4 v[36:39], v5, s[8:11], s13 offen sc1
    s_mov_b32 s13, 0x300000
    buffer_load_dwordx4 v[40:43], v5, s[8:11], s13 offen sc1
    s_mov_b32 s13, 0x310000
    buffer_load_dwordx4 v[44:47], v5, s[8:11], s13 offen sc1
    s_mov_b32 s13, 0x320000
    buffer_load_dwordx4 v[48:51], v5, s[8:11], s13 offen sc1
    s_mov_b32 s13, 0x330000
    buffer_load_dwordx4 v[52:55], v5, s[8:11], s13 offen sc1
    s_mov_b32 s13, 0x340000
    buffer_load_dwordx4 v[56:59], v5, s[8:11], s13 offen sc1
    s_mov_b32 s13, 0x350000
    buffer_load_dwordx4 v[60:63], v5, s[8:11], s13 offen sc1
    s_mov_b32 s13, 0x360000
    buffer_load_dwordx4 v[176:179], v5, s[8:11], s13 offen sc1
    s_mov_b32 s13, 0x370000
    buffer_load_dwordx4 v[180:183], v5, s[8:11], s13 offen sc1
    s_waitcnt vmcnt(0)
    s_branch HOK_69
HBAD_70:
    s_mov_b32 s47, 0
HT_114:
    s_sleep 2
    s_mov_b32 s13, 0x2c0000
    buffer_load_dwordx4 v[24:27], v5, s[8:11], s13 offen sc1
    s_mov_b32 s13, 0x2d0000
    buffer_load_dwordx4 v[28:31], v5, s[8:11], s13 offen sc1
    s_waitcnt vmcnt(0)
    v_max3_u32 v6, v24, v26, v28
    v_max_u32 v6, v6, v30
    v_cmp_eq_u32 vcc, -1, v6
    s_cbranch_vccz HR_115
    s_add_u32 s47, s47, 1
    s_cmp_lt_u32 s47, 262144
    s_cbranch_scc1 HT_114
HR_115:
    s_mov_b32 s13, 0x2e0000
    buffer_load_dwordx4 v[32:35], v5, s[8:11], s13 offen sc1
    s_mov_b32 s13, 0x2f0000
    buffer_load_dwordx4 v[36:39], v5, s[8:11], s13 offen sc1
    s_mov_b32 s13, 0x300000
    buffer_load_dwordx4 v[40:43], v5, s[8:11], s13 offen sc1
    s_mov_b32 s13, 0x310000
    buffer_load_dwordx4 v[44:47], v5, s[8:11], s13 offen sc1
    s_mov_b32 s13, 0x320000
    buffer_load_dwordx4 v[48:51], v5, s[8:11], s13 offen sc1
    s_mov_b32 s13, 0x330000
    buffer_load_dwordx4 v[52:55], v5, s[8:11], s13 offen sc1
    s_mov_b32 s13, 0x340000
    buffer_load_dwordx4 v[56:59], v5, s[8:11], s13 offen sc1
    s_mov_b32 s13, 0x350000
    buffer_load_dwordx4 v[60:63], v5, s[8:11], s13 offen sc1
    s_mov_b32 s13, 0x360000
    buffer_load_dwordx4 v[176:179], v5, s[8:11], s13 offen sc1
    s_mov_b32 s13, 0x370000
    buffer_load_dwordx4 v[180:183], v5, s[8:11], s13 offen sc1
    s_waitcnt vmcnt(0)
    s_branch HOK_71
HBAD_72:
    s_mov_b32 s47, 0
HT_116:
    s_sleep 2
    s_mov_b32 s13, 0x2e0000
    buffer_load_dwordx4 v[32:35], v5, s[8:11], s13 offen sc1
    s_mov_b32 s13, 0x2f0000
    buffer_load_dwordx4 v[36:39], v5, s[8:11], s13 offen sc1
    s_waitcnt vmcnt(0)
    v_max3_u32 v6, v32, v34, v36
    v_max_u32 v6, v6, v38
    v_cmp_eq_u32 vcc, -1, v6
    s_cbranch_vccz HR_117
    s_add_u32 s47, s47, 1
    s_cmp_lt_u32 s47, 262144
    s_cbranch_scc1 HT_116
HR_117:
    s_mov_b32 s13, 0x300000
    buffer_load_dwordx4 v[40:43], v5, s[8:11], s13 offen sc1
    s_mov_b32 s13, 0x310000
    buffer_load_dwordx4 v[44:47], v5, s[8:11], s13 offen sc1
    s_mov_b32 s13, 0x320000
    buffer_load_dwordx4 v[48:51], v5, s[8:11], s13 offen sc1
    s_mov_b32 s13, 0x330000
    buffer_load_dwordx4 v[52:55], v5, s[8:11], s13 offen sc1
    s_mov_b32 s13, 0x340000
    buffer_load_dwordx4 v[56:59], v5, s[8:11], s13 offen sc1
    s_mov_b32 s13, 0x350000
    buffer_load_dwordx4 v[60:63], v5, s[8:11], s13 offen sc1
    s_mov_b32 s13, 0x360000
    buffer_load_dwordx4 v[176:179], v5, s[8:11], s13 offen sc1
    s_mov_b32 s13, 0x370000
    buffer_load_dwordx4 v[180:183], v5, s[8:11], s13 offen sc1
    s_waitcnt vmcnt(0)
    s_branch HOK_73
HBAD_74:
    s_mov_b32 s47, 0
HT_118:
    s_sleep 2
    s_mov_b32 s13, 0x300000
    buffer_load_dwordx4 v[40:43], v5, s[8:11], s13 offen sc1
    s_mov_b32 s13, 0x310000
    buffer_load_dwordx4 v[44:47], v5, s[8:11], s13 offen sc1
    s_waitcnt vmcnt(0)
    v_max3_u32 v6, v40, v42, v44
    v_max_u32 v6, v6, v46
    v_cmp_eq_u32 vcc, -1, v6
    s_cbranch_vccz HR_119
    s_add_u32 s47, s47, 1
    s_cmp_lt_u32 s47, 262144
    s_cbranch_scc1 HT_118
HR_119:
    s_mov_b32 s13, 0x320000
    buffer_load_dwordx4 v[48:51], v5, s[8:11], s13 offen sc1
    s_mov_b32 s13, 0x330000
    buffer_load_dwordx4 v[52:55], v5, s[8:11], s13 offen sc1
    s_mov_b32 s13, 0x340000
    buffer_load_dwordx4 v[56:59], v5, s[8:11], s13 offen sc1
    s_mov_b32 s13, 0x350000
    buffer_load_dwordx4 v[60:63], v5, s[8:11], s13 offen sc1
    s_mov_b32 s13, 0x360000
    buffer_load_dwordx4 v[176:179], v5, s[8:11], s13 offen sc1
    s_mov_b32 s13, 0x370000
    buffer_load_dwordx4 v[180:183], v5, s[8:11], s13 offen sc1
    s_waitcnt vmcnt(0)
    s_branch HOK_75
HBAD_76:
    s_mov_b32 s47, 0
HT_120:
    s_sleep 2
    s_mov_b32 s13, 0x320000
    buffer_load_dwordx4 v[48:51], v5, s[8:11], s13 offen sc1
    s_mov_b32 s13, 0x330000
    buffer_load_dwordx4 v[52:55], v5, s[8:11], s13 offen sc1
    s_waitcnt vmcnt(0)
    v_max3_u32 v6, v48, v50, v52
    v_max_u32 v6, v6, v54
    v_cmp_eq_u32 vcc, -1, v6
    s_cbranch_vccz HR_121
    s_add_u32 s47, s47, 1
    s_cmp_lt_u32 s47, 262144
    s_cbranch_scc1 HT_120
HR_121:
    s_mov_b32 s13, 0x340000
    buffer_load_dwordx4 v[56:59], v5, s[8:11], s13 offen sc1
    s_mov_b32 s13, 0x350000
    buffer_load_dwordx4 v[60:63], v5, s[8:11], s13 offen sc1
    s_mov_b32 s13, 0x360000
    buffer_load_dwordx4 v[176:179], v5, s[8:11], s13 offen sc1
    s_mov_b32 s13, 0x370000
    buffer_load_dwordx4 v[180:183], v5, s[8:11], s13 offen sc1
    s_waitcnt vmcnt(0)
    s_branch HOK_77
HBAD_78:
    s_mov_b32 s47, 0
HT_122:
    s_sleep 2
    s_mov_b32 s13, 0x340000
    buffer_load_dwordx4 v[56:59], v5, s[8:11], s13 offen sc1
    s_mov_b32 s13, 0x350000
    buffer_load_dwordx4 v[60:63], v5, s[8:11], s13 offen sc1
    s_waitcnt vmcnt(0)
    v_max3_u32 v6, v56, v58, v60
    v_max_u32 v6, v6, v62
    v_cmp_eq_u32 vcc, -1, v6
    s_cbranch_vccz HR_123
    s_add_u32 s47, s47, 1
    s_cmp_lt_u32 s47, 262144
    s_cbranch_scc1 HT_122
HR_123:
    s_mov_b32 s13, 0x360000
    buffer_load_dwordx4 v[176:179], v5, s[8:11], s13 offen sc1
    s_mov_b32 s13, 0x370000
    buffer_load_dwordx4 v[180:183], v5, s[8:11], s13 offen sc1
    s_waitcnt vmcnt(0)
    s_branch HOK_79
HBAD_80:
    s_mov_b32 s47, 0
HT_124:
    s_sleep 2
    s_mov_b32 s13, 0x360000
    buffer_load_dwordx4 v[176:179], v5, s[8:11], s13 offen sc1
    s_mov_b32 s13, 0x370000
    buffer_load_dwordx4 v[180:183], v5, s[8:11], s13 offen sc1
    s_waitcnt vmcnt(0)
    v_max3_u32 v6, v176, v178, v180
    v_max_u32 v6, v6, v182
    v_cmp_eq_u32 vcc, -1, v6
    s_cbranch_vccz HR_125
    s_add_u32 s47, s47, 1
    s_cmp_lt_u32 s47, 262144
    s_cbranch_scc1 HT_124
HR_125:
    s_waitcnt vmcnt(0)
    s_branch HOK_81
L_B_LOAD:
    v_mov_b32 v4, 158748
LW_126:
    ds_read_b32 v5, v4
    s_waitcnt lgkmcnt(0)
    v_readfirstlane_b32 s13, v5
    s_cmp_ge_u32 s13, 1
    s_cbranch_scc1 LWD_127
    s_sleep 4
    s_branch LW_126
LWD_127:
    s_setprio 2
    s_lshl_b32 s12, s66, 7
    s_lshl_b32 s13, s67, 3
    s_add_u32 s12, s12, s13
    s_sub_u32 s14, s3, 4
    s_mul_i32 s14, s14, 40
    v_lshrrev_b32 v5, 2, v1
    v_add_u32 v5, s14, v5
    v_and_b32 v6, 3, v1
    v_lshlrev_b32 v7, 14, v5
    v_lshl_add_u32 v7, v6, 4, v7
    s_lshl_b32 s13, s12, 3
    s_add_u32 s13, s13, 0x100000
    s_mov_b32 s15, s13
    s_mov_b32 s47, 0
    v_mov_b32 v24, 0
    v_mov_b32 v25, 0
    v_mov_b32 v26, 0
    v_mov_b32 v27, 0
L_LS_TOP:
    s_mov_b32 s13, s15
    buffer_load_dwordx4 v[16:19], v7, s[8:11], s13 offen sc1
    s_add_u32 s13, s13, 262144
    buffer_load_dwordx4 v[20:23], v7, s[8:11], s13 offen sc1
    s_add_u32 s13, s13, 262144
    s_mov_b64 exec, 0xffffffff
    buffer_load_dwordx4 v[24:27], v7, s[8:11], s13 offen sc1
    s_add_u32 s13, s13, 262144
    s_mov_b64 exec, -1
    s_waitcnt vmcnt(0)
    v_max3_u32 v8, v16, v18, v20
    v_max3_u32 v9, v22, v24, v26
    v_max_u32 v8, v8, v9
    v_cmp_eq_u32 vcc, -1, v8
    s_cbranch_vccz L_LS_OK
    s_sleep 8
    s_add_u32 s47, s47, 1
    s_cmp_lt_u32 s47, 262144
    s_cbranch_scc1 L_LS_TOP
L_LS_OK:
    v_mov_b32 v7, 0x3f803f80
    v_mov_b32 v8, 0
    v_mov_b32 v9, 0
    v_mov_b32 v10, 0
    v_mov_b32 v11, 0
    v_mov_b32 v12, 0
    v_mov_b32 v13, 0
    v_mov_b32 v14, 0
    v_mov_b32 v15, 0
    v_dot2_f32_bf16 v8, v16, v7, v8
    v_dot2_f32_bf16 v9, v16, v16, v9
    v_dot2_f32_bf16 v12, v17, v7, v12
    v_dot2_f32_bf16 v13, v17, v17, v13
    v_dot2_f32_bf16 v10, v18, v7, v10
    v_dot2_f32_bf16 v11, v18, v18, v11
    v_dot2_f32_bf16 v14, v19, v7, v14
    v_dot2_f32_bf16 v15, v19, v19, v15
    v_dot2_f32_bf16 v8, v20, v7, v8
    v_dot2_f32_bf16 v9, v20, v20, v9
    v_dot2_f32_bf16 v12, v21, v7, v12
    v_dot2_f32_bf16 v13, v21, v21, v13
    v_dot2_f32_bf16 v10, v22, v7, v10
    v_dot2_f32_bf16 v11, v22, v22, v11
    v_dot2_f32_bf16 v14, v23, v7, v14
    v_dot2_f32_bf16 v15, v23, v23, v15
    v_dot2_f32_bf16 v8, v24, v7, v8
    v_dot2_f32_bf16 v9, v24, v24, v9
    v_dot2_f32_bf16 v12, v25, v7, v12
    v_dot2_f32_bf16 v13, v25, v25, v13
    v_dot2_f32_bf16 v10, v26, v7, v10
    v_dot2_f32_bf16 v11, v26, v26, v11
    v_dot2_f32_bf16 v14, v27, v7, v14
    v_dot2_f32_bf16 v15, v27, v27, v15
    s_nop 2
    v_add_f32 v8, v8, v12
    v_add_f32 v9, v9, v13
    v_add_f32 v10, v10, v14
    v_add_f32 v11, v11, v15
    s_nop 1
    v_add_f32_dpp v8, v8, v8 row_ror:8 row_mask:0xf bank_mask:0xf
    v_add_f32_dpp v9, v9, v9 row_ror:8 row_mask:0xf bank_mask:0xf
    v_add_f32_dpp v10, v10, v10 row_ror:8 row_mask:0xf bank_mask:0xf
    v_add_f32_dpp v11, v11, v11 row_ror:8 row_mask:0xf bank_mask:0xf
    s_nop 1
    v_add_f32_dpp v8, v8, v8 row_ror:4 row_mask:0xf bank_mask:0xf
    v_add_f32_dpp v9, v9, v9 row_ror:4 row_mask:0xf bank_mask:0xf
    v_add_f32_dpp v10, v10, v10 row_ror:4 row_mask:0xf bank_mask:0xf
    v_add_f32_dpp v11, v11, v11 row_ror:4 row_mask:0xf bank_mask:0xf
    v_mov_b32 v12, v8
    v_mov_b32 v13, v9
    v_mov_b32 v14, v10
    v_mov_b32 v15, v11
    s_nop 0
    v_permlane16_swap_b32 v12, v8
    v_permlane16_swap_b32 v13, v9
    v_permlane16_swap_b32 v14, v10
    v_permlane16_swap_b32 v15, v11
    s_nop 0
    v_add_f32 v8, v8, v12
    v_add_f32 v9, v9, v13
    v_add_f32 v10, v10, v14
    v_add_f32 v11, v11, v15
    v_mov_b32 v12, v8
    v_mov_b32 v13, v9
    v_mov_b32 v14, v10
    v_mov_b32 v15, v11
    s_nop 0
    v_permlane32_swap_b32 v12, v8
    v_permlane32_swap_b32 v13, v9
    v_permlane32_swap_b32 v14, v10
    v_permlane32_swap_b32 v15, v11
    s_nop 0
    v_add_f32 v8, v8, v12
    v_add_f32 v9, v9, v13
    v_add_f32 v10, v10, v14
    v_add_f32 v11, v11, v15
    s_sub_u32 s13, s3, 4
    s_lshl_b32 s13, s13, 6
    s_add_u32 s13, s13, 161024
    v_lshlrev_b32 v5, 4, v1
    v_add_u32 v5, s13, v5
    s_mov_b64 exec, 0xf
    ds_write_b128 v5, v[8:11]
    s_mov_b64 exec, -1
    s_waitcnt lgkmcnt(0)
    s_mov_b64 exec, 1
    v_mov_b32 v4, 158752
    v_mov_b32 v5, 1
    ds_add_rtn_u32 v5, v4, v5
    s_waitcnt lgkmcnt(0)
    v_readfirstlane_b32 s13, v5
    s_mov_b64 exec, -1
    s_cmp_eq_u32 s13, 0
    s_cbranch_scc1 L_B_CSP
    s_cmp_lg_u32 s13, 3
    s_cbranch_scc1 L_B_LD1
    s_mov_b64 exec, 0xf
    v_lshlrev_b32 v5, 4, v1
    v_add_u32 v5, 161024, v5
    ds_read_b128 v[16:19], v5 offset:0
    ds_read_b128 v[20:23], v5 offset:64
    ds_read_b128 v[24:27], v5 offset:128
    ds_read_b128 v[28:31], v5 offset:192
    s_waitcnt lgkmcnt(0)
    v_pk_add_f32 v[16:17], v[16:17], v[20:21]
    v_pk_add_f32 v[18:19], v[18:19], v[22:23]
    v_pk_add_f32 v[16:17], v[16:17], v[24:25]
    v_pk_add_f32 v[18:19], v[18:19], v[26:27]
    v_pk_add_f32 v[16:17], v[16:17], v[28:29]
    v_pk_add_f32 v[18:19], v[18:19], v[30:31]
    v_mul_f32 v16, 0x3acccccd, v16
    v_mul_f32 v17, 0x3acccccd, v17
    v_fma_f32 v17, -v16, v16, v17
    v_max_f32 v17, 0, v17
    v_cvt_pk_bf16_f32 v16, v16, v16
    v_lshlrev_b32 v16, 16, v16
    v_cvt_pk_bf16_f32 v17, v17, v17
    v_lshlrev_b32 v17, 16, v17
    v_add_f32 v17, 0x3727c5ac, v17
    v_cvt_pk_bf16_f32 v17, v17, v17
    v_lshlrev_b32 v17, 16, v17
    v_sqrt_f32 v17, v17
    s_nop 0
    v_cvt_pk_bf16_f32 v17, v17, v17
    v_lshlrev_b32 v17, 16, v17
    v_rcp_f32 v17, v17
    s_nop 0
    v_mul_f32 v16, v16, v17
    v_mul_f32 v18, 0x3acccccd, v18
    v_mul_f32 v19, 0x3acccccd, v19
    v_fma_f32 v19, -v18, v18, v19
    v_max_f32 v19, 0, v19
    v_cvt_pk_bf16_f32 v18, v18, v18
    v_lshlrev_b32 v18, 16, v18
    v_cvt_pk_bf16_f32 v19, v19, v19
    v_lshlrev_b32 v19, 16, v19
    v_add_f32 v19, 0x3727c5ac, v19
    v_cvt_pk_bf16_f32 v19, v19, v19
    v_lshlrev_b32 v19, 16, v19
    v_sqrt_f32 v19, v19
    s_nop 0
    v_cvt_pk_bf16_f32 v19, v19, v19
    v_lshlrev_b32 v19, 16, v19
    v_rcp_f32 v19, v19
    s_nop 0
    v_mul_f32 v18, v18, v19
    v_lshlrev_b32 v5, 4, v1
    s_lshl_b32 s13, s12, 3
    s_add_u32 s13, s13, 0x10000
    buffer_store_dwordx4 v[16:19], v5, s[8:11], s13 offen sc1
    s_mov_b64 exec, -1
    v_lshlrev_b32 v5, 4, v1
    s_lshl_b32 s13, s66, 10
    s_add_u32 s13, s13, 0x10000
    s_mov_b32 s47, 0
L_ST2_TOP:
    buffer_load_dwordx4 v[16:19], v5, s[8:11], s13 offen sc1
    s_waitcnt vmcnt(0)
    v_max_u32 v8, v17, v19
    v_cmp_eq_u32 vcc, -1, v8
    s_cbranch_vccz L_ST2_OK
    s_sleep 1
    s_add_u32 s47, s47, 1
    s_cmp_lt_u32 s47, 262144
    s_cbranch_scc1 L_ST2_TOP
L_ST2_OK:
    v_add_u32 v6, 158976, v5
    ds_write_b128 v6, v[16:19]
    s_waitcnt lgkmcnt(0)
    s_mov_b64 exec, 1
    v_mov_b32 v6, 158804
    v_mov_b32 v7, 1
    ds_add_u32 v6, v7
    s_mov_b64 exec, -1
    s_branch L_B_LD1
L_B_CSP:
    s_mov_b64 s[68:69], exec
    s_mov_b64 exec, 0xff
    v_lshlrev_b32 v25, 7, v1
    s_mov_b32 s46, 0x20400
    s_mov_b32 s47, 0
PS_128:
    buffer_load_dword v24, v25, s[8:11], s46 offen sc1
    s_waitcnt vmcnt(0)
    v_cmp_le_u32 vcc, 32, v24
    s_cmp_eq_u64 vcc, exec
    s_cbranch_scc1 PSD_129
    s_sleep 16
    s_add_u32 s47, s47, 1
    s_cmp_lt_u32 s47, 262144
    s_cbranch_scc1 PS_128
PSD_129:
    s_mov_b64 exec, s[68:69]
    s_mul_i32 s14, s67, 112
    v_lshlrev_b32 v5, 2, v1
    s_lshl_b32 s13, s14, 2
    s_add_u32 s13, s13, 0x8000
    buffer_load_dword v20, v5, s[8:11], s13 offen sc1
    buffer_load_dword v21, v5, s[8:11], s13 offen offset:256 sc1
    s_mov_b32 s4, s38
    s_mov_b32 s5, s39
    s_mov_b32 s6, 0xd80
    s_mov_b32 s7, 0x00020000
    v_lshlrev_b32 v6, 1, v1
    s_lshl_b32 s13, s14, 1
    buffer_load_ushort v22, v6, s[4:7], s13 offen
    buffer_load_ushort v23, v6, s[4:7], s13 offen offset:128
    s_waitcnt vmcnt(0)
    v_lshlrev_b32 v22, 16, v22
    v_lshlrev_b32 v23, 16, v23
    v_add_u32 v6, 158720, v5
    ds_write_b32 v6, v20 offset:1280
    ds_write_b32 v6, v21 offset:1536
    ds_write_b32 v6, v22 offset:1792
    ds_write_b32 v6, v23 offset:2048
    s_waitcnt lgkmcnt(0)
    s_mov_b64 exec, 1
    v_mov_b32 v6, 158804
    v_mov_b32 v7, 1
    ds_add_u32 v6, v7
    s_mov_b64 exec, -1
L_B_LD1:
    s_setprio 0
    s_mov_b32 s46, 132
    s_mov_b64 s[68:69], exec
    s_mov_b32 exec_lo, 0x1
    s_mov_b32 exec_hi, 0x0
    v_lshlrev_b32 v12, 2, v1
    s_mov_b32 s47, 0
POLL_130:
    buffer_load_dword v8, v12, s[56:59], s46 offen sc1
    s_waitcnt vmcnt(0)
    v_cmp_ne_u32 vcc, 0, v8
    s_cmp_eq_u64 vcc, exec
    s_cbranch_scc1 POLLD_131
    s_sleep 2
    s_add_u32 s47, s47, 1
    s_cmp_lt_u32 s47, 262144
    s_cbranch_scc1 POLL_130
POLLD_131:
    s_mov_b64 exec, s[68:69]
    s_mov_b64 exec, 1
    v_mov_b32 v8, 158800
    v_mov_b32 v9, 1
    ds_add_u32 v8, v9
    s_mov_b64 exec, -1
    v_mov_b32 v6, 158736
LW_132:
    ds_read_b32 v7, v6
    s_waitcnt lgkmcnt(0)
    v_readfirstlane_b32 s13, v7
    s_cmp_ge_u32 s13, 4
    s_cbranch_scc1 LWD_133
    s_sleep 2
    s_branch LW_132
LWD_133:
    v_lshlrev_b32 v4, 4, v1
    s_add_u32 s46, s61, 0
    buffer_load_dwordx4 v[120:123], v4, s[8:11], s46 offen offset:0 sc1
    buffer_load_dwordx4 v[124:127], v4, s[8:11], s46 offen offset:1024 sc1
    buffer_load_dwordx4 v[128:131], v4, s[8:11], s46 offen offset:2048 sc1
    buffer_load_dwordx4 v[132:135], v4, s[8:11], s46 offen offset:3072 sc1
    s_add_u32 s46, s46, 4096
    buffer_load_dwordx4 v[136:139], v4, s[8:11], s46 offen sc1
    s_add_u32 s46, s61, 5120
    buffer_load_dwordx4 v[140:143], v4, s[8:11], s46 offen offset:0 sc1
    buffer_load_dwordx4 v[144:147], v4, s[8:11], s46 offen offset:1024 sc1
    buffer_load_dwordx4 v[148:151], v4, s[8:11], s46 offen offset:2048 sc1
    buffer_load_dwordx4 v[152:155], v4, s[8:11], s46 offen offset:3072 sc1
    s_add_u32 s46, s46, 4096
    buffer_load_dwordx4 v[156:159], v4, s[8:11], s46 offen sc1
    s_add_u32 s46, s61, 10240
    buffer_load_dwordx4 v[160:163], v4, s[8:11], s46 offen offset:0 sc1
    buffer_load_dwordx4 v[164:167], v4, s[8:11], s46 offen offset:1024 sc1
    buffer_load_dwordx4 v[168:171], v4, s[8:11], s46 offen offset:2048 sc1
    buffer_load_dwordx4 v[172:175], v4, s[8:11], s46 offen offset:3072 sc1
    s_add_u32 s46, s46, 4096
    buffer_load_dwordx4 v[176:179], v4, s[8:11], s46 offen sc1
    s_add_u32 s46, s61, 15360
    buffer_load_dwordx4 v[180:183], v4, s[8:11], s46 offen offset:0 sc1
    buffer_load_dwordx4 v[184:187], v4, s[8:11], s46 offen offset:1024 sc1
    buffer_load_dwordx4 v[188:191], v4, s[8:11], s46 offen offset:2048 sc1
    buffer_load_dwordx4 v[192:195], v4, s[8:11], s46 offen offset:3072 sc1
    s_add_u32 s46, s46, 4096
    buffer_load_dwordx4 v[196:199], v4, s[8:11], s46 offen sc1
    s_add_u32 s46, s61, 20480
    buffer_load_dwordx4 v[200:203], v4, s[8:11], s46 offen offset:0 sc1
    buffer_load_dwordx4 v[204:207], v4, s[8:11], s46 offen offset:1024 sc1
    buffer_load_dwordx4 v[208:211], v4, s[8:11], s46 offen offset:2048 sc1
    buffer_load_dwordx4 v[212:215], v4, s[8:11], s46 offen offset:3072 sc1
    s_add_u32 s46, s46, 4096
    buffer_load_dwordx4 v[216:219], v4, s[8:11], s46 offen sc1
    s_add_u32 s46, s61, 25600
    buffer_load_dwordx4 v[220:223], v4, s[8:11], s46 offen offset:0 sc1
    buffer_load_dwordx4 v[224:227], v4, s[8:11], s46 offen offset:1024 sc1
    buffer_load_dwordx4 v[228:231], v4, s[8:11], s46 offen offset:2048 sc1
    buffer_load_dwordx4 v[232:235], v4, s[8:11], s46 offen offset:3072 sc1
    s_add_u32 s46, s46, 4096
    buffer_load_dwordx4 v[236:239], v4, s[8:11], s46 offen sc1
    v_mov_b32 v6, 158804
LW_134:
    ds_read_b32 v7, v6
    s_waitcnt lgkmcnt(0)
    v_readfirstlane_b32 s13, v7
    s_cmp_ge_u32 s13, 2
    s_cbranch_scc1 LWD_135
    s_sleep 4
    s_branch LW_134
LWD_135:
    v_mov_b32 v6, 158760
LW_136:
    ds_read_b32 v7, v6
    s_waitcnt lgkmcnt(0)
    v_readfirstlane_b32 s13, v7
    s_cmp_ge_u32 s13, 4
    s_cbranch_scc1 LWD_137
    s_sleep 4
    s_branch LW_136
LWD_137:
L_PHASE_C:
    s_lshr_b32 s12, s64, 1
    s_lshl_b32 s12, s12, 3
    s_lshr_b32 s13, s65, 2
    s_add_u32 s12, s12, s13
    s_and_b32 s4, s3, 3
    s_mul_i32 s5, s4, 7
    s_lshr_b32 s6, s3, 2
    s_mul_i32 s7, s6, 27
    s_add_u32 s5, s5, s7
    s_lshl_b32 s5, s5, 7
    s_lshl_b32 s7, s12, 2
    s_add_u32 s5, s5, s7
    s_lshl_b32 s5, s5, 10
    s_add_u32 s5, s5, 0x400000
    s_cmp_ge_u32 s3, 4
    s_cbranch_scc1 W2S_138
    s_add_u32 s46, s61, 0
    buffer_load_dwordx4 v[120:123], v4, s[8:11], s46 offen offset:0 sc1
    buffer_load_dwordx4 v[124:127], v4, s[8:11], s46 offen offset:1024 sc1
    buffer_load_dwordx4 v[128:131], v4, s[8:11], s46 offen offset:2048 sc1
    buffer_load_dwordx4 v[132:135], v4, s[8:11], s46 offen offset:3072 sc1
    s_add_u32 s46, s46, 4096
    buffer_load_dwordx4 v[136:139], v4, s[8:11], s46 offen sc1
W2S_138:
    s_cmp_ge_u32 s3, 4
    s_cbranch_scc1 W2S_139
    s_add_u32 s46, s61, 5120
    buffer_load_dwordx4 v[140:143], v4, s[8:11], s46 offen offset:0 sc1
    buffer_load_dwordx4 v[144:147], v4, s[8:11], s46 offen offset:1024 sc1
    buffer_load_dwordx4 v[148:151], v4, s[8:11], s46 offen offset:2048 sc1
    buffer_load_dwordx4 v[152:155], v4, s[8:11], s46 offen offset:3072 sc1
    s_add_u32 s46, s46, 4096
    buffer_load_dwordx4 v[156:159], v4, s[8:11], s46 offen sc1
W2S_139:
    s_cmp_ge_u32 s3, 4
    s_cbranch_scc1 W2S_140
    s_add_u32 s46, s61, 10240
    buffer_load_dwordx4 v[160:163], v4, s[8:11], s46 offen offset:0 sc1
    buffer_load_dwordx4 v[164:167], v4, s[8:11], s46 offen offset:1024 sc1
    buffer_load_dwordx4 v[168:171], v4, s[8:11], s46 offen offset:2048 sc1
    buffer_load_dwordx4 v[172:175], v4, s[8:11], s46 offen offset:3072 sc1
    s_add_u32 s46, s46, 4096
    buffer_load_dwordx4 v[176:179], v4, s[8:11], s46 offen sc1
W2S_140:
    s_cmp_ge_u32 s3, 4
    s_cbranch_scc1 W2S_141
    s_add_u32 s46, s61, 15360
    buffer_load_dwordx4 v[180:183], v4, s[8:11], s46 offen offset:0 sc1
    buffer_load_dwordx4 v[184:187], v4, s[8:11], s46 offen offset:1024 sc1
    buffer_load_dwordx4 v[188:191], v4, s[8:11], s46 offen offset:2048 sc1
    buffer_load_dwordx4 v[192:195], v4, s[8:11], s46 offen offset:3072 sc1
    s_add_u32 s46, s46, 4096
    buffer_load_dwordx4 v[196:199], v4, s[8:11], s46 offen sc1
W2S_141:
    s_cmp_ge_u32 s3, 4
    s_cbranch_scc1 W2S_142
    s_add_u32 s46, s61, 20480
    buffer_load_dwordx4 v[200:203], v4, s[8:11], s46 offen offset:0 sc1
    buffer_load_dwordx4 v[204:207], v4, s[8:11], s46 offen offset:1024 sc1
    buffer_load_dwordx4 v[208:211], v4, s[8:11], s46 offen offset:2048 sc1
    buffer_load_dwordx4 v[212:215], v4, s[8:11], s46 offen offset:3072 sc1
    s_add_u32 s46, s46, 4096
    buffer_load_dwordx4 v[216:219], v4, s[8:11], s46 offen sc1
W2S_142:
    s_cmp_ge_u32 s3, 4
    s_cbranch_scc1 W2S_143
    s_add_u32 s46, s61, 25600
    buffer_load_dwordx4 v[220:223], v4, s[8:11], s46 offen offset:0 sc1
    buffer_load_dwordx4 v[224:227], v4, s[8:11], s46 offen offset:1024 sc1
    buffer_load_dwordx4 v[228:231], v4, s[8:11], s46 offen offset:2048 sc1
    buffer_load_dwordx4 v[232:235], v4, s[8:11], s46 offen offset:3072 sc1
    s_add_u32 s46, s46, 4096
    buffer_load_dwordx4 v[236:239], v4, s[8:11], s46 offen sc1
W2S_143:
    s_add_u32 s13, s5, 0
    buffer_load_dwordx4 v[8:11], v4, s[8:11], s13 offen offset:0 sc1
    s_add_u32 s13, s5, 0
    buffer_load_dwordx4 v[12:15], v4, s[8:11], s13 offen offset:1024 sc1
    s_add_u32 s13, s5, 0
    buffer_load_dwordx4 v[16:19], v4, s[8:11], s13 offen offset:2048 sc1
    s_add_u32 s13, s5, 0
    buffer_load_dwordx4 v[20:23], v4, s[8:11], s13 offen offset:3072 sc1
    s_add_u32 s13, s5, 131072
    buffer_load_dwordx4 v[24:27], v4, s[8:11], s13 offen offset:0 sc1
    s_add_u32 s13, s5, 131072
    buffer_load_dwordx4 v[28:31], v4, s[8:11], s13 offen offset:1024 sc1
    s_add_u32 s13, s5, 131072
    buffer_load_dwordx4 v[32:35], v4, s[8:11], s13 offen offset:2048 sc1
    s_add_u32 s13, s5, 131072
    buffer_load_dwordx4 v[36:39], v4, s[8:11], s13 offen offset:3072 sc1
    v_mov_b32 v40, 0
    v_mov_b32 v41, 0
    v_mov_b32 v42, 0
    v_mov_b32 v43, 0
    v_mov_b32 v44, 0
    v_mov_b32 v45, 0
    v_mov_b32 v46, 0
    v_mov_b32 v47, 0
    v_mov_b32 v48, 0
    v_mov_b32 v49, 0
    v_mov_b32 v50, 0
    v_mov_b32 v51, 0
    v_mov_b32 v52, 0
    v_mov_b32 v53, 0
    v_mov_b32 v54, 0
    v_mov_b32 v55, 0
    v_mov_b32 v56, 0
    v_mov_b32 v57, 0
    v_mov_b32 v58, 0
    v_mov_b32 v59, 0
    v_mov_b32 v60, 0
    v_mov_b32 v61, 0
    v_mov_b32 v62, 0
    v_mov_b32 v63, 0
    v_mov_b32 v64, 0
    v_mov_b32 v65, 0
    v_mov_b32 v66, 0
    v_mov_b32 v67, 0
    v_mov_b32 v68, 0
    v_mov_b32 v69, 0
    v_mov_b32 v70, 0
    v_mov_b32 v71, 0
    v_mov_b32 v72, 0
    v_mov_b32 v73, 0
    v_mov_b32 v74, 0
    v_mov_b32 v75, 0
    v_mov_b32 v76, 0
    v_mov_b32 v77, 0
    v_mov_b32 v78, 0
    v_mov_b32 v79, 0
    v_mov_b32 v80, 0
    v_mov_b32 v81, 0
    v_mov_b32 v82, 0
    v_mov_b32 v83, 0
    v_mov_b32 v84, 0
    v_mov_b32 v85, 0
    v_mov_b32 v86, 0
    v_mov_b32 v87, 0
    v_mov_b32 v88, 0
    v_mov_b32 v89, 0
    v_mov_b32 v90, 0
    v_mov_b32 v91, 0
    v_mov_b32 v92, 0
    v_mov_b32 v93, 0
    v_mov_b32 v94, 0
    v_mov_b32 v95, 0
    v_mov_b32 v96, 0
    v_mov_b32 v97, 0
    v_mov_b32 v98, 0
    v_mov_b32 v99, 0
    v_mov_b32 v100, 0
    v_mov_b32 v101, 0
    v_mov_b32 v102, 0
    v_mov_b32 v103, 0
    v_mov_b32 v104, 0
    v_mov_b32 v105, 0
    v_mov_b32 v106, 0
    v_mov_b32 v107, 0
    v_mov_b32 v108, 0
    v_mov_b32 v109, 0
    v_mov_b32 v110, 0
    v_mov_b32 v111, 0
    v_mov_b32 v112, 0
    v_mov_b32 v113, 0
    v_mov_b32 v114, 0
    v_mov_b32 v115, 0
    v_mov_b32 v116, 0
    v_mov_b32 v117, 0
    v_mov_b32 v118, 0
    v_mov_b32 v119, 0
    s_mov_b32 s56, s42
    s_mov_b32 s57, s43
    s_mov_b32 s58, 0x500
    s_mov_b32 s59, 0x00020000
    s_mov_b32 s48, s44
    s_mov_b32 s49, s45
    s_mov_b32 s50, 0x280000
    s_mov_b32 s51, 0x00020000
    s_mul_i32 s7, s60, 5
    s_lshl_b32 s15, s12, 6
    s_and_b32 s14, s3, 3
    s_lshr_b32 s13, s14, 1
    s_lshl_b32 s13, s13, 5
    s_add_u32 s15, s15, s13
    s_and_b32 s13, s14, 1
    s_add_u32 s15, s15, s13
    v_lshlrev_b32 v6, 1, v2
    v_add_u32 v6, s15, v6
    s_waitcnt vmcnt(7)
    v_max_u32 v5, v8, v10
    v_cmp_eq_u32 vcc, -1, v5
    s_cbranch_vccnz GBAD_144
GOK_145:
    v_mfma_f32_16x16x32_bf16 v[40:43], v[120:123], v[8:11], v[40:43]
    v_mfma_f32_16x16x32_bf16 v[56:59], v[124:127], v[8:11], v[56:59]
    s_waitcnt vmcnt(6)
    v_max_u32 v5, v12, v14
    v_cmp_eq_u32 vcc, -1, v5
    v_mfma_f32_16x16x32_bf16 v[72:75], v[128:131], v[8:11], v[72:75]
    v_mfma_f32_16x16x32_bf16 v[88:91], v[132:135], v[8:11], v[88:91]
    v_mfma_f32_16x16x32_bf16 v[104:107], v[136:139], v[8:11], v[104:107]
    s_add_u32 s13, s5, 262144
    buffer_load_dwordx4 v[8:11], v4, s[8:11], s13 offen offset:0 sc1
    s_cbranch_vccnz GBAD_146
GOK_147:
    v_mfma_f32_16x16x32_bf16 v[44:47], v[120:123], v[12:15], v[44:47]
    v_mfma_f32_16x16x32_bf16 v[60:63], v[124:127], v[12:15], v[60:63]
    s_waitcnt vmcnt(6)
    v_max_u32 v5, v16, v18
    v_cmp_eq_u32 vcc, -1, v5
    v_mfma_f32_16x16x32_bf16 v[76:79], v[128:131], v[12:15], v[76:79]
    v_mfma_f32_16x16x32_bf16 v[92:95], v[132:135], v[12:15], v[92:95]
    v_mfma_f32_16x16x32_bf16 v[108:111], v[136:139], v[12:15], v[108:111]
    s_add_u32 s13, s5, 262144
    buffer_load_dwordx4 v[12:15], v4, s[8:11], s13 offen offset:1024 sc1
    s_cbranch_vccnz GBAD_148
GOK_149:
    v_mfma_f32_16x16x32_bf16 v[48:51], v[120:123], v[16:19], v[48:51]
    v_mfma_f32_16x16x32_bf16 v[64:67], v[124:127], v[16:19], v[64:67]
    s_waitcnt vmcnt(6)
    v_max_u32 v5, v20, v22
    v_cmp_eq_u32 vcc, -1, v5
    v_mfma_f32_16x16x32_bf16 v[80:83], v[128:131], v[16:19], v[80:83]
    v_mfma_f32_16x16x32_bf16 v[96:99], v[132:135], v[16:19], v[96:99]
    v_mfma_f32_16x16x32_bf16 v[112:115], v[136:139], v[16:19], v[112:115]
    s_add_u32 s13, s5, 262144
    buffer_load_dwordx4 v[16:19], v4, s[8:11], s13 offen offset:2048 sc1
    s_cbranch_vccnz GBAD_150
GOK_151:
    v_mfma_f32_16x16x32_bf16 v[52:55], v[120:123], v[20:23], v[52:55]
    v_mfma_f32_16x16x32_bf16 v[68:71], v[124:127], v[20:23], v[68:71]
    s_waitcnt vmcnt(6)
    v_max_u32 v5, v24, v26
    v_cmp_eq_u32 vcc, -1, v5
    v_mfma_f32_16x16x32_bf16 v[84:87], v[128:131], v[20:23], v[84:87]
    v_mfma_f32_16x16x32_bf16 v[100:103], v[132:135], v[20:23], v[100:103]
    v_mfma_f32_16x16x32_bf16 v[116:119], v[136:139], v[20:23], v[116:119]
    s_add_u32 s13, s5, 262144
    buffer_load_dwordx4 v[20:23], v4, s[8:11], s13 offen offset:3072 sc1
    s_add_u32 s46, s61, 30720
    buffer_load_dwordx4 v[120:123], v4, s[8:11], s46 offen offset:0 sc1
    buffer_load_dwordx4 v[124:127], v4, s[8:11], s46 offen offset:1024 sc1
    buffer_load_dwordx4 v[128:131], v4, s[8:11], s46 offen offset:2048 sc1
    buffer_load_dwordx4 v[132:135], v4, s[8:11], s46 offen offset:3072 sc1
    s_add_u32 s46, s46, 4096
    buffer_load_dwordx4 v[136:139], v4, s[8:11], s46 offen sc1
W2S_152:
    s_cbranch_vccnz GBAD_153
GOK_154:
    v_mfma_f32_16x16x32_bf16 v[40:43], v[140:143], v[24:27], v[40:43]
    v_mfma_f32_16x16x32_bf16 v[56:59], v[144:147], v[24:27], v[56:59]
    s_waitcnt vmcnt(11)
    v_max_u32 v5, v28, v30
    v_cmp_eq_u32 vcc, -1, v5
    v_mfma_f32_16x16x32_bf16 v[72:75], v[148:151], v[24:27], v[72:75]
    v_mfma_f32_16x16x32_bf16 v[88:91], v[152:155], v[24:27], v[88:91]
    v_mfma_f32_16x16x32_bf16 v[104:107], v[156:159], v[24:27], v[104:107]
    s_add_u32 s13, s5, 393216
    buffer_load_dwordx4 v[24:27], v4, s[8:11], s13 offen offset:0 sc1
    s_cbranch_vccnz GBAD_155
GOK_156:
    v_mfma_f32_16x16x32_bf16 v[44:47], v[140:143], v[28:31], v[44:47]
    v_mfma_f32_16x16x32_bf16 v[60:63], v[144:147], v[28:31], v[60:63]
    s_waitcnt vmcnt(11)
    v_max_u32 v5, v32, v34
    v_cmp_eq_u32 vcc, -1, v5
    v_mfma_f32_16x16x32_bf16 v[76:79], v[148:151], v[28:31], v[76:79]
    v_mfma_f32_16x16x32_bf16 v[92:95], v[152:155], v[28:31], v[92:95]
    v_mfma_f32_16x16x32_bf16 v[108:111], v[156:159], v[28:31], v[108:111]
    s_add_u32 s13, s5, 393216
    buffer_load_dwordx4 v[28:31], v4, s[8:11], s13 offen offset:1024 sc1
    s_cbranch_vccnz GBAD_157
GOK_158:
    v_mfma_f32_16x16x32_bf16 v[48:51], v[140:143], v[32:35], v[48:51]
    v_mfma_f32_16x16x32_bf16 v[64:67], v[144:147], v[32:35], v[64:67]
    s_waitcnt vmcnt(11)
    v_max_u32 v5, v36, v38
    v_cmp_eq_u32 vcc, -1, v5
    v_mfma_f32_16x16x32_bf16 v[80:83], v[148:151], v[32:35], v[80:83]
    v_mfma_f32_16x16x32_bf16 v[96:99], v[152:155], v[32:35], v[96:99]
    v_mfma_f32_16x16x32_bf16 v[112:115], v[156:159], v[32:35], v[112:115]
    s_add_u32 s13, s5, 393216
    buffer_load_dwordx4 v[32:35], v4, s[8:11], s13 offen offset:2048 sc1
    s_cbranch_vccnz GBAD_159
GOK_160:
    v_mfma_f32_16x16x32_bf16 v[52:55], v[140:143], v[36:39], v[52:55]
    v_mfma_f32_16x16x32_bf16 v[68:71], v[144:147], v[36:39], v[68:71]
    s_waitcnt vmcnt(11)
    v_max_u32 v5, v8, v10
    v_cmp_eq_u32 vcc, -1, v5
    v_mfma_f32_16x16x32_bf16 v[84:87], v[148:151], v[36:39], v[84:87]
    v_mfma_f32_16x16x32_bf16 v[100:103], v[152:155], v[36:39], v[100:103]
    v_mfma_f32_16x16x32_bf16 v[116:119], v[156:159], v[36:39], v[116:119]
    s_add_u32 s13, s5, 393216
    buffer_load_dwordx4 v[36:39], v4, s[8:11], s13 offen offset:3072 sc1
    s_lshr_b32 s46, s3, 2
    s_add_u32 s46, s46, 0
    s_min_u32 s46, s46, 4
    s_add_u32 s46, s46, s7
    s_lshl_b32 s13, s46, 16
    s_add_u32 s13, s13, 0x100000
    v_lshlrev_b32 v7, 14, v3
    v_lshl_add_u32 v7, v6, 3, v7
    buffer_load_dwordx2 v[240:241], v7, s[8:11], s13 offen sc1
    s_lshl_b32 s13, s46, 5
    v_lshlrev_b32 v7, 3, v3
    buffer_load_dwordx2 v[246:247], v7, s[56:59], s13 offen
    s_lshr_b32 s46, s3, 2
    s_add_u32 s46, s46, 2
    s_min_u32 s46, s46, 4
    s_add_u32 s46, s46, s7
    s_lshl_b32 s13, s46, 16
    s_add_u32 s13, s13, 0x100000
    v_lshlrev_b32 v7, 14, v3
    v_lshl_add_u32 v7, v6, 3, v7
    buffer_load_dwordx2 v[242:243], v7, s[8:11], s13 offen sc1
    s_lshl_b32 s13, s46, 5
    v_lshlrev_b32 v7, 3, v3
    buffer_load_dwordx2 v[248:249], v7, s[56:59], s13 offen
    s_lshr_b32 s46, s3, 2
    s_add_u32 s46, s46, 4
    s_min_u32 s46, s46, 4
    s_add_u32 s46, s46, s7
    s_lshl_b32 s13, s46, 16
    s_add_u32 s13, s13, 0x100000
    v_lshlrev_b32 v7, 14, v3
    v_lshl_add_u32 v7, v6, 3, v7
    buffer_load_dwordx2 v[244:245], v7, s[8:11], s13 offen sc1
    s_lshl_b32 s13, s46, 5
    v_lshlrev_b32 v7, 3, v3
    buffer_load_dwordx2 v[250:251], v7, s[56:59], s13 offen
    s_cbranch_vccnz GBAD_161
GOK_162:
    v_mfma_f32_16x16x32_bf16 v[40:43], v[160:163], v[8:11], v[40:43]
    v_mfma_f32_16x16x32_bf16 v[56:59], v[164:167], v[8:11], v[56:59]
    s_waitcnt vmcnt(17)
    v_max_u32 v5, v12, v14
    v_cmp_eq_u32 vcc, -1, v5
    v_mfma_f32_16x16x32_bf16 v[72:75], v[168:171], v[8:11], v[72:75]
    v_mfma_f32_16x16x32_bf16 v[88:91], v[172:175], v[8:11], v[88:91]
    v_mfma_f32_16x16x32_bf16 v[104:107], v[176:179], v[8:11], v[104:107]
    s_add_u32 s13, s5, 524288
    buffer_load_dwordx4 v[8:11], v4, s[8:11], s13 offen offset:0 sc1
    s_cbranch_vccnz GBAD_163
GOK_164:
    v_mfma_f32_16x16x32_bf16 v[44:47], v[160:163], v[12:15], v[44:47]
    v_mfma_f32_16x16x32_bf16 v[60:63], v[164:167], v[12:15], v[60:63]
    s_waitcnt vmcnt(17)
    v_max_u32 v5, v16, v18
    v_cmp_eq_u32 vcc, -1, v5
    v_mfma_f32_16x16x32_bf16 v[76:79], v[168:171], v[12:15], v[76:79]
    v_mfma_f32_16x16x32_bf16 v[92:95], v[172:175], v[12:15], v[92:95]
    v_mfma_f32_16x16x32_bf16 v[108:111], v[176:179], v[12:15], v[108:111]
    s_add_u32 s13, s5, 524288
    buffer_load_dwordx4 v[12:15], v4, s[8:11], s13 offen offset:1024 sc1
    s_cbranch_vccnz GBAD_165
GOK_166:
    v_mfma_f32_16x16x32_bf16 v[48:51], v[160:163], v[16:19], v[48:51]
    v_mfma_f32_16x16x32_bf16 v[64:67], v[164:167], v[16:19], v[64:67]
    s_waitcnt vmcnt(17)
    v_max_u32 v5, v20, v22
    v_cmp_eq_u32 vcc, -1, v5
    v_mfma_f32_16x16x32_bf16 v[80:83], v[168:171], v[16:19], v[80:83]
    v_mfma_f32_16x16x32_bf16 v[96:99], v[172:175], v[16:19], v[96:99]
    v_mfma_f32_16x16x32_bf16 v[112:115], v[176:179], v[16:19], v[112:115]
    s_add_u32 s13, s5, 524288
    buffer_load_dwordx4 v[16:19], v4, s[8:11], s13 offen offset:2048 sc1
    s_cbranch_vccnz GBAD_167
GOK_168:
    v_mfma_f32_16x16x32_bf16 v[52:55], v[160:163], v[20:23], v[52:55]
    v_mfma_f32_16x16x32_bf16 v[68:71], v[164:167], v[20:23], v[68:71]
    s_waitcnt vmcnt(12)
    v_max_u32 v5, v24, v26
    v_cmp_eq_u32 vcc, -1, v5
    v_mfma_f32_16x16x32_bf16 v[84:87], v[168:171], v[20:23], v[84:87]
    v_mfma_f32_16x16x32_bf16 v[100:103], v[172:175], v[20:23], v[100:103]
    v_mfma_f32_16x16x32_bf16 v[116:119], v[176:179], v[20:23], v[116:119]
    s_add_u32 s13, s5, 524288
    buffer_load_dwordx4 v[20:23], v4, s[8:11], s13 offen offset:3072 sc1
    s_cbranch_vccnz GBAD_169
GOK_170:
    v_mfma_f32_16x16x32_bf16 v[40:43], v[180:183], v[24:27], v[40:43]
    v_mfma_f32_16x16x32_bf16 v[56:59], v[184:187], v[24:27], v[56:59]
    s_waitcnt vmcnt(12)
    v_max_u32 v5, v28, v30
    v_cmp_eq_u32 vcc, -1, v5
    v_mfma_f32_16x16x32_bf16 v[72:75], v[188:191], v[24:27], v[72:75]
    v_mfma_f32_16x16x32_bf16 v[88:91], v[192:195], v[24:27], v[88:91]
    v_mfma_f32_16x16x32_bf16 v[104:107], v[196:199], v[24:27], v[104:107]
    s_add_u32 s13, s5, 655360
    buffer_load_dwordx4 v[24:27], v4, s[8:11], s13 offen offset:0 sc1
    s_cbranch_vccnz GBAD_171
GOK_172:
    v_mfma_f32_16x16x32_bf16 v[44:47], v[180:183], v[28:31], v[44:47]
    v_mfma_f32_16x16x32_bf16 v[60:63], v[184:187], v[28:31], v[60:63]
    s_waitcnt vmcnt(12)
    v_max_u32 v5, v32, v34
    v_cmp_eq_u32 vcc, -1, v5
    v_mfma_f32_16x16x32_bf16 v[76:79], v[188:191], v[28:31], v[76:79]
    v_mfma_f32_16x16x32_bf16 v[92:95], v[192:195], v[28:31], v[92:95]
    v_mfma_f32_16x16x32_bf16 v[108:111], v[196:199], v[28:31], v[108:111]
    s_add_u32 s13, s5, 655360
    buffer_load_dwordx4 v[28:31], v4, s[8:11], s13 offen offset:1024 sc1
    s_cbranch_vccnz GBAD_173
GOK_174:
    v_mfma_f32_16x16x32_bf16 v[48:51], v[180:183], v[32:35], v[48:51]
    v_mfma_f32_16x16x32_bf16 v[64:67], v[184:187], v[32:35], v[64:67]
    s_waitcnt vmcnt(12)
    v_max_u32 v5, v36, v38
    v_cmp_eq_u32 vcc, -1, v5
    v_mfma_f32_16x16x32_bf16 v[80:83], v[188:191], v[32:35], v[80:83]
    v_mfma_f32_16x16x32_bf16 v[96:99], v[192:195], v[32:35], v[96:99]
    v_mfma_f32_16x16x32_bf16 v[112:115], v[196:199], v[32:35], v[112:115]
    s_add_u32 s13, s5, 655360
    buffer_load_dwordx4 v[32:35], v4, s[8:11], s13 offen offset:2048 sc1
    s_cbranch_vccnz GBAD_175
GOK_176:
    v_mfma_f32_16x16x32_bf16 v[52:55], v[180:183], v[36:39], v[52:55]
    v_mfma_f32_16x16x32_bf16 v[68:71], v[184:187], v[36:39], v[68:71]
    s_waitcnt vmcnt(6)
    v_max_u32 v5, v8, v10
    v_cmp_eq_u32 vcc, -1, v5
    v_mfma_f32_16x16x32_bf16 v[84:87], v[188:191], v[36:39], v[84:87]
    v_mfma_f32_16x16x32_bf16 v[100:103], v[192:195], v[36:39], v[100:103]
    v_mfma_f32_16x16x32_bf16 v[116:119], v[196:199], v[36:39], v[116:119]
    s_add_u32 s13, s5, 655360
    buffer_load_dwordx4 v[36:39], v4, s[8:11], s13 offen offset:3072 sc1
    s_cbranch_vccnz GBAD_177
GOK_178:
    v_mfma_f32_16x16x32_bf16 v[40:43], v[200:203], v[8:11], v[40:43]
    v_mfma_f32_16x16x32_bf16 v[56:59], v[204:207], v[8:11], v[56:59]
    s_waitcnt vmcnt(6)
    v_max_u32 v5, v12, v14
    v_cmp_eq_u32 vcc, -1, v5
    v_mfma_f32_16x16x32_bf16 v[72:75], v[208:211], v[8:11], v[72:75]
    v_mfma_f32_16x16x32_bf16 v[88:91], v[212:215], v[8:11], v[88:91]
    v_mfma_f32_16x16x32_bf16 v[104:107], v[216:219], v[8:11], v[104:107]
    s_add_u32 s13, s5, 786432
    buffer_load_dwordx4 v[8:11], v4, s[8:11], s13 offen offset:0 sc1
    s_cbranch_vccnz GBAD_179
GOK_180:
    v_mfma_f32_16x16x32_bf16 v[44:47], v[200:203], v[12:15], v[44:47]
    v_mfma_f32_16x16x32_bf16 v[60:63], v[204:207], v[12:15], v[60:63]
    s_waitcnt vmcnt(6)
    v_max_u32 v5, v16, v18
    v_cmp_eq_u32 vcc, -1, v5
    v_mfma_f32_16x16x32_bf16 v[76:79], v[208:211], v[12:15], v[76:79]
    v_mfma_f32_16x16x32_bf16 v[92:95], v[212:215], v[12:15], v[92:95]
    v_mfma_f32_16x16x32_bf16 v[108:111], v[216:219], v[12:15], v[108:111]
    s_add_u32 s13, s5, 786432
    buffer_load_dwordx4 v[12:15], v4, s[8:11], s13 offen offset:1024 sc1
    s_cbranch_vccnz GBAD_181
GOK_182:
    v_mfma_f32_16x16x32_bf16 v[48:51], v[200:203], v[16:19], v[48:51]
    v_mfma_f32_16x16x32_bf16 v[64:67], v[204:207], v[16:19], v[64:67]
    s_waitcnt vmcnt(6)
    v_max_u32 v5, v20, v22
    v_cmp_eq_u32 vcc, -1, v5
    v_mfma_f32_16x16x32_bf16 v[80:83], v[208:211], v[16:19], v[80:83]
    v_mfma_f32_16x16x32_bf16 v[96:99], v[212:215], v[16:19], v[96:99]
    v_mfma_f32_16x16x32_bf16 v[112:115], v[216:219], v[16:19], v[112:115]
    s_add_u32 s13, s5, 786432
    buffer_load_dwordx4 v[16:19], v4, s[8:11], s13 offen offset:2048 sc1
    s_cbranch_vccnz GBAD_183
GOK_184:
    v_mfma_f32_16x16x32_bf16 v[52:55], v[200:203], v[20:23], v[52:55]
    v_mfma_f32_16x16x32_bf16 v[68:71], v[204:207], v[20:23], v[68:71]
    s_waitcnt vmcnt(6)
    v_max_u32 v5, v24, v26
    v_cmp_eq_u32 vcc, -1, v5
    v_mfma_f32_16x16x32_bf16 v[84:87], v[208:211], v[20:23], v[84:87]
    v_mfma_f32_16x16x32_bf16 v[100:103], v[212:215], v[20:23], v[100:103]
    v_mfma_f32_16x16x32_bf16 v[116:119], v[216:219], v[20:23], v[116:119]
    s_add_u32 s13, s5, 786432
    buffer_load_dwordx4 v[20:23], v4, s[8:11], s13 offen offset:3072 sc1
    s_cbranch_vccnz GBAD_185
GOK_186:
    v_mfma_f32_16x16x32_bf16 v[40:43], v[220:223], v[24:27], v[40:43]
    v_mfma_f32_16x16x32_bf16 v[56:59], v[224:227], v[24:27], v[56:59]
    s_waitcnt vmcnt(6)
    v_max_u32 v5, v28, v30
    v_cmp_eq_u32 vcc, -1, v5
    v_mfma_f32_16x16x32_bf16 v[72:75], v[228:231], v[24:27], v[72:75]
    v_mfma_f32_16x16x32_bf16 v[88:91], v[232:235], v[24:27], v[88:91]
    v_mfma_f32_16x16x32_bf16 v[104:107], v[236:239], v[24:27], v[104:107]
    s_cbranch_vccnz GBAD_187
GOK_188:
    v_mfma_f32_16x16x32_bf16 v[44:47], v[220:223], v[28:31], v[44:47]
    v_mfma_f32_16x16x32_bf16 v[60:63], v[224:227], v[28:31], v[60:63]
    s_waitcnt vmcnt(5)
    v_max_u32 v5, v32, v34
    v_cmp_eq_u32 vcc, -1, v5
    v_mfma_f32_16x16x32_bf16 v[76:79], v[228:231], v[28:31], v[76:79]
    v_mfma_f32_16x16x32_bf16 v[92:95], v[232:235], v[28:31], v[92:95]
    v_mfma_f32_16x16x32_bf16 v[108:111], v[236:239], v[28:31], v[108:111]
    s_cbranch_vccnz GBAD_189
GOK_190:
    v_mfma_f32_16x16x32_bf16 v[48:51], v[220:223], v[32:35], v[48:51]
    v_mfma_f32_16x16x32_bf16 v[64:67], v[224:227], v[32:35], v[64:67]
    s_waitcnt vmcnt(4)
    v_max_u32 v5, v36, v38
    v_cmp_eq_u32 vcc, -1, v5
    v_mfma_f32_16x16x32_bf16 v[80:83], v[228:231], v[32:35], v[80:83]
    v_mfma_f32_16x16x32_bf16 v[96:99], v[232:235], v[32:35], v[96:99]
    v_mfma_f32_16x16x32_bf16 v[112:115], v[236:239], v[32:35], v[112:115]
    s_cbranch_vccnz GBAD_191
GOK_192:
    v_mfma_f32_16x16x32_bf16 v[52:55], v[220:223], v[36:39], v[52:55]
    v_mfma_f32_16x16x32_bf16 v[68:71], v[224:227], v[36:39], v[68:71]
    s_waitcnt vmcnt(3)
    v_max_u32 v5, v8, v10
    v_cmp_eq_u32 vcc, -1, v5
    v_mfma_f32_16x16x32_bf16 v[84:87], v[228:231], v[36:39], v[84:87]
    v_mfma_f32_16x16x32_bf16 v[100:103], v[232:235], v[36:39], v[100:103]
    v_mfma_f32_16x16x32_bf16 v[116:119], v[236:239], v[36:39], v[116:119]
    s_cmp_eq_u32 s4, 3
    s_cbranch_scc1 L_C_RED
    s_waitcnt vmcnt(22)
    s_cbranch_vccnz GBAD_193
GOK_194:
    v_mfma_f32_16x16x32_bf16 v[40:43], v[120:123], v[8:11], v[40:43]
    v_mfma_f32_16x16x32_bf16 v[56:59], v[124:127], v[8:11], v[56:59]
    s_waitcnt vmcnt(2)
    v_max_u32 v5, v12, v14
    v_cmp_eq_u32 vcc, -1, v5
    v_mfma_f32_16x16x32_bf16 v[72:75], v[128:131], v[8:11], v[72:75]
    v_mfma_f32_16x16x32_bf16 v[88:91], v[132:135], v[8:11], v[88:91]
    v_mfma_f32_16x16x32_bf16 v[104:107], v[136:139], v[8:11], v[104:107]
    s_cbranch_vccnz GBAD_195
GOK_196:
    v_mfma_f32_16x16x32_bf16 v[44:47], v[120:123], v[12:15], v[44:47]
    v_mfma_f32_16x16x32_bf16 v[60:63], v[124:127], v[12:15], v[60:63]
    s_waitcnt vmcnt(1)
    v_max_u32 v5, v16, v18
    v_cmp_eq_u32 vcc, -1, v5
    v_mfma_f32_16x16x32_bf16 v[76:79], v[128:131], v[12:15], v[76:79]
    v_mfma_f32_16x16x32_bf16 v[92:95], v[132:135], v[12:15], v[92:95]
    v_mfma_f32_16x16x32_bf16 v[108:111], v[136:139], v[12:15], v[108:111]
    s_cbranch_vccnz GBAD_197
GOK_198:
    v_mfma_f32_16x16x32_bf16 v[48:51], v[120:123], v[16:19], v[48:51]
    v_mfma_f32_16x16x32_bf16 v[64:67], v[124:127], v[16:19], v[64:67]
    s_waitcnt vmcnt(0)
    v_max_u32 v5, v20, v22
    v_cmp_eq_u32 vcc, -1, v5
    v_mfma_f32_16x16x32_bf16 v[80:83], v[128:131], v[16:19], v[80:83]
    v_mfma_f32_16x16x32_bf16 v[96:99], v[132:135], v[16:19], v[96:99]
    v_mfma_f32_16x16x32_bf16 v[112:115], v[136:139], v[16:19], v[112:115]
    s_cbranch_vccnz GBAD_199
GOK_200:
    v_mfma_f32_16x16x32_bf16 v[52:55], v[120:123], v[20:23], v[52:55]
    v_mfma_f32_16x16x32_bf16 v[68:71], v[124:127], v[20:23], v[68:71]
    v_mfma_f32_16x16x32_bf16 v[84:87], v[128:131], v[20:23], v[84:87]
    v_mfma_f32_16x16x32_bf16 v[100:103], v[132:135], v[20:23], v[100:103]
    v_mfma_f32_16x16x32_bf16 v[116:119], v[136:139], v[20:23], v[116:119]
L_C_RED:
    s_waitcnt vmcnt(0)
    s_barrier
    s_lshl_b32 s13, s3, 10
    v_add_u32 v5, s13, v4
    v_add_u32 v7, 65536, v5
    v_add_u32 v8, 131072, v5
    s_nop 3
    ds_write_b128 v5, v[40:43] offset:0
    ds_write_b128 v5, v[44:47] offset:8192
    ds_write_b128 v5, v[48:51] offset:16384
    ds_write_b128 v5, v[52:55] offset:24576
    ds_write_b128 v5, v[56:59] offset:32768
    ds_write_b128 v5, v[60:63] offset:40960
    ds_write_b128 v5, v[64:67] offset:49152
    ds_write_b128 v5, v[68:71] offset:57344
    ds_write_b128 v7, v[72:75] offset:0
    ds_write_b128 v7, v[76:79] offset:8192
    ds_write_b128 v7, v[80:83] offset:16384
    ds_write_b128 v7, v[84:87] offset:24576
    ds_write_b128 v7, v[88:91] offset:32768
    ds_write_b128 v7, v[92:95] offset:40960
    ds_write_b128 v7, v[96:99] offset:49152
    ds_write_b128 v7, v[100:103] offset:57344
    ds_write_b128 v8, v[104:107] offset:0
    ds_write_b128 v8, v[108:111] offset:8192
    ds_write_b128 v8, v[112:115] offset:16384
    ds_write_b128 v8, v[116:119] offset:24576
    s_lshl_b32 s13, s3, 13
    v_add_u32 v5, s13, v4
    v_add_u32 v7, 65536, v5
    v_add_u32 v8, 131072, v5
    s_waitcnt lgkmcnt(0)
    s_barrier
    ds_read_b128 v[120:123], v5 offset:0
    ds_read_b128 v[124:127], v5 offset:1024
    ds_read_b128 v[128:131], v5 offset:2048
    ds_read_b128 v[132:135], v5 offset:3072
    ds_read_b128 v[136:139], v5 offset:4096
    ds_read_b128 v[140:143], v5 offset:5120
    ds_read_b128 v[144:147], v5 offset:6144
    ds_read_b128 v[148:151], v5 offset:7168
    ds_read_b128 v[152:155], v7 offset:0
    ds_read_b128 v[156:159], v7 offset:1024
    ds_read_b128 v[160:163], v7 offset:2048
    ds_read_b128 v[164:167], v7 offset:3072
    ds_read_b128 v[168:171], v7 offset:4096
    ds_read_b128 v[172:175], v7 offset:5120
    ds_read_b128 v[176:179], v7 offset:6144
    ds_read_b128 v[180:183], v7 offset:7168
    s_cmp_ge_u32 s3, 4
    s_cbranch_scc1 L_C_RD
    ds_read_b128 v[184:187], v8 offset:0
    ds_read_b128 v[188:191], v8 offset:1024
    ds_read_b128 v[192:195], v8 offset:2048
    ds_read_b128 v[196:199], v8 offset:3072
    ds_read_b128 v[200:203], v8 offset:4096
    ds_read_b128 v[204:207], v8 offset:5120
    ds_read_b128 v[208:211], v8 offset:6144
    ds_read_b128 v[212:215], v8 offset:7168
L_C_RD:
    s_waitcnt vmcnt(0)
    s_waitcnt lgkmcnt(8)
    v_pk_add_f32 v[120:121], v[120:121], v[124:125]
    v_pk_add_f32 v[122:123], v[122:123], v[126:127]
    v_pk_add_f32 v[128:129], v[128:129], v[132:133]
    v_pk_add_f32 v[130:131], v[130:131], v[134:135]
    v_pk_add_f32 v[136:137], v[136:137], v[140:141]
    v_pk_add_f32 v[138:139], v[138:139], v[142:143]
    v_pk_add_f32 v[144:145], v[144:145], v[148:149]
    v_pk_add_f32 v[146:147], v[146:147], v[150:151]
    v_pk_add_f32 v[120:121], v[120:121], v[128:129]
    v_pk_add_f32 v[122:123], v[122:123], v[130:131]
    v_pk_add_f32 v[136:137], v[136:137], v[144:145]
    v_pk_add_f32 v[138:139], v[138:139], v[146:147]
    v_pk_add_f32 v[120:121], v[120:121], v[136:137]
    v_pk_add_f32 v[122:123], v[122:123], v[138:139]
    v_cvt_pk_bf16_f32 v30, v120, v121
    v_cvt_pk_bf16_f32 v31, v122, v123
    v_lshlrev_b32 v32, 16, v30
    v_and_b32 v33, 0xffff0000, v30
    v_lshlrev_b32 v34, 16, v31
    v_and_b32 v35, 0xffff0000, v31
    v_lshlrev_b32 v36, 16, v246
    v_and_b32 v37, 0xffff0000, v246
    v_lshlrev_b32 v38, 16, v247
    v_and_b32 v39, 0xffff0000, v247
    v_pk_add_f32 v[32:33], v[32:33], v[36:37]
    v_pk_add_f32 v[34:35], v[34:35], v[38:39]
    v_cvt_pk_bf16_f32 v30, v32, v33
    v_cvt_pk_bf16_f32 v31, v34, v35
    v_lshlrev_b32 v32, 16, v30
    v_and_b32 v33, 0xffff0000, v30
    v_lshlrev_b32 v34, 16, v31
    v_and_b32 v35, 0xffff0000, v31
    v_lshlrev_b32 v36, 16, v240
    v_and_b32 v37, 0xffff0000, v240
    v_lshlrev_b32 v38, 16, v241
    v_and_b32 v39, 0xffff0000, v241
    v_pk_add_f32 v[32:33], v[32:33], v[36:37]
    v_pk_add_f32 v[34:35], v[34:35], v[38:39]
    v_cvt_pk_bf16_f32 v24, v32, v33
    v_cvt_pk_bf16_f32 v25, v34, v35
    s_lshr_b32 s46, s3, 2
    s_add_u32 s46, s46, 0
    s_add_u32 s46, s46, s7
    s_lshl_b32 s46, s46, 5
    v_mul_u32_u24 v9, 1280, v6
    v_lshl_add_u32 v9, v3, 3, v9
    buffer_store_dwordx2 v[24:25], v9, s[48:51], s46 offen
    s_waitcnt lgkmcnt(0)
    v_pk_add_f32 v[152:153], v[152:153], v[156:157]
    v_pk_add_f32 v[154:155], v[154:155], v[158:159]
    v_pk_add_f32 v[160:161], v[160:161], v[164:165]
    v_pk_add_f32 v[162:163], v[162:163], v[166:167]
    v_pk_add_f32 v[168:169], v[168:169], v[172:173]
    v_pk_add_f32 v[170:171], v[170:171], v[174:175]
    v_pk_add_f32 v[176:177], v[176:177], v[180:181]
    v_pk_add_f32 v[178:179], v[178:179], v[182:183]
    v_pk_add_f32 v[152:153], v[152:153], v[160:161]
    v_pk_add_f32 v[154:155], v[154:155], v[162:163]
    v_pk_add_f32 v[168:169], v[168:169], v[176:177]
    v_pk_add_f32 v[170:171], v[170:171], v[178:179]
    v_pk_add_f32 v[152:153], v[152:153], v[168:169]
    v_pk_add_f32 v[154:155], v[154:155], v[170:171]
    v_cvt_pk_bf16_f32 v30, v152, v153
    v_cvt_pk_bf16_f32 v31, v154, v155
    v_lshlrev_b32 v32, 16, v30
    v_and_b32 v33, 0xffff0000, v30
    v_lshlrev_b32 v34, 16, v31
    v_and_b32 v35, 0xffff0000, v31
    v_lshlrev_b32 v36, 16, v248
    v_and_b32 v37, 0xffff0000, v248
    v_lshlrev_b32 v38, 16, v249
    v_and_b32 v39, 0xffff0000, v249
    v_pk_add_f32 v[32:33], v[32:33], v[36:37]
    v_pk_add_f32 v[34:35], v[34:35], v[38:39]
    v_cvt_pk_bf16_f32 v30, v32, v33
    v_cvt_pk_bf16_f32 v31, v34, v35
    v_lshlrev_b32 v32, 16, v30
    v_and_b32 v33, 0xffff0000, v30
    v_lshlrev_b32 v34, 16, v31
    v_and_b32 v35, 0xffff0000, v31
    v_lshlrev_b32 v36, 16, v242
    v_and_b32 v37, 0xffff0000, v242
    v_lshlrev_b32 v38, 16, v243
    v_and_b32 v39, 0xffff0000, v243
    v_pk_add_f32 v[32:33], v[32:33], v[36:37]
    v_pk_add_f32 v[34:35], v[34:35], v[38:39]
    v_cvt_pk_bf16_f32 v26, v32, v33
    v_cvt_pk_bf16_f32 v27, v34, v35
    s_lshr_b32 s46, s3, 2
    s_add_u32 s46, s46, 2
    s_add_u32 s46, s46, s7
    s_lshl_b32 s46, s46, 5
    v_mul_u32_u24 v9, 1280, v6
    v_lshl_add_u32 v9, v3, 3, v9
    buffer_store_dwordx2 v[26:27], v9, s[48:51], s46 offen
    s_cmp_ge_u32 s3, 4
    s_cbranch_scc1 L_FIN
    s_waitcnt lgkmcnt(0)
    v_pk_add_f32 v[184:185], v[184:185], v[188:189]
    v_pk_add_f32 v[186:187], v[186:187], v[190:191]
    v_pk_add_f32 v[192:193], v[192:193], v[196:197]
    v_pk_add_f32 v[194:195], v[194:195], v[198:199]
    v_pk_add_f32 v[200:201], v[200:201], v[204:205]
    v_pk_add_f32 v[202:203], v[202:203], v[206:207]
    v_pk_add_f32 v[208:209], v[208:209], v[212:213]
    v_pk_add_f32 v[210:211], v[210:211], v[214:215]
    v_pk_add_f32 v[184:185], v[184:185], v[192:193]
    v_pk_add_f32 v[186:187], v[186:187], v[194:195]
    v_pk_add_f32 v[200:201], v[200:201], v[208:209]
    v_pk_add_f32 v[202:203], v[202:203], v[210:211]
    v_pk_add_f32 v[184:185], v[184:185], v[200:201]
    v_pk_add_f32 v[186:187], v[186:187], v[202:203]
    v_cvt_pk_bf16_f32 v30, v184, v185
    v_cvt_pk_bf16_f32 v31, v186, v187
    v_lshlrev_b32 v32, 16, v30
    v_and_b32 v33, 0xffff0000, v30
    v_lshlrev_b32 v34, 16, v31
    v_and_b32 v35, 0xffff0000, v31
    v_lshlrev_b32 v36, 16, v250
    v_and_b32 v37, 0xffff0000, v250
    v_lshlrev_b32 v38, 16, v251
    v_and_b32 v39, 0xffff0000, v251
    v_pk_add_f32 v[32:33], v[32:33], v[36:37]
    v_pk_add_f32 v[34:35], v[34:35], v[38:39]
    v_cvt_pk_bf16_f32 v30, v32, v33
    v_cvt_pk_bf16_f32 v31, v34, v35
    v_lshlrev_b32 v32, 16, v30
    v_and_b32 v33, 0xffff0000, v30
    v_lshlrev_b32 v34, 16, v31
    v_and_b32 v35, 0xffff0000, v31
    v_lshlrev_b32 v36, 16, v244
    v_and_b32 v37, 0xffff0000, v244
    v_lshlrev_b32 v38, 16, v245
    v_and_b32 v39, 0xffff0000, v245
    v_pk_add_f32 v[32:33], v[32:33], v[36:37]
    v_pk_add_f32 v[34:35], v[34:35], v[38:39]
    v_cvt_pk_bf16_f32 v28, v32, v33
    v_cvt_pk_bf16_f32 v29, v34, v35
    s_lshr_b32 s46, s3, 2
    s_add_u32 s46, s46, 4
    s_add_u32 s46, s46, s7
    s_lshl_b32 s46, s46, 5
    v_mul_u32_u24 v9, 1280, v6
    v_lshl_add_u32 v9, v3, 3, v9
    buffer_store_dwordx2 v[28:29], v9, s[48:51], s46 offen
L_FIN:
L_END:
    s_endpgm
GBAD_144:
    s_mov_b32 s47, 0
GT_201:
    s_sleep 1
    s_add_u32 s13, s5, 0
    buffer_load_dwordx4 v[8:11], v4, s[8:11], s13 offen offset:0 sc1
    s_waitcnt vmcnt(0)
    v_max_u32 v5, v8, v10
    v_cmp_eq_u32 vcc, -1, v5
    s_cbranch_vccz GR_202
    s_add_u32 s47, s47, 1
    s_cmp_lt_u32 s47, 262144
    s_cbranch_scc1 GT_201
GR_202:
    s_add_u32 s13, s5, 0
    buffer_load_dwordx4 v[12:15], v4, s[8:11], s13 offen offset:1024 sc1
    s_add_u32 s13, s5, 0
    buffer_load_dwordx4 v[16:19], v4, s[8:11], s13 offen offset:2048 sc1
    s_add_u32 s13, s5, 0
    buffer_load_dwordx4 v[20:23], v4, s[8:11], s13 offen offset:3072 sc1
    s_add_u32 s13, s5, 131072
    buffer_load_dwordx4 v[24:27], v4, s[8:11], s13 offen offset:0 sc1
    s_add_u32 s13, s5, 131072
    buffer_load_dwordx4 v[28:31], v4, s[8:11], s13 offen offset:1024 sc1
    s_add_u32 s13, s5, 131072
    buffer_load_dwordx4 v[32:35], v4, s[8:11], s13 offen offset:2048 sc1
    s_add_u32 s13, s5, 131072
    buffer_load_dwordx4 v[36:39], v4, s[8:11], s13 offen offset:3072 sc1
    s_waitcnt vmcnt(0)
    s_branch GOK_145
GBAD_146:
    s_mov_b32 s47, 0
GT_203:
    s_sleep 1
    s_add_u32 s13, s5, 0
    buffer_load_dwordx4 v[12:15], v4, s[8:11], s13 offen offset:1024 sc1
    s_waitcnt vmcnt(0)
    v_max_u32 v5, v12, v14
    v_cmp_eq_u32 vcc, -1, v5
    s_cbranch_vccz GR_204
    s_add_u32 s47, s47, 1
    s_cmp_lt_u32 s47, 262144
    s_cbranch_scc1 GT_203
GR_204:
    s_add_u32 s13, s5, 0
    buffer_load_dwordx4 v[16:19], v4, s[8:11], s13 offen offset:2048 sc1
    s_add_u32 s13, s5, 0
    buffer_load_dwordx4 v[20:23], v4, s[8:11], s13 offen offset:3072 sc1
    s_add_u32 s13, s5, 131072
    buffer_load_dwordx4 v[24:27], v4, s[8:11], s13 offen offset:0 sc1
    s_add_u32 s13, s5, 131072
    buffer_load_dwordx4 v[28:31], v4, s[8:11], s13 offen offset:1024 sc1
    s_add_u32 s13, s5, 131072
    buffer_load_dwordx4 v[32:35], v4, s[8:11], s13 offen offset:2048 sc1
    s_add_u32 s13, s5, 131072
    buffer_load_dwordx4 v[36:39], v4, s[8:11], s13 offen offset:3072 sc1
    s_add_u32 s13, s5, 262144
    buffer_load_dwordx4 v[8:11], v4, s[8:11], s13 offen offset:0 sc1
    s_waitcnt vmcnt(0)
    s_branch GOK_147
GBAD_148:
    s_mov_b32 s47, 0
GT_205:
    s_sleep 1
    s_add_u32 s13, s5, 0
    buffer_load_dwordx4 v[16:19], v4, s[8:11], s13 offen offset:2048 sc1
    s_waitcnt vmcnt(0)
    v_max_u32 v5, v16, v18
    v_cmp_eq_u32 vcc, -1, v5
    s_cbranch_vccz GR_206
    s_add_u32 s47, s47, 1
    s_cmp_lt_u32 s47, 262144
    s_cbranch_scc1 GT_205
GR_206:
    s_add_u32 s13, s5, 0
    buffer_load_dwordx4 v[20:23], v4, s[8:11], s13 offen offset:3072 sc1
    s_add_u32 s13, s5, 131072
    buffer_load_dwordx4 v[24:27], v4, s[8:11], s13 offen offset:0 sc1
    s_add_u32 s13, s5, 131072
    buffer_load_dwordx4 v[28:31], v4, s[8:11], s13 offen offset:1024 sc1
    s_add_u32 s13, s5, 131072
    buffer_load_dwordx4 v[32:35], v4, s[8:11], s13 offen offset:2048 sc1
    s_add_u32 s13, s5, 131072
    buffer_load_dwordx4 v[36:39], v4, s[8:11], s13 offen offset:3072 sc1
    s_add_u32 s13, s5, 262144
    buffer_load_dwordx4 v[8:11], v4, s[8:11], s13 offen offset:0 sc1
    s_add_u32 s13, s5, 262144
    buffer_load_dwordx4 v[12:15], v4, s[8:11], s13 offen offset:1024 sc1
    s_waitcnt vmcnt(0)
    s_branch GOK_149
GBAD_150:
    s_mov_b32 s47, 0
GT_207:
    s_sleep 1
    s_add_u32 s13, s5, 0
    buffer_load_dwordx4 v[20:23], v4, s[8:11], s13 offen offset:3072 sc1
    s_waitcnt vmcnt(0)
    v_max_u32 v5, v20, v22
    v_cmp_eq_u32 vcc, -1, v5
    s_cbranch_vccz GR_208
    s_add_u32 s47, s47, 1
    s_cmp_lt_u32 s47, 262144
    s_cbranch_scc1 GT_207
GR_208:
    s_add_u32 s13, s5, 131072
    buffer_load_dwordx4 v[24:27], v4, s[8:11], s13 offen offset:0 sc1
    s_add_u32 s13, s5, 131072
    buffer_load_dwordx4 v[28:31], v4, s[8:11], s13 offen offset:1024 sc1
    s_add_u32 s13, s5, 131072
    buffer_load_dwordx4 v[32:35], v4, s[8:11], s13 offen offset:2048 sc1
    s_add_u32 s13, s5, 131072
    buffer_load_dwordx4 v[36:39], v4, s[8:11], s13 offen offset:3072 sc1
    s_add_u32 s13, s5, 262144
    buffer_load_dwordx4 v[8:11], v4, s[8:11], s13 offen offset:0 sc1
    s_add_u32 s13, s5, 262144
    buffer_load_dwordx4 v[12:15], v4, s[8:11], s13 offen offset:1024 sc1
    s_add_u32 s13, s5, 262144
    buffer_load_dwordx4 v[16:19], v4, s[8:11], s13 offen offset:2048 sc1
    s_waitcnt vmcnt(0)
    s_branch GOK_151
GBAD_153:
    s_mov_b32 s47, 0
GT_209:
    s_sleep 1
    s_add_u32 s13, s5, 131072
    buffer_load_dwordx4 v[24:27], v4, s[8:11], s13 offen offset:0 sc1
    s_waitcnt vmcnt(0)
    v_max_u32 v5, v24, v26
    v_cmp_eq_u32 vcc, -1, v5
    s_cbranch_vccz GR_210
    s_add_u32 s47, s47, 1
    s_cmp_lt_u32 s47, 262144
    s_cbranch_scc1 GT_209
GR_210:
    s_add_u32 s13, s5, 131072
    buffer_load_dwordx4 v[28:31], v4, s[8:11], s13 offen offset:1024 sc1
    s_add_u32 s13, s5, 131072
    buffer_load_dwordx4 v[32:35], v4, s[8:11], s13 offen offset:2048 sc1
    s_add_u32 s13, s5, 131072
    buffer_load_dwordx4 v[36:39], v4, s[8:11], s13 offen offset:3072 sc1
    s_add_u32 s13, s5, 262144
    buffer_load_dwordx4 v[8:11], v4, s[8:11], s13 offen offset:0 sc1
    s_add_u32 s13, s5, 262144
    buffer_load_dwordx4 v[12:15], v4, s[8:11], s13 offen offset:1024 sc1
    s_add_u32 s13, s5, 262144
    buffer_load_dwordx4 v[16:19], v4, s[8:11], s13 offen offset:2048 sc1
    s_add_u32 s13, s5, 262144
    buffer_load_dwordx4 v[20:23], v4, s[8:11], s13 offen offset:3072 sc1
    s_waitcnt vmcnt(0)
    s_branch GOK_154
GBAD_155:
    s_mov_b32 s47, 0
GT_211:
    s_sleep 1
    s_add_u32 s13, s5, 131072
    buffer_load_dwordx4 v[28:31], v4, s[8:11], s13 offen offset:1024 sc1
    s_waitcnt vmcnt(0)
    v_max_u32 v5, v28, v30
    v_cmp_eq_u32 vcc, -1, v5
    s_cbranch_vccz GR_212
    s_add_u32 s47, s47, 1
    s_cmp_lt_u32 s47, 262144
    s_cbranch_scc1 GT_211
GR_212:
    s_add_u32 s13, s5, 131072
    buffer_load_dwordx4 v[32:35], v4, s[8:11], s13 offen offset:2048 sc1
    s_add_u32 s13, s5, 131072
    buffer_load_dwordx4 v[36:39], v4, s[8:11], s13 offen offset:3072 sc1
    s_add_u32 s13, s5, 262144
    buffer_load_dwordx4 v[8:11], v4, s[8:11], s13 offen offset:0 sc1
    s_add_u32 s13, s5, 262144
    buffer_load_dwordx4 v[12:15], v4, s[8:11], s13 offen offset:1024 sc1
    s_add_u32 s13, s5, 262144
    buffer_load_dwordx4 v[16:19], v4, s[8:11], s13 offen offset:2048 sc1
    s_add_u32 s13, s5, 262144
    buffer_load_dwordx4 v[20:23], v4, s[8:11], s13 offen offset:3072 sc1
    s_add_u32 s13, s5, 393216
    buffer_load_dwordx4 v[24:27], v4, s[8:11], s13 offen offset:0 sc1
    s_waitcnt vmcnt(0)
    s_branch GOK_156
GBAD_157:
    s_mov_b32 s47, 0
GT_213:
    s_sleep 1
    s_add_u32 s13, s5, 131072
    buffer_load_dwordx4 v[32:35], v4, s[8:11], s13 offen offset:2048 sc1
    s_waitcnt vmcnt(0)
    v_max_u32 v5, v32, v34
    v_cmp_eq_u32 vcc, -1, v5
    s_cbranch_vccz GR_214
    s_add_u32 s47, s47, 1
    s_cmp_lt_u32 s47, 262144
    s_cbranch_scc1 GT_213
GR_214:
    s_add_u32 s13, s5, 131072
    buffer_load_dwordx4 v[36:39], v4, s[8:11], s13 offen offset:3072 sc1
    s_add_u32 s13, s5, 262144
    buffer_load_dwordx4 v[8:11], v4, s[8:11], s13 offen offset:0 sc1
    s_add_u32 s13, s5, 262144
    buffer_load_dwordx4 v[12:15], v4, s[8:11], s13 offen offset:1024 sc1
    s_add_u32 s13, s5, 262144
    buffer_load_dwordx4 v[16:19], v4, s[8:11], s13 offen offset:2048 sc1
    s_add_u32 s13, s5, 262144
    buffer_load_dwordx4 v[20:23], v4, s[8:11], s13 offen offset:3072 sc1
    s_add_u32 s13, s5, 393216
    buffer_load_dwordx4 v[24:27], v4, s[8:11], s13 offen offset:0 sc1
    s_add_u32 s13, s5, 393216
    buffer_load_dwordx4 v[28:31], v4, s[8:11], s13 offen offset:1024 sc1
    s_waitcnt vmcnt(0)
    s_branch GOK_158
GBAD_159:
    s_mov_b32 s47, 0
GT_215:
    s_sleep 1
    s_add_u32 s13, s5, 131072
    buffer_load_dwordx4 v[36:39], v4, s[8:11], s13 offen offset:3072 sc1
    s_waitcnt vmcnt(0)
    v_max_u32 v5, v36, v38
    v_cmp_eq_u32 vcc, -1, v5
    s_cbranch_vccz GR_216
    s_add_u32 s47, s47, 1
    s_cmp_lt_u32 s47, 262144
    s_cbranch_scc1 GT_215
GR_216:
    s_add_u32 s13, s5, 262144
    buffer_load_dwordx4 v[8:11], v4, s[8:11], s13 offen offset:0 sc1
    s_add_u32 s13, s5, 262144
    buffer_load_dwordx4 v[12:15], v4, s[8:11], s13 offen offset:1024 sc1
    s_add_u32 s13, s5, 262144
    buffer_load_dwordx4 v[16:19], v4, s[8:11], s13 offen offset:2048 sc1
    s_add_u32 s13, s5, 262144
    buffer_load_dwordx4 v[20:23], v4, s[8:11], s13 offen offset:3072 sc1
    s_add_u32 s13, s5, 393216
    buffer_load_dwordx4 v[24:27], v4, s[8:11], s13 offen offset:0 sc1
    s_add_u32 s13, s5, 393216
    buffer_load_dwordx4 v[28:31], v4, s[8:11], s13 offen offset:1024 sc1
    s_add_u32 s13, s5, 393216
    buffer_load_dwordx4 v[32:35], v4, s[8:11], s13 offen offset:2048 sc1
    s_waitcnt vmcnt(0)
    s_branch GOK_160
GBAD_161:
    s_mov_b32 s47, 0
GT_217:
    s_sleep 1
    s_add_u32 s13, s5, 262144
    buffer_load_dwordx4 v[8:11], v4, s[8:11], s13 offen offset:0 sc1
    s_waitcnt vmcnt(0)
    v_max_u32 v5, v8, v10
    v_cmp_eq_u32 vcc, -1, v5
    s_cbranch_vccz GR_218
    s_add_u32 s47, s47, 1
    s_cmp_lt_u32 s47, 262144
    s_cbranch_scc1 GT_217
GR_218:
    s_add_u32 s13, s5, 262144
    buffer_load_dwordx4 v[12:15], v4, s[8:11], s13 offen offset:1024 sc1
    s_add_u32 s13, s5, 262144
    buffer_load_dwordx4 v[16:19], v4, s[8:11], s13 offen offset:2048 sc1
    s_add_u32 s13, s5, 262144
    buffer_load_dwordx4 v[20:23], v4, s[8:11], s13 offen offset:3072 sc1
    s_add_u32 s13, s5, 393216
    buffer_load_dwordx4 v[24:27], v4, s[8:11], s13 offen offset:0 sc1
    s_add_u32 s13, s5, 393216
    buffer_load_dwordx4 v[28:31], v4, s[8:11], s13 offen offset:1024 sc1
    s_add_u32 s13, s5, 393216
    buffer_load_dwordx4 v[32:35], v4, s[8:11], s13 offen offset:2048 sc1
    s_add_u32 s13, s5, 393216
    buffer_load_dwordx4 v[36:39], v4, s[8:11], s13 offen offset:3072 sc1
    s_waitcnt vmcnt(0)
    s_branch GOK_162
GBAD_163:
    s_mov_b32 s47, 0
GT_219:
    s_sleep 1
    s_add_u32 s13, s5, 262144
    buffer_load_dwordx4 v[12:15], v4, s[8:11], s13 offen offset:1024 sc1
    s_waitcnt vmcnt(0)
    v_max_u32 v5, v12, v14
    v_cmp_eq_u32 vcc, -1, v5
    s_cbranch_vccz GR_220
    s_add_u32 s47, s47, 1
    s_cmp_lt_u32 s47, 262144
    s_cbranch_scc1 GT_219
GR_220:
    s_add_u32 s13, s5, 262144
    buffer_load_dwordx4 v[16:19], v4, s[8:11], s13 offen offset:2048 sc1
    s_add_u32 s13, s5, 262144
    buffer_load_dwordx4 v[20:23], v4, s[8:11], s13 offen offset:3072 sc1
    s_add_u32 s13, s5, 393216
    buffer_load_dwordx4 v[24:27], v4, s[8:11], s13 offen offset:0 sc1
    s_add_u32 s13, s5, 393216
    buffer_load_dwordx4 v[28:31], v4, s[8:11], s13 offen offset:1024 sc1
    s_add_u32 s13, s5, 393216
    buffer_load_dwordx4 v[32:35], v4, s[8:11], s13 offen offset:2048 sc1
    s_add_u32 s13, s5, 393216
    buffer_load_dwordx4 v[36:39], v4, s[8:11], s13 offen offset:3072 sc1
    s_add_u32 s13, s5, 524288
    buffer_load_dwordx4 v[8:11], v4, s[8:11], s13 offen offset:0 sc1
    s_waitcnt vmcnt(0)
    s_branch GOK_164
GBAD_165:
    s_mov_b32 s47, 0
GT_221:
    s_sleep 1
    s_add_u32 s13, s5, 262144
    buffer_load_dwordx4 v[16:19], v4, s[8:11], s13 offen offset:2048 sc1
    s_waitcnt vmcnt(0)
    v_max_u32 v5, v16, v18
    v_cmp_eq_u32 vcc, -1, v5
    s_cbranch_vccz GR_222
    s_add_u32 s47, s47, 1
    s_cmp_lt_u32 s47, 262144
    s_cbranch_scc1 GT_221
GR_222:
    s_add_u32 s13, s5, 262144
    buffer_load_dwordx4 v[20:23], v4, s[8:11], s13 offen offset:3072 sc1
    s_add_u32 s13, s5, 393216
    buffer_load_dwordx4 v[24:27], v4, s[8:11], s13 offen offset:0 sc1
    s_add_u32 s13, s5, 393216
    buffer_load_dwordx4 v[28:31], v4, s[8:11], s13 offen offset:1024 sc1
    s_add_u32 s13, s5, 393216
    buffer_load_dwordx4 v[32:35], v4, s[8:11], s13 offen offset:2048 sc1
    s_add_u32 s13, s5, 393216
    buffer_load_dwordx4 v[36:39], v4, s[8:11], s13 offen offset:3072 sc1
    s_add_u32 s13, s5, 524288
    buffer_load_dwordx4 v[8:11], v4, s[8:11], s13 offen offset:0 sc1
    s_add_u32 s13, s5, 524288
    buffer_load_dwordx4 v[12:15], v4, s[8:11], s13 offen offset:1024 sc1
    s_waitcnt vmcnt(0)
    s_branch GOK_166
GBAD_167:
    s_mov_b32 s47, 0
GT_223:
    s_sleep 1
    s_add_u32 s13, s5, 262144
    buffer_load_dwordx4 v[20:23], v4, s[8:11], s13 offen offset:3072 sc1
    s_waitcnt vmcnt(0)
    v_max_u32 v5, v20, v22
    v_cmp_eq_u32 vcc, -1, v5
    s_cbranch_vccz GR_224
    s_add_u32 s47, s47, 1
    s_cmp_lt_u32 s47, 262144
    s_cbranch_scc1 GT_223
GR_224:
    s_add_u32 s13, s5, 393216
    buffer_load_dwordx4 v[24:27], v4, s[8:11], s13 offen offset:0 sc1
    s_add_u32 s13, s5, 393216
    buffer_load_dwordx4 v[28:31], v4, s[8:11], s13 offen offset:1024 sc1
    s_add_u32 s13, s5, 393216
    buffer_load_dwordx4 v[32:35], v4, s[8:11], s13 offen offset:2048 sc1
    s_add_u32 s13, s5, 393216
    buffer_load_dwordx4 v[36:39], v4, s[8:11], s13 offen offset:3072 sc1
    s_add_u32 s13, s5, 524288
    buffer_load_dwordx4 v[8:11], v4, s[8:11], s13 offen offset:0 sc1
    s_add_u32 s13, s5, 524288
    buffer_load_dwordx4 v[12:15], v4, s[8:11], s13 offen offset:1024 sc1
    s_add_u32 s13, s5, 524288
    buffer_load_dwordx4 v[16:19], v4, s[8:11], s13 offen offset:2048 sc1
    s_waitcnt vmcnt(0)
    s_branch GOK_168
GBAD_169:
    s_mov_b32 s47, 0
GT_225:
    s_sleep 1
    s_add_u32 s13, s5, 393216
    buffer_load_dwordx4 v[24:27], v4, s[8:11], s13 offen offset:0 sc1
    s_waitcnt vmcnt(0)
    v_max_u32 v5, v24, v26
    v_cmp_eq_u32 vcc, -1, v5
    s_cbranch_vccz GR_226
    s_add_u32 s47, s47, 1
    s_cmp_lt_u32 s47, 262144
    s_cbranch_scc1 GT_225
GR_226:
    s_add_u32 s13, s5, 393216
    buffer_load_dwordx4 v[28:31], v4, s[8:11], s13 offen offset:1024 sc1
    s_add_u32 s13, s5, 393216
    buffer_load_dwordx4 v[32:35], v4, s[8:11], s13 offen offset:2048 sc1
    s_add_u32 s13, s5, 393216
    buffer_load_dwordx4 v[36:39], v4, s[8:11], s13 offen offset:3072 sc1
    s_add_u32 s13, s5, 524288
    buffer_load_dwordx4 v[8:11], v4, s[8:11], s13 offen offset:0 sc1
    s_add_u32 s13, s5, 524288
    buffer_load_dwordx4 v[12:15], v4, s[8:11], s13 offen offset:1024 sc1
    s_add_u32 s13, s5, 524288
    buffer_load_dwordx4 v[16:19], v4, s[8:11], s13 offen offset:2048 sc1
    s_add_u32 s13, s5, 524288
    buffer_load_dwordx4 v[20:23], v4, s[8:11], s13 offen offset:3072 sc1
    s_waitcnt vmcnt(0)
    s_branch GOK_170
GBAD_171:
    s_mov_b32 s47, 0
GT_227:
    s_sleep 1
    s_add_u32 s13, s5, 393216
    buffer_load_dwordx4 v[28:31], v4, s[8:11], s13 offen offset:1024 sc1
    s_waitcnt vmcnt(0)
    v_max_u32 v5, v28, v30
    v_cmp_eq_u32 vcc, -1, v5
    s_cbranch_vccz GR_228
    s_add_u32 s47, s47, 1
    s_cmp_lt_u32 s47, 262144
    s_cbranch_scc1 GT_227
GR_228:
    s_add_u32 s13, s5, 393216
    buffer_load_dwordx4 v[32:35], v4, s[8:11], s13 offen offset:2048 sc1
    s_add_u32 s13, s5, 393216
    buffer_load_dwordx4 v[36:39], v4, s[8:11], s13 offen offset:3072 sc1
    s_add_u32 s13, s5, 524288
    buffer_load_dwordx4 v[8:11], v4, s[8:11], s13 offen offset:0 sc1
    s_add_u32 s13, s5, 524288
    buffer_load_dwordx4 v[12:15], v4, s[8:11], s13 offen offset:1024 sc1
    s_add_u32 s13, s5, 524288
    buffer_load_dwordx4 v[16:19], v4, s[8:11], s13 offen offset:2048 sc1
    s_add_u32 s13, s5, 524288
    buffer_load_dwordx4 v[20:23], v4, s[8:11], s13 offen offset:3072 sc1
    s_add_u32 s13, s5, 655360
    buffer_load_dwordx4 v[24:27], v4, s[8:11], s13 offen offset:0 sc1
    s_waitcnt vmcnt(0)
    s_branch GOK_172
GBAD_173:
    s_mov_b32 s47, 0
GT_229:
    s_sleep 1
    s_add_u32 s13, s5, 393216
    buffer_load_dwordx4 v[32:35], v4, s[8:11], s13 offen offset:2048 sc1
    s_waitcnt vmcnt(0)
    v_max_u32 v5, v32, v34
    v_cmp_eq_u32 vcc, -1, v5
    s_cbranch_vccz GR_230
    s_add_u32 s47, s47, 1
    s_cmp_lt_u32 s47, 262144
    s_cbranch_scc1 GT_229
GR_230:
    s_add_u32 s13, s5, 393216
    buffer_load_dwordx4 v[36:39], v4, s[8:11], s13 offen offset:3072 sc1
    s_add_u32 s13, s5, 524288
    buffer_load_dwordx4 v[8:11], v4, s[8:11], s13 offen offset:0 sc1
    s_add_u32 s13, s5, 524288
    buffer_load_dwordx4 v[12:15], v4, s[8:11], s13 offen offset:1024 sc1
    s_add_u32 s13, s5, 524288
    buffer_load_dwordx4 v[16:19], v4, s[8:11], s13 offen offset:2048 sc1
    s_add_u32 s13, s5, 524288
    buffer_load_dwordx4 v[20:23], v4, s[8:11], s13 offen offset:3072 sc1
    s_add_u32 s13, s5, 655360
    buffer_load_dwordx4 v[24:27], v4, s[8:11], s13 offen offset:0 sc1
    s_add_u32 s13, s5, 655360
    buffer_load_dwordx4 v[28:31], v4, s[8:11], s13 offen offset:1024 sc1
    s_waitcnt vmcnt(0)
    s_branch GOK_174
GBAD_175:
    s_mov_b32 s47, 0
GT_231:
    s_sleep 1
    s_add_u32 s13, s5, 393216
    buffer_load_dwordx4 v[36:39], v4, s[8:11], s13 offen offset:3072 sc1
    s_waitcnt vmcnt(0)
    v_max_u32 v5, v36, v38
    v_cmp_eq_u32 vcc, -1, v5
    s_cbranch_vccz GR_232
    s_add_u32 s47, s47, 1
    s_cmp_lt_u32 s47, 262144
    s_cbranch_scc1 GT_231
GR_232:
    s_add_u32 s13, s5, 524288
    buffer_load_dwordx4 v[8:11], v4, s[8:11], s13 offen offset:0 sc1
    s_add_u32 s13, s5, 524288
    buffer_load_dwordx4 v[12:15], v4, s[8:11], s13 offen offset:1024 sc1
    s_add_u32 s13, s5, 524288
    buffer_load_dwordx4 v[16:19], v4, s[8:11], s13 offen offset:2048 sc1
    s_add_u32 s13, s5, 524288
    buffer_load_dwordx4 v[20:23], v4, s[8:11], s13 offen offset:3072 sc1
    s_add_u32 s13, s5, 655360
    buffer_load_dwordx4 v[24:27], v4, s[8:11], s13 offen offset:0 sc1
    s_add_u32 s13, s5, 655360
    buffer_load_dwordx4 v[28:31], v4, s[8:11], s13 offen offset:1024 sc1
    s_add_u32 s13, s5, 655360
    buffer_load_dwordx4 v[32:35], v4, s[8:11], s13 offen offset:2048 sc1
    s_waitcnt vmcnt(0)
    s_branch GOK_176
GBAD_177:
    s_mov_b32 s47, 0
GT_233:
    s_sleep 1
    s_add_u32 s13, s5, 524288
    buffer_load_dwordx4 v[8:11], v4, s[8:11], s13 offen offset:0 sc1
    s_waitcnt vmcnt(0)
    v_max_u32 v5, v8, v10
    v_cmp_eq_u32 vcc, -1, v5
    s_cbranch_vccz GR_234
    s_add_u32 s47, s47, 1
    s_cmp_lt_u32 s47, 262144
    s_cbranch_scc1 GT_233
GR_234:
    s_add_u32 s13, s5, 524288
    buffer_load_dwordx4 v[12:15], v4, s[8:11], s13 offen offset:1024 sc1
    s_add_u32 s13, s5, 524288
    buffer_load_dwordx4 v[16:19], v4, s[8:11], s13 offen offset:2048 sc1
    s_add_u32 s13, s5, 524288
    buffer_load_dwordx4 v[20:23], v4, s[8:11], s13 offen offset:3072 sc1
    s_add_u32 s13, s5, 655360
    buffer_load_dwordx4 v[24:27], v4, s[8:11], s13 offen offset:0 sc1
    s_add_u32 s13, s5, 655360
    buffer_load_dwordx4 v[28:31], v4, s[8:11], s13 offen offset:1024 sc1
    s_add_u32 s13, s5, 655360
    buffer_load_dwordx4 v[32:35], v4, s[8:11], s13 offen offset:2048 sc1
    s_add_u32 s13, s5, 655360
    buffer_load_dwordx4 v[36:39], v4, s[8:11], s13 offen offset:3072 sc1
    s_waitcnt vmcnt(0)
    s_branch GOK_178
GBAD_179:
    s_mov_b32 s47, 0
GT_235:
    s_sleep 1
    s_add_u32 s13, s5, 524288
    buffer_load_dwordx4 v[12:15], v4, s[8:11], s13 offen offset:1024 sc1
    s_waitcnt vmcnt(0)
    v_max_u32 v5, v12, v14
    v_cmp_eq_u32 vcc, -1, v5
    s_cbranch_vccz GR_236
    s_add_u32 s47, s47, 1
    s_cmp_lt_u32 s47, 262144
    s_cbranch_scc1 GT_235
GR_236:
    s_add_u32 s13, s5, 524288
    buffer_load_dwordx4 v[16:19], v4, s[8:11], s13 offen offset:2048 sc1
    s_add_u32 s13, s5, 524288
    buffer_load_dwordx4 v[20:23], v4, s[8:11], s13 offen offset:3072 sc1
    s_add_u32 s13, s5, 655360
    buffer_load_dwordx4 v[24:27], v4, s[8:11], s13 offen offset:0 sc1
    s_add_u32 s13, s5, 655360
    buffer_load_dwordx4 v[28:31], v4, s[8:11], s13 offen offset:1024 sc1
    s_add_u32 s13, s5, 655360
    buffer_load_dwordx4 v[32:35], v4, s[8:11], s13 offen offset:2048 sc1
    s_add_u32 s13, s5, 655360
    buffer_load_dwordx4 v[36:39], v4, s[8:11], s13 offen offset:3072 sc1
    s_add_u32 s13, s5, 786432
    buffer_load_dwordx4 v[8:11], v4, s[8:11], s13 offen offset:0 sc1
    s_waitcnt vmcnt(0)
    s_branch GOK_180
GBAD_181:
    s_mov_b32 s47, 0
GT_237:
    s_sleep 1
    s_add_u32 s13, s5, 524288
    buffer_load_dwordx4 v[16:19], v4, s[8:11], s13 offen offset:2048 sc1
    s_waitcnt vmcnt(0)
    v_max_u32 v5, v16, v18
    v_cmp_eq_u32 vcc, -1, v5
    s_cbranch_vccz GR_238
    s_add_u32 s47, s47, 1
    s_cmp_lt_u32 s47, 262144
    s_cbranch_scc1 GT_237
GR_238:
    s_add_u32 s13, s5, 524288
    buffer_load_dwordx4 v[20:23], v4, s[8:11], s13 offen offset:3072 sc1
    s_add_u32 s13, s5, 655360
    buffer_load_dwordx4 v[24:27], v4, s[8:11], s13 offen offset:0 sc1
    s_add_u32 s13, s5, 655360
    buffer_load_dwordx4 v[28:31], v4, s[8:11], s13 offen offset:1024 sc1
    s_add_u32 s13, s5, 655360
    buffer_load_dwordx4 v[32:35], v4, s[8:11], s13 offen offset:2048 sc1
    s_add_u32 s13, s5, 655360
    buffer_load_dwordx4 v[36:39], v4, s[8:11], s13 offen offset:3072 sc1
    s_add_u32 s13, s5, 786432
    buffer_load_dwordx4 v[8:11], v4, s[8:11], s13 offen offset:0 sc1
    s_add_u32 s13, s5, 786432
    buffer_load_dwordx4 v[12:15], v4, s[8:11], s13 offen offset:1024 sc1
    s_waitcnt vmcnt(0)
    s_branch GOK_182
GBAD_183:
    s_mov_b32 s47, 0
GT_239:
    s_sleep 1
    s_add_u32 s13, s5, 524288
    buffer_load_dwordx4 v[20:23], v4, s[8:11], s13 offen offset:3072 sc1
    s_waitcnt vmcnt(0)
    v_max_u32 v5, v20, v22
    v_cmp_eq_u32 vcc, -1, v5
    s_cbranch_vccz GR_240
    s_add_u32 s47, s47, 1
    s_cmp_lt_u32 s47, 262144
    s_cbranch_scc1 GT_239
GR_240:
    s_add_u32 s13, s5, 655360
    buffer_load_dwordx4 v[24:27], v4, s[8:11], s13 offen offset:0 sc1
    s_add_u32 s13, s5, 655360
    buffer_load_dwordx4 v[28:31], v4, s[8:11], s13 offen offset:1024 sc1
    s_add_u32 s13, s5, 655360
    buffer_load_dwordx4 v[32:35], v4, s[8:11], s13 offen offset:2048 sc1
    s_add_u32 s13, s5, 655360
    buffer_load_dwordx4 v[36:39], v4, s[8:11], s13 offen offset:3072 sc1
    s_add_u32 s13, s5, 786432
    buffer_load_dwordx4 v[8:11], v4, s[8:11], s13 offen offset:0 sc1
    s_add_u32 s13, s5, 786432
    buffer_load_dwordx4 v[12:15], v4, s[8:11], s13 offen offset:1024 sc1
    s_add_u32 s13, s5, 786432
    buffer_load_dwordx4 v[16:19], v4, s[8:11], s13 offen offset:2048 sc1
    s_waitcnt vmcnt(0)
    s_branch GOK_184
GBAD_185:
    s_mov_b32 s47, 0
GT_241:
    s_sleep 1
    s_add_u32 s13, s5, 655360
    buffer_load_dwordx4 v[24:27], v4, s[8:11], s13 offen offset:0 sc1
    s_waitcnt vmcnt(0)
    v_max_u32 v5, v24, v26
    v_cmp_eq_u32 vcc, -1, v5
    s_cbranch_vccz GR_242
    s_add_u32 s47, s47, 1
    s_cmp_lt_u32 s47, 262144
    s_cbranch_scc1 GT_241
GR_242:
    s_add_u32 s13, s5, 655360
    buffer_load_dwordx4 v[28:31], v4, s[8:11], s13 offen offset:1024 sc1
    s_add_u32 s13, s5, 655360
    buffer_load_dwordx4 v[32:35], v4, s[8:11], s13 offen offset:2048 sc1
    s_add_u32 s13, s5, 655360
    buffer_load_dwordx4 v[36:39], v4, s[8:11], s13 offen offset:3072 sc1
    s_add_u32 s13, s5, 786432
    buffer_load_dwordx4 v[8:11], v4, s[8:11], s13 offen offset:0 sc1
    s_add_u32 s13, s5, 786432
    buffer_load_dwordx4 v[12:15], v4, s[8:11], s13 offen offset:1024 sc1
    s_add_u32 s13, s5, 786432
    buffer_load_dwordx4 v[16:19], v4, s[8:11], s13 offen offset:2048 sc1
    s_add_u32 s13, s5, 786432
    buffer_load_dwordx4 v[20:23], v4, s[8:11], s13 offen offset:3072 sc1
    s_waitcnt vmcnt(0)
    s_branch GOK_186
GBAD_187:
    s_mov_b32 s47, 0
GT_243:
    s_sleep 1
    s_add_u32 s13, s5, 655360
    buffer_load_dwordx4 v[28:31], v4, s[8:11], s13 offen offset:1024 sc1
    s_waitcnt vmcnt(0)
    v_max_u32 v5, v28, v30
    v_cmp_eq_u32 vcc, -1, v5
    s_cbranch_vccz GR_244
    s_add_u32 s47, s47, 1
    s_cmp_lt_u32 s47, 262144
    s_cbranch_scc1 GT_243
GR_244:
    s_add_u32 s13, s5, 655360
    buffer_load_dwordx4 v[32:35], v4, s[8:11], s13 offen offset:2048 sc1
    s_add_u32 s13, s5, 655360
    buffer_load_dwordx4 v[36:39], v4, s[8:11], s13 offen offset:3072 sc1
    s_add_u32 s13, s5, 786432
    buffer_load_dwordx4 v[8:11], v4, s[8:11], s13 offen offset:0 sc1
    s_add_u32 s13, s5, 786432
    buffer_load_dwordx4 v[12:15], v4, s[8:11], s13 offen offset:1024 sc1
    s_add_u32 s13, s5, 786432
    buffer_load_dwordx4 v[16:19], v4, s[8:11], s13 offen offset:2048 sc1
    s_add_u32 s13, s5, 786432
    buffer_load_dwordx4 v[20:23], v4, s[8:11], s13 offen offset:3072 sc1
    s_waitcnt vmcnt(0)
    s_branch GOK_188
GBAD_189:
    s_mov_b32 s47, 0
GT_245:
    s_sleep 1
    s_add_u32 s13, s5, 655360
    buffer_load_dwordx4 v[32:35], v4, s[8:11], s13 offen offset:2048 sc1
    s_waitcnt vmcnt(0)
    v_max_u32 v5, v32, v34
    v_cmp_eq_u32 vcc, -1, v5
    s_cbranch_vccz GR_246
    s_add_u32 s47, s47, 1
    s_cmp_lt_u32 s47, 262144
    s_cbranch_scc1 GT_245
GR_246:
    s_add_u32 s13, s5, 655360
    buffer_load_dwordx4 v[36:39], v4, s[8:11], s13 offen offset:3072 sc1
    s_add_u32 s13, s5, 786432
    buffer_load_dwordx4 v[8:11], v4, s[8:11], s13 offen offset:0 sc1
    s_add_u32 s13, s5, 786432
    buffer_load_dwordx4 v[12:15], v4, s[8:11], s13 offen offset:1024 sc1
    s_add_u32 s13, s5, 786432
    buffer_load_dwordx4 v[16:19], v4, s[8:11], s13 offen offset:2048 sc1
    s_add_u32 s13, s5, 786432
    buffer_load_dwordx4 v[20:23], v4, s[8:11], s13 offen offset:3072 sc1
    s_waitcnt vmcnt(0)
    s_branch GOK_190
GBAD_191:
    s_mov_b32 s47, 0
GT_247:
    s_sleep 1
    s_add_u32 s13, s5, 655360
    buffer_load_dwordx4 v[36:39], v4, s[8:11], s13 offen offset:3072 sc1
    s_waitcnt vmcnt(0)
    v_max_u32 v5, v36, v38
    v_cmp_eq_u32 vcc, -1, v5
    s_cbranch_vccz GR_248
    s_add_u32 s47, s47, 1
    s_cmp_lt_u32 s47, 262144
    s_cbranch_scc1 GT_247
GR_248:
    s_add_u32 s13, s5, 786432
    buffer_load_dwordx4 v[8:11], v4, s[8:11], s13 offen offset:0 sc1
    s_add_u32 s13, s5, 786432
    buffer_load_dwordx4 v[12:15], v4, s[8:11], s13 offen offset:1024 sc1
    s_add_u32 s13, s5, 786432
    buffer_load_dwordx4 v[16:19], v4, s[8:11], s13 offen offset:2048 sc1
    s_add_u32 s13, s5, 786432
    buffer_load_dwordx4 v[20:23], v4, s[8:11], s13 offen offset:3072 sc1
    s_waitcnt vmcnt(0)
    s_branch GOK_192
GBAD_193:
    s_mov_b32 s47, 0
GT_249:
    s_sleep 1
    s_add_u32 s13, s5, 786432
    buffer_load_dwordx4 v[8:11], v4, s[8:11], s13 offen offset:0 sc1
    s_waitcnt vmcnt(0)
    v_max_u32 v5, v8, v10
    v_cmp_eq_u32 vcc, -1, v5
    s_cbranch_vccz GR_250
    s_add_u32 s47, s47, 1
    s_cmp_lt_u32 s47, 262144
    s_cbranch_scc1 GT_249
GR_250:
    s_add_u32 s13, s5, 786432
    buffer_load_dwordx4 v[12:15], v4, s[8:11], s13 offen offset:1024 sc1
    s_add_u32 s13, s5, 786432
    buffer_load_dwordx4 v[16:19], v4, s[8:11], s13 offen offset:2048 sc1
    s_add_u32 s13, s5, 786432
    buffer_load_dwordx4 v[20:23], v4, s[8:11], s13 offen offset:3072 sc1
    s_waitcnt vmcnt(0)
    s_branch GOK_194
GBAD_195:
    s_mov_b32 s47, 0
GT_251:
    s_sleep 1
    s_add_u32 s13, s5, 786432
    buffer_load_dwordx4 v[12:15], v4, s[8:11], s13 offen offset:1024 sc1
    s_waitcnt vmcnt(0)
    v_max_u32 v5, v12, v14
    v_cmp_eq_u32 vcc, -1, v5
    s_cbranch_vccz GR_252
    s_add_u32 s47, s47, 1
    s_cmp_lt_u32 s47, 262144
    s_cbranch_scc1 GT_251
GR_252:
    s_add_u32 s13, s5, 786432
    buffer_load_dwordx4 v[16:19], v4, s[8:11], s13 offen offset:2048 sc1
    s_add_u32 s13, s5, 786432
    buffer_load_dwordx4 v[20:23], v4, s[8:11], s13 offen offset:3072 sc1
    s_waitcnt vmcnt(0)
    s_branch GOK_196
GBAD_197:
    s_mov_b32 s47, 0
GT_253:
    s_sleep 1
    s_add_u32 s13, s5, 786432
    buffer_load_dwordx4 v[16:19], v4, s[8:11], s13 offen offset:2048 sc1
    s_waitcnt vmcnt(0)
    v_max_u32 v5, v16, v18
    v_cmp_eq_u32 vcc, -1, v5
    s_cbranch_vccz GR_254
    s_add_u32 s47, s47, 1
    s_cmp_lt_u32 s47, 262144
    s_cbranch_scc1 GT_253
GR_254:
    s_add_u32 s13, s5, 786432
    buffer_load_dwordx4 v[20:23], v4, s[8:11], s13 offen offset:3072 sc1
    s_waitcnt vmcnt(0)
    s_branch GOK_198
GBAD_199:
    s_mov_b32 s47, 0
GT_255:
    s_sleep 1
    s_add_u32 s13, s5, 786432
    buffer_load_dwordx4 v[20:23], v4, s[8:11], s13 offen offset:3072 sc1
    s_waitcnt vmcnt(0)
    v_max_u32 v5, v20, v22
    v_cmp_eq_u32 vcc, -1, v5
    s_cbranch_vccz GR_256
    s_add_u32 s47, s47, 1
    s_cmp_lt_u32 s47, 262144
    s_cbranch_scc1 GT_255
GR_256:
    s_waitcnt vmcnt(0)
    s_branch GOK_200
L_CODE_END:
.section .rodata,"a"
.p2align 6
.amdhsa_kernel sequential_preLN__ssm_conv_s4d__dense_activation_squared_relu__prompt_kernel
  .amdhsa_next_free_vgpr 256
  .amdhsa_next_free_sgpr 102
  .amdhsa_accum_offset 256
  .amdhsa_group_segment_fixed_size 0
  .amdhsa_kernarg_size 120
  .amdhsa_user_sgpr_count 2
  .amdhsa_user_sgpr_kernarg_segment_ptr 1
  .amdhsa_system_sgpr_workgroup_id_x 1
.end_amdhsa_kernel
```
